```python
import torch

def _softmax(x, axis=-1):
    return torch.softmax(x, dim=axis)

def _gelu(x):
    return torch.nn.functional.gelu(x, approximate='tanh')

def _silu(x):
    return torch.nn.functional.silu(x)

def _sigmoid(x):
    return torch.sigmoid(x)

def _layernorm(x, axis=-1, eps=1e-05):
    m = x.mean(dim=axis, keepdim=True)
    v = x.var(dim=axis, keepdim=True, unbiased=False)
    return (x - m) / torch.sqrt(v + eps)

def _scatter_add(tgt, idx, src, axis=0):
    return tgt.clone().index_add_(axis, idx, src)

def _segment_sum(src, seg, n):
    out = torch.zeros((n,) + src.shape[1:], dtype=src.dtype)
    return out.index_add_(0, seg, src)

def _pad(x, pw):
    flat = tuple((v for pair in reversed(pw) for v in pair))
    return torch.nn.functional.pad(x, flat)
kernel_name = 'sequential_preLN__ssm_conv_s4__mixer_gmlp__prompt'

def setup_inputs():

    _w = lambda a: (lambda t: t.to(torch.bfloat16) if t.is_floating_point() else t)(torch.as_tensor(a))

    def _A_setup():
        B, L, D, N = (1, 2048, 448, 256)
        A_re = -(lambda _x: torch.exp(torch.as_tensor(_x)))((lambda *s: torch.randn(*s, dtype=torch.bfloat16) * 3.2)(D, N))
        A_im = torch.pi * (lambda *s: torch.randn(*s, dtype=torch.bfloat16) * 0.05)(D, N)
        B_re = (lambda *s: torch.randn(*s, dtype=torch.bfloat16) * 0.05)(D, N)
        B_im = (lambda *s: torch.randn(*s, dtype=torch.bfloat16) * 0.05)(D, N)
        C_re = (lambda *s: torch.randn(*s, dtype=torch.bfloat16) * 0.05)(D, N)
        C_im = (lambda *s: torch.randn(*s, dtype=torch.bfloat16) * 0.05)(D, N)
        log_dt = (lambda *s: torch.randn(*s, dtype=torch.bfloat16) * 0.05)(D) * 0.5 - 4.0
        Dskip = (lambda *s: torch.randn(*s, dtype=torch.bfloat16) * 0.05)(D)
        return {'u': _w((lambda *s: torch.randn(*s, dtype=torch.bfloat16) * 0.05)(B, L, D)), 'A_re': _w(A_re), 'A_im': _w(A_im), 'B_re': _w(B_re), 'B_im': _w(B_im), 'C_re': _w(C_re), 'C_im': _w(C_im), 'log_dt': _w(log_dt), 'Dskip': _w(Dskip)}
    _A_in = _A_setup()

    def _B_setup():
        B, S, D, F = (1, 2048, 448, 1792)
        Fh = F // 2
        return {'x': _w((lambda *s: torch.randn(*s, dtype=torch.bfloat16) * 0.05)(B, S, D)), 'w_in': _w((lambda *s: torch.randn(*s, dtype=torch.bfloat16) * 0.4)(D, 2 * Fh)), 'w_sp': _w(0.01 * (lambda *s: torch.randn(*s, dtype=torch.bfloat16) * 0.4)(S, S)), 'b_sp': _w(1.0 + 0.01 * (lambda *s: torch.randn(*s, dtype=torch.bfloat16) * 0.05)(S)), 'w_out': _w((lambda *s: torch.randn(*s, dtype=torch.bfloat16) * 0.05)(Fh, D))}
    _B_in = _B_setup()
    return {'A_u': _A_in['u'], 'A_A_re': _A_in['A_re'], 'A_A_im': _A_in['A_im'], 'A_B_re': _A_in['B_re'], 'A_B_im': _A_in['B_im'], 'A_C_re': _A_in['C_re'], 'A_C_im': _A_in['C_im'], 'A_log_dt': _A_in['log_dt'], 'A_Dskip': _A_in['Dskip'], 'B_x': _B_in['x'], 'B_w_in': _B_in['w_in'], 'B_w_sp': _B_in['w_sp'], 'B_b_sp': _B_in['b_sp'], 'B_w_out': _B_in['w_out']}

def reference(A_u, A_A_re, A_A_im, A_B_re, A_B_im, A_C_re, A_C_im, A_log_dt, A_Dskip, B_x, B_w_in, B_w_sp, B_b_sp, B_w_out):

    def _A_ref(u, A_re, A_im, B_re, B_im, C_re, C_im, log_dt, Dskip):
        Bsz, L, D = u.shape
        dt = torch.exp(log_dt)[:, None]
        A = A_re + 1j * A_im
        Bc = B_re + 1j * B_im
        Cc = C_re + 1j * C_im
        logdA = dt * A
        dB = dt * Bc
        l = (lambda x, dt: x.to(dt))(torch.arange(L), A_re.dtype)
        P = torch.exp(logdA[:, :, None] * l[None, None, :])
        K = torch.einsum('dn,dnl,dn->dl', Cc, P, dB).real
        L2 = 2 * L
        Kp = _pad(K, ((0, 0), (0, L)))
        up = (lambda x, *d: x.permute(*d))(u, 0, 2, 1)
        up = _pad(up, ((0, 0), (0, 0), (0, L)))
        Kf = (lambda x, axes=(-2, -1): torch.fft.rfft2(x.float(), dim=axes))(Kp[:, None, :], axes=(-2, -1))
        Uf = (lambda x, axes=(-2, -1): torch.fft.rfft2(x.float(), dim=axes))(up[:, :, None, :], axes=(-2, -1))
        Yf = Uf * Kf[None, :, :, :]
        y = (lambda x, s, axes=(-2, -1): torch.fft.irfft2(x, s=s, dim=axes).to(torch.bfloat16))(Yf, (1, L2), axes=(-2, -1))[:, :, 0, :L]
        y = (lambda x, *d: x.permute(*d))(y, 0, 2, 1) + u * Dskip[None, None, :]
        return y

    def _B_ref(x, w_in, w_sp, b_sp, w_out):
        B, S, D = x.shape
        F = w_in.shape[-1]
        Fh = F // 2
        z = _gelu(torch.einsum('bsd,df->bsf', x, w_in))
        z1 = z[..., :Fh].clone()
        z2 = _layernorm(z[..., Fh:], axis=-1)
        g = torch.einsum('ts,bsf->btf', w_sp, z2) + b_sp[None, :, None]
        return torch.einsum('bsf,fd->bsd', z1 * g, w_out)
    x = A_u
    h = x + _A_ref(_layernorm(x, axis=-1), A_A_re, A_A_im, A_B_re, A_B_im, A_C_re, A_C_im, A_log_dt, A_Dskip)
    h2 = h + _B_ref(_layernorm(h, axis=-1), B_w_in, B_w_sp, B_b_sp, B_w_out)
    return h2
```

```asm
; @launch kernel=fz_kernel grid=(256,1,1) block=(256,1,1) lds=163840
.amdgcn_target "amdgcn-amd-amdhsa--gfx950"
.text
.globl fz_kernel
.p2align 8
.type fz_kernel,@function
fz_kernel:
    s_cmp_ge_u32 s2, 256
    s_cbranch_scc1 fz_end
    s_load_dwordx16 s[8:23], s[0:1], 0
    s_load_dwordx2 s[24:25], s[0:1], 64
    s_load_dwordx2 s[26:27], s[0:1], 128
    s_load_dwordx8 s[52:59], s[0:1], 72
    s_getpc_b64 s[28:29]
fz_pc:
    s_add_u32 s28, s28, fz_tab-fz_pc
    s_addc_u32 s29, s29, 0
    v_and_b32 v1, 63, v0
    v_lshrrev_b32 v2, 6, v0
    s_nop 0
    v_readfirstlane_b32 s4, v2
    v_and_b32 v3, 127, v0
    v_lshlrev_b32 v4, 5, v3
    s_cmp_ge_u32 s2, 224
    s_cbranch_scc1 fz_helper
    global_load_dwordx4 v[52:55], v4, s[28:29]
    global_load_dwordx4 v[56:59], v4, s[28:29] offset:16
    global_load_dwordx2 v[60:61], v4, s[28:29] offset:32
    s_lshl_b32 s30, s2, 2
    s_add_u32 s30, s30, s4
    s_lshl_b32 s48, s4, 12
    s_lshl_b32 s31, s2, 4
    s_add_u32 s48, s48, s31
    s_mul_i32 s30, s30, 1792
    v_lshlrev_b32 v5, 4, v1
    v_mov_b32 v6, 0x80000000
    v_cmp_gt_u32 vcc, 56, v1
    s_nop 1
    v_cndmask_b32 v5, v6, v5, vcc
    v_mov_b32 v7, 32768
    s_and_b32 s3, s2, 7
    s_mul_i32 s3, s3, 28
    s_lshr_b32 s5, s2, 3
    s_add_u32 s3, s3, s5
    s_lshr_b32 s5, s4, 1
    s_and_b32 s6, s4, 1
    s_lshl_b32 s7, s3, 1
    s_add_u32 s7, s7, s5
    s_lshl_b32 s31, s7, 9
    v_lshlrev_b32 v24, 2, v3
    v_add_u32 v24, s31, v24
    s_lshl_b32 s34, s3, 2
    s_waitcnt lgkmcnt(0)
    s_load_dword s32, s[22:23], s34
    global_load_dword v62, v24, s[10:11]
    global_load_dword v63, v24, s[12:13]
    global_load_dword v64, v24, s[14:15]
    global_load_dword v65, v24, s[16:17]
    global_load_dword v66, v24, s[18:19]
    global_load_dword v67, v24, s[20:21]
    s_load_dword s33, s[24:25], s34
    s_mov_b32 s40, s8
    s_mov_b32 s41, s9
    s_mov_b32 s42, 0x1c0000
    s_mov_b32 s43, 0x20000
    buffer_load_dwordx4 v[8:11], v5, s[40:43], s30 offen offset:0
    buffer_load_dwordx4 v[12:15], v5, s[40:43], s30 offen offset:896
    global_load_dword v20, v7, s[26:27] sc0 sc1
    s_mov_b32 s44, s26
    s_mov_b32 s45, s27
    s_mov_b32 s46, 0x4000
    s_mov_b32 s47, 0x20000
    s_add_u32 s60, s26, 0x100000
    s_addc_u32 s61, s27, 0
    s_mov_b32 s62, 0x1f8000
    s_mov_b32 s63, 0x20000
    v_lshrrev_b32 v21, 2, v1
    v_mul_u32_u24 v226, 28672, v21
    v_and_b32 v22, 3, v1
    v_lshl_add_u32 v226, v22, 4, v226
    s_mul_i32 s100, s6, 917504
    s_lshl_b32 s101, s7, 6
    s_add_u32 s100, s100, s101
    s_add_u32 s101, s100, 458752
    v_mov_b32 v228, -1
    v_mov_b32 v229, -1
    v_mov_b32 v230, -1
    v_mov_b32 v231, -1
    v_mul_u32_u24 v159, 7168, v0
    v_add_u32 v159, s34, v159
    v_add_u32 v158, 3584, v159
    global_load_dword v160, v159, s[8:9] offset:0
    global_load_dword v161, v159, s[8:9] offset:896
    s_and_b32 s30, s2, 7
    s_lshr_b32 s31, s2, 3
    s_mul_i32 s10, s31, 9363
    s_lshr_b32 s10, s10, 16
    s_mul_i32 s11, s10, 7
    s_sub_u32 s11, s31, s11
    s_lshr_b32 s31, s30, 1
    s_lshl_b32 s31, s31, 2
    s_add_u32 s10, s10, s31
    s_and_b32 s30, s30, 1
    s_mul_i32 s30, s30, 7
    s_add_u32 s11, s11, s30
    s_mov_b32 s12, s56
    s_mov_b32 s13, s57
    s_mov_b32 s14, 0x800000
    s_mov_b32 s15, 0x20000
    s_mov_b32 s16, s54
    s_mov_b32 s17, s55
    s_mov_b32 s18, 0x188000
    s_mov_b32 s19, 0x20000
    s_lshl_b32 s30, s2, 1
    s_lshr_b32 s31, s4, 1
    s_add_u32 s30, s30, s31
    s_mul_i32 s86, s30, 3584
    s_mul_i32 s31, s6, 896
    s_add_u32 s86, s86, s31
    s_cmp_ge_u32 s11, 7
    s_cselect_b32 s25, 7, 0
    s_sub_u32 s25, s11, s25
    s_mov_b32 s87, s25
    s_and_b32 s25, s10, 7
    s_lshl_b32 s20, s25, 12
    s_lshl_b32 s21, s10, 2
    s_add_u32 s21, s21, s4
    s_lshl_b32 s30, s21, 6
    s_lshl_b32 s21, s21, 17
    v_and_b32 v225, 15, v1
    v_lshlrev_b32 v225, 1, v225
    v_add_u32 v225, s30, v225
    s_mul_i32 s36, s5, 55968
    v_lshlrev_b32 v68, 3, v3
    v_add_u32 v68, s36, v68
    v_mov_b32 v70, 0
    v_mov_b32 v71, 0
    s_mul_i32 s37, s5, 4608
    s_add_u32 s37, s37, 154176
    s_mul_i32 s38, s5, 4608
    s_add_u32 s38, s38, 111936
    v_mov_b32 v69, s38
    ds_write_b32 v69, v70 offset:128
    v_mov_b32 v70, 0x3f80
    v_mov_b32 v71, 0x3f80
    ds_write_b64 v68, v[70:71] offset:0
    s_lshr_b32 s31, s21, 17
    s_lshl_b32 s28, s11, 18
    s_lshl_b32 s29, s31, 12
    s_add_u32 s28, s28, s29
    s_mul_i32 s29, s31, 56
    s_lshl_b32 s30, s11, 1
    s_add_u32 s29, s29, s30
    s_lshl_b32 s29, s29, 10
    s_add_u32 s29, s29, 3670016
    s_mul_i32 s35, s31, 3584
    s_lshl_b32 s30, s11, 8
    s_add_u32 s35, s35, s30
    s_add_u32 s35, s35, 1835008
    s_mov_b32 s24, s29
    s_waitcnt lgkmcnt(0)
    s_lshl_b32 s39, s5, 4
    s_lshr_b32 s32, s32, s39
    s_lshl_b32 s32, s32, 16
    s_lshl_b32 s40, s33, 16
    s_and_b32 s41, s33, 0xffff0000
    v_mov_b32 v72, 0x3fb8aa3b
    v_mul_f32 v73, s32, v72
    v_fma_f32 v74, s32, v72, -v73
    v_mov_b32 v72, 0x32a57060
    v_fma_f32 v74, s32, v72, v74
    v_exp_f32 v73, v73
    v_mul_f32 v74, 0x3f317218, v74
    v_fma_f32 v73, v73, v74, v73
    v_cvt_pk_bf16_f32 v73, v73, v73
    v_lshlrev_b32 v73, 16, v73
    s_waitcnt vmcnt(10)
    v_lshlrev_b32 v74, 16, v62
    s_waitcnt vmcnt(9)
    v_lshlrev_b32 v76, 16, v63
    v_and_b32 v75, 0xffff0000, v62
    v_and_b32 v77, 0xffff0000, v63
    v_mul_f32 v74, v73, v74
    v_mul_f32 v76, v73, v76
    v_mul_f32 v75, v73, v75
    v_mul_f32 v77, v73, v77
    v_mul_f32 v102, 0x4138aa3b, v74
    v_mul_f32 v103, 0x3fa2f983, v76
    v_mul_f32 v104, 0x4138aa3b, v75
    v_mul_f32 v105, 0x3fa2f983, v77
    v_exp_f32 v102, v102
    v_fract_f32 v103, v103
    v_exp_f32 v104, v104
    v_fract_f32 v105, v105
    v_cos_f32 v90, v103
    v_sin_f32 v91, v103
    v_cos_f32 v92, v105
    v_sin_f32 v93, v105
    v_mul_f32 v90, v102, v90
    v_mul_f32_e64 v91, -v102, v91
    v_mul_f32 v92, v104, v92
    v_mul_f32_e64 v93, -v104, v93
    v_cvt_pk_bf16_f32 v106, v90, v91
    v_cvt_pk_bf16_f32 v107, v92, v93
    ds_write_b64 v68, v[106:107] offset:1056
    v_pk_mul_f32 v[102:103], v[90:91], v[90:91] op_sel:[0,0] op_sel_hi:[1,0]
    v_pk_mul_f32 v[104:105], v[92:93], v[92:93] op_sel:[0,0] op_sel_hi:[1,0]
    v_pk_fma_f32 v[110:111], v[90:91], v[90:91], v[102:103] op_sel:[1,1,0] op_sel_hi:[0,1,1] neg_lo:[1,0,0]
    v_pk_fma_f32 v[112:113], v[92:93], v[92:93], v[104:105] op_sel:[1,1,0] op_sel_hi:[0,1,1] neg_lo:[1,0,0]
    v_cvt_pk_bf16_f32 v108, v110, v111
    v_cvt_pk_bf16_f32 v109, v112, v113
    ds_write_b64 v68, v[108:109] offset:2112
    v_pk_mul_f32 v[102:103], v[110:111], v[90:91] op_sel:[0,0] op_sel_hi:[1,0]
    v_pk_mul_f32 v[104:105], v[112:113], v[92:93] op_sel:[0,0] op_sel_hi:[1,0]
    v_pk_fma_f32 v[114:115], v[110:111], v[90:91], v[102:103] op_sel:[1,1,0] op_sel_hi:[0,1,1] neg_lo:[1,0,0]
    v_pk_fma_f32 v[116:117], v[112:113], v[92:93], v[104:105] op_sel:[1,1,0] op_sel_hi:[0,1,1] neg_lo:[1,0,0]
    v_cvt_pk_bf16_f32 v106, v114, v115
    v_cvt_pk_bf16_f32 v107, v116, v117
    ds_write_b64 v68, v[106:107] offset:3168
    v_pk_mul_f32 v[102:103], v[114:115], v[90:91] op_sel:[0,0] op_sel_hi:[1,0]
    v_pk_mul_f32 v[104:105], v[116:117], v[92:93] op_sel:[0,0] op_sel_hi:[1,0]
    v_pk_fma_f32 v[110:111], v[114:115], v[90:91], v[102:103] op_sel:[1,1,0] op_sel_hi:[0,1,1] neg_lo:[1,0,0]
    v_pk_fma_f32 v[112:113], v[116:117], v[92:93], v[104:105] op_sel:[1,1,0] op_sel_hi:[0,1,1] neg_lo:[1,0,0]
    v_cvt_pk_bf16_f32 v108, v110, v111
    v_cvt_pk_bf16_f32 v109, v112, v113
    ds_write_b64 v68, v[108:109] offset:4224
    v_pk_mul_f32 v[102:103], v[110:111], v[90:91] op_sel:[0,0] op_sel_hi:[1,0]
    v_pk_mul_f32 v[104:105], v[112:113], v[92:93] op_sel:[0,0] op_sel_hi:[1,0]
    v_pk_fma_f32 v[114:115], v[110:111], v[90:91], v[102:103] op_sel:[1,1,0] op_sel_hi:[0,1,1] neg_lo:[1,0,0]
    v_pk_fma_f32 v[116:117], v[112:113], v[92:93], v[104:105] op_sel:[1,1,0] op_sel_hi:[0,1,1] neg_lo:[1,0,0]
    v_cvt_pk_bf16_f32 v106, v114, v115
    v_cvt_pk_bf16_f32 v107, v116, v117
    ds_write_b64 v68, v[106:107] offset:5280
    v_pk_mul_f32 v[102:103], v[114:115], v[90:91] op_sel:[0,0] op_sel_hi:[1,0]
    v_pk_mul_f32 v[104:105], v[116:117], v[92:93] op_sel:[0,0] op_sel_hi:[1,0]
    v_pk_fma_f32 v[110:111], v[114:115], v[90:91], v[102:103] op_sel:[1,1,0] op_sel_hi:[0,1,1] neg_lo:[1,0,0]
    v_pk_fma_f32 v[112:113], v[116:117], v[92:93], v[104:105] op_sel:[1,1,0] op_sel_hi:[0,1,1] neg_lo:[1,0,0]
    v_cvt_pk_bf16_f32 v108, v110, v111
    v_cvt_pk_bf16_f32 v109, v112, v113
    ds_write_b64 v68, v[108:109] offset:6336
    v_pk_mul_f32 v[102:103], v[110:111], v[90:91] op_sel:[0,0] op_sel_hi:[1,0]
    v_pk_mul_f32 v[104:105], v[112:113], v[92:93] op_sel:[0,0] op_sel_hi:[1,0]
    v_pk_fma_f32 v[114:115], v[110:111], v[90:91], v[102:103] op_sel:[1,1,0] op_sel_hi:[0,1,1] neg_lo:[1,0,0]
    v_pk_fma_f32 v[116:117], v[112:113], v[92:93], v[104:105] op_sel:[1,1,0] op_sel_hi:[0,1,1] neg_lo:[1,0,0]
    v_cvt_pk_bf16_f32 v106, v114, v115
    v_cvt_pk_bf16_f32 v107, v116, v117
    ds_write_b64 v68, v[106:107] offset:7392
    v_pk_mul_f32 v[102:103], v[114:115], v[90:91] op_sel:[0,0] op_sel_hi:[1,0]
    v_pk_mul_f32 v[104:105], v[116:117], v[92:93] op_sel:[0,0] op_sel_hi:[1,0]
    v_pk_fma_f32 v[110:111], v[114:115], v[90:91], v[102:103] op_sel:[1,1,0] op_sel_hi:[0,1,1] neg_lo:[1,0,0]
    v_pk_fma_f32 v[112:113], v[116:117], v[92:93], v[104:105] op_sel:[1,1,0] op_sel_hi:[0,1,1] neg_lo:[1,0,0]
    v_cvt_pk_bf16_f32 v108, v110, v111
    v_cvt_pk_bf16_f32 v109, v112, v113
    ds_write_b64 v68, v[108:109] offset:8448
    global_load_dword v162, v159, s[8:9] offset:1792
    v_pk_mul_f32 v[102:103], v[110:111], v[90:91] op_sel:[0,0] op_sel_hi:[1,0]
    v_pk_mul_f32 v[104:105], v[112:113], v[92:93] op_sel:[0,0] op_sel_hi:[1,0]
    v_pk_fma_f32 v[114:115], v[110:111], v[90:91], v[102:103] op_sel:[1,1,0] op_sel_hi:[0,1,1] neg_lo:[1,0,0]
    v_pk_fma_f32 v[116:117], v[112:113], v[92:93], v[104:105] op_sel:[1,1,0] op_sel_hi:[0,1,1] neg_lo:[1,0,0]
    v_cvt_pk_bf16_f32 v106, v114, v115
    v_cvt_pk_bf16_f32 v107, v116, v117
    ds_write_b64 v68, v[106:107] offset:9504
    v_pk_mul_f32 v[102:103], v[114:115], v[90:91] op_sel:[0,0] op_sel_hi:[1,0]
    v_pk_mul_f32 v[104:105], v[116:117], v[92:93] op_sel:[0,0] op_sel_hi:[1,0]
    v_pk_fma_f32 v[110:111], v[114:115], v[90:91], v[102:103] op_sel:[1,1,0] op_sel_hi:[0,1,1] neg_lo:[1,0,0]
    v_pk_fma_f32 v[112:113], v[116:117], v[92:93], v[104:105] op_sel:[1,1,0] op_sel_hi:[0,1,1] neg_lo:[1,0,0]
    v_cvt_pk_bf16_f32 v108, v110, v111
    v_cvt_pk_bf16_f32 v109, v112, v113
    ds_write_b64 v68, v[108:109] offset:10560
    v_pk_mul_f32 v[102:103], v[110:111], v[90:91] op_sel:[0,0] op_sel_hi:[1,0]
    v_pk_mul_f32 v[104:105], v[112:113], v[92:93] op_sel:[0,0] op_sel_hi:[1,0]
    v_pk_fma_f32 v[114:115], v[110:111], v[90:91], v[102:103] op_sel:[1,1,0] op_sel_hi:[0,1,1] neg_lo:[1,0,0]
    v_pk_fma_f32 v[116:117], v[112:113], v[92:93], v[104:105] op_sel:[1,1,0] op_sel_hi:[0,1,1] neg_lo:[1,0,0]
    v_cvt_pk_bf16_f32 v106, v114, v115
    v_cvt_pk_bf16_f32 v107, v116, v117
    ds_write_b64 v68, v[106:107] offset:11616
    v_pk_mul_f32 v[102:103], v[114:115], v[90:91] op_sel:[0,0] op_sel_hi:[1,0]
    v_pk_mul_f32 v[104:105], v[116:117], v[92:93] op_sel:[0,0] op_sel_hi:[1,0]
    v_pk_fma_f32 v[110:111], v[114:115], v[90:91], v[102:103] op_sel:[1,1,0] op_sel_hi:[0,1,1] neg_lo:[1,0,0]
    v_pk_fma_f32 v[112:113], v[116:117], v[92:93], v[104:105] op_sel:[1,1,0] op_sel_hi:[0,1,1] neg_lo:[1,0,0]
    v_cvt_pk_bf16_f32 v108, v110, v111
    v_cvt_pk_bf16_f32 v109, v112, v113
    ds_write_b64 v68, v[108:109] offset:12672
    v_pk_mul_f32 v[102:103], v[110:111], v[90:91] op_sel:[0,0] op_sel_hi:[1,0]
    v_pk_mul_f32 v[104:105], v[112:113], v[92:93] op_sel:[0,0] op_sel_hi:[1,0]
    v_pk_fma_f32 v[114:115], v[110:111], v[90:91], v[102:103] op_sel:[1,1,0] op_sel_hi:[0,1,1] neg_lo:[1,0,0]
    v_pk_fma_f32 v[116:117], v[112:113], v[92:93], v[104:105] op_sel:[1,1,0] op_sel_hi:[0,1,1] neg_lo:[1,0,0]
    v_cvt_pk_bf16_f32 v106, v114, v115
    v_cvt_pk_bf16_f32 v107, v116, v117
    ds_write_b64 v68, v[106:107] offset:13728
    v_pk_mul_f32 v[102:103], v[114:115], v[90:91] op_sel:[0,0] op_sel_hi:[1,0]
    v_pk_mul_f32 v[104:105], v[116:117], v[92:93] op_sel:[0,0] op_sel_hi:[1,0]
    v_pk_fma_f32 v[110:111], v[114:115], v[90:91], v[102:103] op_sel:[1,1,0] op_sel_hi:[0,1,1] neg_lo:[1,0,0]
    v_pk_fma_f32 v[112:113], v[116:117], v[92:93], v[104:105] op_sel:[1,1,0] op_sel_hi:[0,1,1] neg_lo:[1,0,0]
    v_cvt_pk_bf16_f32 v108, v110, v111
    v_cvt_pk_bf16_f32 v109, v112, v113
    ds_write_b64 v68, v[108:109] offset:14784
    v_pk_mul_f32 v[102:103], v[110:111], v[90:91] op_sel:[0,0] op_sel_hi:[1,0]
    v_pk_mul_f32 v[104:105], v[112:113], v[92:93] op_sel:[0,0] op_sel_hi:[1,0]
    v_pk_fma_f32 v[114:115], v[110:111], v[90:91], v[102:103] op_sel:[1,1,0] op_sel_hi:[0,1,1] neg_lo:[1,0,0]
    v_pk_fma_f32 v[116:117], v[112:113], v[92:93], v[104:105] op_sel:[1,1,0] op_sel_hi:[0,1,1] neg_lo:[1,0,0]
    v_cvt_pk_bf16_f32 v106, v114, v115
    v_cvt_pk_bf16_f32 v107, v116, v117
    ds_write_b64 v68, v[106:107] offset:15840
    global_load_ushort v224, v225, s[58:59]
    global_load_ushort v225, v225, s[58:59] offset:32
    v_pk_mul_f32 v[102:103], v[114:115], v[90:91] op_sel:[0,0] op_sel_hi:[1,0]
    v_pk_mul_f32 v[104:105], v[116:117], v[92:93] op_sel:[0,0] op_sel_hi:[1,0]
    v_pk_fma_f32 v[110:111], v[114:115], v[90:91], v[102:103] op_sel:[1,1,0] op_sel_hi:[0,1,1] neg_lo:[1,0,0]
    v_pk_fma_f32 v[112:113], v[116:117], v[92:93], v[104:105] op_sel:[1,1,0] op_sel_hi:[0,1,1] neg_lo:[1,0,0]
    v_cvt_pk_bf16_f32 v108, v110, v111
    v_cvt_pk_bf16_f32 v109, v112, v113
    ds_write_b64 v68, v[108:109] offset:16896
    v_pk_mul_f32 v[102:103], v[110:111], v[90:91] op_sel:[0,0] op_sel_hi:[1,0]
    v_pk_mul_f32 v[104:105], v[112:113], v[92:93] op_sel:[0,0] op_sel_hi:[1,0]
    v_pk_fma_f32 v[114:115], v[110:111], v[90:91], v[102:103] op_sel:[1,1,0] op_sel_hi:[0,1,1] neg_lo:[1,0,0]
    v_pk_fma_f32 v[116:117], v[112:113], v[92:93], v[104:105] op_sel:[1,1,0] op_sel_hi:[0,1,1] neg_lo:[1,0,0]
    v_cvt_pk_bf16_f32 v106, v114, v115
    v_cvt_pk_bf16_f32 v107, v116, v117
    ds_write_b64 v68, v[106:107] offset:17952
    v_pk_mul_f32 v[102:103], v[114:115], v[90:91] op_sel:[0,0] op_sel_hi:[1,0]
    v_pk_mul_f32 v[104:105], v[116:117], v[92:93] op_sel:[0,0] op_sel_hi:[1,0]
    v_pk_fma_f32 v[110:111], v[114:115], v[90:91], v[102:103] op_sel:[1,1,0] op_sel_hi:[0,1,1] neg_lo:[1,0,0]
    v_pk_fma_f32 v[112:113], v[116:117], v[92:93], v[104:105] op_sel:[1,1,0] op_sel_hi:[0,1,1] neg_lo:[1,0,0]
    v_cvt_pk_bf16_f32 v108, v110, v111
    v_cvt_pk_bf16_f32 v109, v112, v113
    ds_write_b64 v68, v[108:109] offset:19008
    v_pk_mul_f32 v[102:103], v[110:111], v[90:91] op_sel:[0,0] op_sel_hi:[1,0]
    v_pk_mul_f32 v[104:105], v[112:113], v[92:93] op_sel:[0,0] op_sel_hi:[1,0]
    v_pk_fma_f32 v[114:115], v[110:111], v[90:91], v[102:103] op_sel:[1,1,0] op_sel_hi:[0,1,1] neg_lo:[1,0,0]
    v_pk_fma_f32 v[116:117], v[112:113], v[92:93], v[104:105] op_sel:[1,1,0] op_sel_hi:[0,1,1] neg_lo:[1,0,0]
    v_cvt_pk_bf16_f32 v106, v114, v115
    v_cvt_pk_bf16_f32 v107, v116, v117
    ds_write_b64 v68, v[106:107] offset:20064
    global_load_dword v163, v159, s[8:9] offset:2688
    v_pk_mul_f32 v[102:103], v[114:115], v[90:91] op_sel:[0,0] op_sel_hi:[1,0]
    v_pk_mul_f32 v[104:105], v[116:117], v[92:93] op_sel:[0,0] op_sel_hi:[1,0]
    v_pk_fma_f32 v[110:111], v[114:115], v[90:91], v[102:103] op_sel:[1,1,0] op_sel_hi:[0,1,1] neg_lo:[1,0,0]
    v_pk_fma_f32 v[112:113], v[116:117], v[92:93], v[104:105] op_sel:[1,1,0] op_sel_hi:[0,1,1] neg_lo:[1,0,0]
    v_cvt_pk_bf16_f32 v108, v110, v111
    v_cvt_pk_bf16_f32 v109, v112, v113
    ds_write_b64 v68, v[108:109] offset:21120
    v_pk_mul_f32 v[102:103], v[110:111], v[90:91] op_sel:[0,0] op_sel_hi:[1,0]
    v_pk_mul_f32 v[104:105], v[112:113], v[92:93] op_sel:[0,0] op_sel_hi:[1,0]
    v_pk_fma_f32 v[114:115], v[110:111], v[90:91], v[102:103] op_sel:[1,1,0] op_sel_hi:[0,1,1] neg_lo:[1,0,0]
    v_pk_fma_f32 v[116:117], v[112:113], v[92:93], v[104:105] op_sel:[1,1,0] op_sel_hi:[0,1,1] neg_lo:[1,0,0]
    v_cvt_pk_bf16_f32 v106, v114, v115
    v_cvt_pk_bf16_f32 v107, v116, v117
    ds_write_b64 v68, v[106:107] offset:22176
    v_pk_mul_f32 v[102:103], v[114:115], v[90:91] op_sel:[0,0] op_sel_hi:[1,0]
    v_pk_mul_f32 v[104:105], v[116:117], v[92:93] op_sel:[0,0] op_sel_hi:[1,0]
    v_pk_fma_f32 v[110:111], v[114:115], v[90:91], v[102:103] op_sel:[1,1,0] op_sel_hi:[0,1,1] neg_lo:[1,0,0]
    v_pk_fma_f32 v[112:113], v[116:117], v[92:93], v[104:105] op_sel:[1,1,0] op_sel_hi:[0,1,1] neg_lo:[1,0,0]
    v_cvt_pk_bf16_f32 v108, v110, v111
    v_cvt_pk_bf16_f32 v109, v112, v113
    ds_write_b64 v68, v[108:109] offset:23232
    s_mov_b32 s49, 0x3f803f80
    s_waitcnt vmcnt(8)
    v_dot2_f32_bf16 v16, v8, s49, 0
    v_dot2_f32_bf16 v16, v9, s49, v16
    v_dot2_f32_bf16 v16, v10, s49, v16
    v_dot2_f32_bf16 v16, v11, s49, v16
    v_dot2_f32_bf16 v18, v8, v8, 0
    v_dot2_f32_bf16 v18, v9, v9, v18
    v_dot2_f32_bf16 v18, v10, v10, v18
    v_dot2_f32_bf16 v18, v11, v11, v18
    s_waitcnt vmcnt(7)
    v_dot2_f32_bf16 v17, v12, s49, 0
    v_dot2_f32_bf16 v17, v13, s49, v17
    v_dot2_f32_bf16 v17, v14, s49, v17
    v_dot2_f32_bf16 v17, v15, s49, v17
    v_dot2_f32_bf16 v19, v12, v12, 0
    v_dot2_f32_bf16 v19, v13, v13, v19
    v_dot2_f32_bf16 v19, v14, v14, v19
    v_dot2_f32_bf16 v19, v15, v15, v19
    v_permlane32_swap_b32 v16, v17
    s_nop 1
    v_permlane32_swap_b32 v18, v19
    v_add_f32 v16, v16, v17
    v_add_f32 v18, v18, v19
    s_nop 1
    v_permlane16_swap_b32 v16, v18
    v_add_f32 v16, v16, v18
    s_nop 1
    v_add_f32_dpp v16, v16, v16 row_ror:8 row_mask:0xf bank_mask:0xf
    s_nop 1
    v_add_f32_dpp v16, v16, v16 row_ror:4 row_mask:0xf bank_mask:0xf
    s_nop 1
    v_add_f32_dpp v16, v16, v16 row_ror:2 row_mask:0xf bank_mask:0xf
    s_nop 1
    v_add_f32_dpp v16, v16, v16 row_ror:1 row_mask:0xf bank_mask:0xf
    v_mov_b32 v18, v16
    s_nop 1
    v_permlane16_swap_b32 v16, v18
    v_mul_f32 v16, 0x3b124925, v16
    v_mul_f32 v18, 0x3b124925, v18
    v_fma_f32 v18, -v16, v16, v18
    v_max_f32 v18, 0, v18
    v_cvt_pk_bf16_f32 v17, v16, v18
    v_lshlrev_b32 v16, 16, v17
    v_and_b32 v18, 0xffff0000, v17
    v_add_f32 v18, 0x3727c5ac, v18
    v_cvt_pk_bf16_f32 v18, v18, v18
    v_lshlrev_b32 v18, 16, v18
    v_sqrt_f32 v18, v18
    s_nop 0
    v_cvt_pk_bf16_f32 v18, v18, v18
    v_lshlrev_b32 v18, 16, v18
    v_cvt_pk_bf16_f32 v16, v16, v18
    s_waitcnt vmcnt(6)
    v_add_u32 v17, 1, v20
    v_lshrrev_b32 v18, 2, v1
    v_readfirstlane_b32 s50, v17
    v_lshlrev_b32 v9, 4, v1
    s_mov_b32 exec_lo, 1
    s_mov_b32 exec_hi, 1
    buffer_store_dwordx2 v[16:17], v18, s[44:47], s48 offen sc0 sc1
    s_mov_b64 exec, -1
    v_mov_b32 v51, s38
    v_add_u32_sdwa v32, v51, v52 dst_sel:DWORD dst_unused:UNUSED_PAD src0_sel:DWORD src1_sel:WORD_0
    v_add_u32_sdwa v33, v51, v52 dst_sel:DWORD dst_unused:UNUSED_PAD src0_sel:DWORD src1_sel:WORD_1
    v_add_u32_sdwa v34, v51, v53 dst_sel:DWORD dst_unused:UNUSED_PAD src0_sel:DWORD src1_sel:WORD_0
    v_add_u32_sdwa v35, v51, v53 dst_sel:DWORD dst_unused:UNUSED_PAD src0_sel:DWORD src1_sel:WORD_1
    v_add_u32_sdwa v36, v51, v54 dst_sel:DWORD dst_unused:UNUSED_PAD src0_sel:DWORD src1_sel:WORD_0
    v_add_u32_sdwa v37, v51, v54 dst_sel:DWORD dst_unused:UNUSED_PAD src0_sel:DWORD src1_sel:WORD_1
    v_add_u32_sdwa v38, v51, v55 dst_sel:DWORD dst_unused:UNUSED_PAD src0_sel:DWORD src1_sel:WORD_0
    v_add_u32_sdwa v39, v51, v55 dst_sel:DWORD dst_unused:UNUSED_PAD src0_sel:DWORD src1_sel:WORD_1
    v_add_u32_sdwa v40, v51, v56 dst_sel:DWORD dst_unused:UNUSED_PAD src0_sel:DWORD src1_sel:WORD_0
    v_add_u32_sdwa v41, v51, v56 dst_sel:DWORD dst_unused:UNUSED_PAD src0_sel:DWORD src1_sel:WORD_1
    v_add_u32_sdwa v42, v51, v57 dst_sel:DWORD dst_unused:UNUSED_PAD src0_sel:DWORD src1_sel:WORD_0
    v_add_u32_sdwa v43, v51, v57 dst_sel:DWORD dst_unused:UNUSED_PAD src0_sel:DWORD src1_sel:WORD_1
    v_add_u32_sdwa v44, v51, v58 dst_sel:DWORD dst_unused:UNUSED_PAD src0_sel:DWORD src1_sel:WORD_0
    v_add_u32_sdwa v45, v51, v58 dst_sel:DWORD dst_unused:UNUSED_PAD src0_sel:DWORD src1_sel:WORD_1
    v_add_u32_sdwa v46, v51, v59 dst_sel:DWORD dst_unused:UNUSED_PAD src0_sel:DWORD src1_sel:WORD_0
    v_add_u32_sdwa v47, v51, v59 dst_sel:DWORD dst_unused:UNUSED_PAD src0_sel:DWORD src1_sel:WORD_1
    v_add_u32_sdwa v48, v51, v60 dst_sel:DWORD dst_unused:UNUSED_PAD src0_sel:DWORD src1_sel:WORD_0
    v_add_u32_sdwa v49, v51, v60 dst_sel:DWORD dst_unused:UNUSED_PAD src0_sel:DWORD src1_sel:WORD_1
    v_add_u32_sdwa v50, v51, v61 dst_sel:DWORD dst_unused:UNUSED_PAD src0_sel:DWORD src1_sel:WORD_0
    v_pk_mul_f32 v[102:103], v[110:111], v[90:91] op_sel:[0,0] op_sel_hi:[1,0]
    v_pk_mul_f32 v[104:105], v[112:113], v[92:93] op_sel:[0,0] op_sel_hi:[1,0]
    v_pk_fma_f32 v[114:115], v[110:111], v[90:91], v[102:103] op_sel:[1,1,0] op_sel_hi:[0,1,1] neg_lo:[1,0,0]
    v_pk_fma_f32 v[116:117], v[112:113], v[92:93], v[104:105] op_sel:[1,1,0] op_sel_hi:[0,1,1] neg_lo:[1,0,0]
    v_cvt_pk_bf16_f32 v106, v114, v115
    v_cvt_pk_bf16_f32 v107, v116, v117
    ds_write_b64 v68, v[106:107] offset:24288
    v_pk_mul_f32 v[102:103], v[114:115], v[90:91] op_sel:[0,0] op_sel_hi:[1,0]
    v_pk_mul_f32 v[104:105], v[116:117], v[92:93] op_sel:[0,0] op_sel_hi:[1,0]
    v_pk_fma_f32 v[110:111], v[114:115], v[90:91], v[102:103] op_sel:[1,1,0] op_sel_hi:[0,1,1] neg_lo:[1,0,0]
    v_pk_fma_f32 v[112:113], v[116:117], v[92:93], v[104:105] op_sel:[1,1,0] op_sel_hi:[0,1,1] neg_lo:[1,0,0]
    v_cvt_pk_bf16_f32 v108, v110, v111
    v_cvt_pk_bf16_f32 v109, v112, v113
    ds_write_b64 v68, v[108:109] offset:25344
    v_pk_mul_f32 v[102:103], v[110:111], v[90:91] op_sel:[0,0] op_sel_hi:[1,0]
    v_pk_mul_f32 v[104:105], v[112:113], v[92:93] op_sel:[0,0] op_sel_hi:[1,0]
    v_pk_fma_f32 v[114:115], v[110:111], v[90:91], v[102:103] op_sel:[1,1,0] op_sel_hi:[0,1,1] neg_lo:[1,0,0]
    v_pk_fma_f32 v[116:117], v[112:113], v[92:93], v[104:105] op_sel:[1,1,0] op_sel_hi:[0,1,1] neg_lo:[1,0,0]
    v_cvt_pk_bf16_f32 v106, v114, v115
    v_cvt_pk_bf16_f32 v107, v116, v117
    ds_write_b64 v68, v[106:107] offset:26400
    v_pk_mul_f32 v[102:103], v[114:115], v[90:91] op_sel:[0,0] op_sel_hi:[1,0]
    v_pk_mul_f32 v[104:105], v[116:117], v[92:93] op_sel:[0,0] op_sel_hi:[1,0]
    v_pk_fma_f32 v[110:111], v[114:115], v[90:91], v[102:103] op_sel:[1,1,0] op_sel_hi:[0,1,1] neg_lo:[1,0,0]
    v_pk_fma_f32 v[112:113], v[116:117], v[92:93], v[104:105] op_sel:[1,1,0] op_sel_hi:[0,1,1] neg_lo:[1,0,0]
    v_cvt_pk_bf16_f32 v108, v110, v111
    v_cvt_pk_bf16_f32 v109, v112, v113
    ds_write_b64 v68, v[108:109] offset:27456
    v_pk_mul_f32 v[102:103], v[110:111], v[90:91] op_sel:[0,0] op_sel_hi:[1,0]
    v_pk_mul_f32 v[104:105], v[112:113], v[92:93] op_sel:[0,0] op_sel_hi:[1,0]
    v_pk_fma_f32 v[114:115], v[110:111], v[90:91], v[102:103] op_sel:[1,1,0] op_sel_hi:[0,1,1] neg_lo:[1,0,0]
    v_pk_fma_f32 v[116:117], v[112:113], v[92:93], v[104:105] op_sel:[1,1,0] op_sel_hi:[0,1,1] neg_lo:[1,0,0]
    v_cvt_pk_bf16_f32 v106, v114, v115
    v_cvt_pk_bf16_f32 v107, v116, v117
    ds_write_b64 v68, v[106:107] offset:28512
    v_pk_mul_f32 v[102:103], v[114:115], v[90:91] op_sel:[0,0] op_sel_hi:[1,0]
    v_pk_mul_f32 v[104:105], v[116:117], v[92:93] op_sel:[0,0] op_sel_hi:[1,0]
    v_pk_fma_f32 v[110:111], v[114:115], v[90:91], v[102:103] op_sel:[1,1,0] op_sel_hi:[0,1,1] neg_lo:[1,0,0]
    v_pk_fma_f32 v[112:113], v[116:117], v[92:93], v[104:105] op_sel:[1,1,0] op_sel_hi:[0,1,1] neg_lo:[1,0,0]
    v_cvt_pk_bf16_f32 v108, v110, v111
    v_cvt_pk_bf16_f32 v109, v112, v113
    ds_write_b64 v68, v[108:109] offset:29568
    v_pk_mul_f32 v[102:103], v[110:111], v[90:91] op_sel:[0,0] op_sel_hi:[1,0]
    v_pk_mul_f32 v[104:105], v[112:113], v[92:93] op_sel:[0,0] op_sel_hi:[1,0]
    v_pk_fma_f32 v[114:115], v[110:111], v[90:91], v[102:103] op_sel:[1,1,0] op_sel_hi:[0,1,1] neg_lo:[1,0,0]
    v_pk_fma_f32 v[116:117], v[112:113], v[92:93], v[104:105] op_sel:[1,1,0] op_sel_hi:[0,1,1] neg_lo:[1,0,0]
    v_cvt_pk_bf16_f32 v106, v114, v115
    v_cvt_pk_bf16_f32 v107, v116, v117
    ds_write_b64 v68, v[106:107] offset:30624
    v_pk_mul_f32 v[102:103], v[114:115], v[90:91] op_sel:[0,0] op_sel_hi:[1,0]
    v_pk_mul_f32 v[104:105], v[116:117], v[92:93] op_sel:[0,0] op_sel_hi:[1,0]
    v_pk_fma_f32 v[110:111], v[114:115], v[90:91], v[102:103] op_sel:[1,1,0] op_sel_hi:[0,1,1] neg_lo:[1,0,0]
    v_pk_fma_f32 v[112:113], v[116:117], v[92:93], v[104:105] op_sel:[1,1,0] op_sel_hi:[0,1,1] neg_lo:[1,0,0]
    v_cvt_pk_bf16_f32 v108, v110, v111
    v_cvt_pk_bf16_f32 v109, v112, v113
    ds_write_b64 v68, v[108:109] offset:31680
    global_load_dword v164, v158, s[8:9] offset:0
    v_pk_mul_f32 v[102:103], v[110:111], v[90:91] op_sel:[0,0] op_sel_hi:[1,0]
    v_pk_mul_f32 v[104:105], v[112:113], v[92:93] op_sel:[0,0] op_sel_hi:[1,0]
    v_pk_fma_f32 v[114:115], v[110:111], v[90:91], v[102:103] op_sel:[1,1,0] op_sel_hi:[0,1,1] neg_lo:[1,0,0]
    v_pk_fma_f32 v[116:117], v[112:113], v[92:93], v[104:105] op_sel:[1,1,0] op_sel_hi:[0,1,1] neg_lo:[1,0,0]
    v_cvt_pk_bf16_f32 v106, v114, v115
    v_cvt_pk_bf16_f32 v107, v116, v117
    ds_write_b64 v68, v[106:107] offset:32736
    v_lshlrev_b32 v78, 16, v64
    v_lshlrev_b32 v79, 16, v65
    v_lshlrev_b32 v82, 16, v66
    v_lshlrev_b32 v83, 16, v67
    v_and_b32 v80, 0xffff0000, v64
    v_and_b32 v81, 0xffff0000, v65
    v_and_b32 v84, 0xffff0000, v66
    v_and_b32 v85, 0xffff0000, v67
    v_mul_f32 v78, v73, v78
    v_mul_f32 v79, v73, v79
    v_mul_f32 v80, v73, v80
    v_mul_f32 v81, v73, v81
    v_pk_mul_f32 v[102:103], v[82:83], v[78:79] op_sel:[0,0] op_sel_hi:[1,0]
    v_pk_mul_f32 v[104:105], v[84:85], v[80:81] op_sel:[0,0] op_sel_hi:[1,0]
    v_pk_fma_f32 v[120:121], v[82:83], v[78:79], v[102:103] op_sel:[1,1,0] op_sel_hi:[0,1,1] neg_lo:[1,0,0]
    v_pk_fma_f32 v[122:123], v[84:85], v[80:81], v[104:105] op_sel:[1,1,0] op_sel_hi:[0,1,1] neg_lo:[1,0,0]
    v_mul_f32 v102, 0x3fb8aa3b, v74
    v_mul_f32 v103, 0x3e22f983, v76
    v_mul_f32 v104, 0x3fb8aa3b, v75
    v_mul_f32 v105, 0x3e22f983, v77
    v_exp_f32 v102, v102
    v_fract_f32 v103, v103
    v_exp_f32 v104, v104
    v_fract_f32 v105, v105
    v_cos_f32 v86, v103
    v_sin_f32 v87, v103
    v_cos_f32 v88, v105
    v_sin_f32 v89, v105
    v_mul_f32 v86, v102, v86
    v_mul_f32 v87, v102, v87
    v_mul_f32 v88, v104, v88
    v_mul_f32 v89, v104, v89
    v_mul_f32 v102, 0x43b8aa3b, v74
    v_mul_f32 v103, 0x4222f983, v76
    v_mul_f32 v104, 0x43b8aa3b, v75
    v_mul_f32 v105, 0x4222f983, v77
    v_exp_f32 v102, v102
    v_fract_f32 v103, v103
    v_exp_f32 v104, v104
    v_fract_f32 v105, v105
    v_cos_f32 v94, v103
    v_sin_f32 v95, v103
    v_cos_f32 v96, v105
    v_sin_f32 v97, v105
    v_mul_f32 v94, v102, v94
    v_mul_f32 v95, v102, v95
    v_mul_f32 v96, v104, v96
    v_mul_f32 v97, v104, v97
    v_cvt_pk_bf16_f32 v108, v120, v121
    v_cvt_pk_bf16_f32 v109, v122, v123
    ds_write_b64 v68, v[108:109] offset:33792
    v_pk_mul_f32 v[102:103], v[120:121], v[86:87] op_sel:[0,0] op_sel_hi:[1,0]
    v_pk_mul_f32 v[104:105], v[122:123], v[88:89] op_sel:[0,0] op_sel_hi:[1,0]
    v_pk_fma_f32 v[124:125], v[120:121], v[86:87], v[102:103] op_sel:[1,1,0] op_sel_hi:[0,1,1] neg_lo:[1,0,0]
    v_pk_fma_f32 v[126:127], v[122:123], v[88:89], v[104:105] op_sel:[1,1,0] op_sel_hi:[0,1,1] neg_lo:[1,0,0]
    v_cvt_pk_bf16_f32 v106, v124, v125
    v_cvt_pk_bf16_f32 v107, v126, v127
    ds_write_b64 v68, v[106:107] offset:34848
    v_pk_mul_f32 v[102:103], v[124:125], v[86:87] op_sel:[0,0] op_sel_hi:[1,0]
    v_pk_mul_f32 v[104:105], v[126:127], v[88:89] op_sel:[0,0] op_sel_hi:[1,0]
    v_pk_fma_f32 v[128:129], v[124:125], v[86:87], v[102:103] op_sel:[1,1,0] op_sel_hi:[0,1,1] neg_lo:[1,0,0]
    v_pk_fma_f32 v[130:131], v[126:127], v[88:89], v[104:105] op_sel:[1,1,0] op_sel_hi:[0,1,1] neg_lo:[1,0,0]
    v_cvt_pk_bf16_f32 v108, v128, v129
    v_cvt_pk_bf16_f32 v109, v130, v131
    ds_write_b64 v68, v[108:109] offset:35904
    v_pk_mul_f32 v[102:103], v[128:129], v[86:87] op_sel:[0,0] op_sel_hi:[1,0]
    v_pk_mul_f32 v[104:105], v[130:131], v[88:89] op_sel:[0,0] op_sel_hi:[1,0]
    v_pk_fma_f32 v[132:133], v[128:129], v[86:87], v[102:103] op_sel:[1,1,0] op_sel_hi:[0,1,1] neg_lo:[1,0,0]
    v_pk_fma_f32 v[134:135], v[130:131], v[88:89], v[104:105] op_sel:[1,1,0] op_sel_hi:[0,1,1] neg_lo:[1,0,0]
    v_cvt_pk_bf16_f32 v106, v132, v133
    v_cvt_pk_bf16_f32 v107, v134, v135
    ds_write_b64 v68, v[106:107] offset:36960
    v_pk_mul_f32 v[102:103], v[132:133], v[86:87] op_sel:[0,0] op_sel_hi:[1,0]
    v_pk_mul_f32 v[104:105], v[134:135], v[88:89] op_sel:[0,0] op_sel_hi:[1,0]
    v_pk_fma_f32 v[136:137], v[132:133], v[86:87], v[102:103] op_sel:[1,1,0] op_sel_hi:[0,1,1] neg_lo:[1,0,0]
    v_pk_fma_f32 v[138:139], v[134:135], v[88:89], v[104:105] op_sel:[1,1,0] op_sel_hi:[0,1,1] neg_lo:[1,0,0]
    v_cvt_pk_bf16_f32 v108, v136, v137
    v_cvt_pk_bf16_f32 v109, v138, v139
    ds_write_b64 v68, v[108:109] offset:38016
    v_pk_mul_f32 v[102:103], v[136:137], v[86:87] op_sel:[0,0] op_sel_hi:[1,0]
    v_pk_mul_f32 v[104:105], v[138:139], v[88:89] op_sel:[0,0] op_sel_hi:[1,0]
    v_pk_fma_f32 v[140:141], v[136:137], v[86:87], v[102:103] op_sel:[1,1,0] op_sel_hi:[0,1,1] neg_lo:[1,0,0]
    v_pk_fma_f32 v[142:143], v[138:139], v[88:89], v[104:105] op_sel:[1,1,0] op_sel_hi:[0,1,1] neg_lo:[1,0,0]
    v_cvt_pk_bf16_f32 v106, v140, v141
    v_cvt_pk_bf16_f32 v107, v142, v143
    ds_write_b64 v68, v[106:107] offset:39072
    v_pk_mul_f32 v[102:103], v[140:141], v[86:87] op_sel:[0,0] op_sel_hi:[1,0]
    v_pk_mul_f32 v[104:105], v[142:143], v[88:89] op_sel:[0,0] op_sel_hi:[1,0]
    v_pk_fma_f32 v[144:145], v[140:141], v[86:87], v[102:103] op_sel:[1,1,0] op_sel_hi:[0,1,1] neg_lo:[1,0,0]
    v_pk_fma_f32 v[146:147], v[142:143], v[88:89], v[104:105] op_sel:[1,1,0] op_sel_hi:[0,1,1] neg_lo:[1,0,0]
    v_cvt_pk_bf16_f32 v108, v144, v145
    v_cvt_pk_bf16_f32 v109, v146, v147
    ds_write_b64 v68, v[108:109] offset:40128
    v_pk_mul_f32 v[102:103], v[144:145], v[86:87] op_sel:[0,0] op_sel_hi:[1,0]
    v_pk_mul_f32 v[104:105], v[146:147], v[88:89] op_sel:[0,0] op_sel_hi:[1,0]
    v_pk_fma_f32 v[148:149], v[144:145], v[86:87], v[102:103] op_sel:[1,1,0] op_sel_hi:[0,1,1] neg_lo:[1,0,0]
    v_pk_fma_f32 v[150:151], v[146:147], v[88:89], v[104:105] op_sel:[1,1,0] op_sel_hi:[0,1,1] neg_lo:[1,0,0]
    v_cvt_pk_bf16_f32 v106, v148, v149
    v_cvt_pk_bf16_f32 v107, v150, v151
    ds_write_b64 v68, v[106:107] offset:41184
    v_pk_mul_f32 v[102:103], v[94:95], v[94:95] op_sel:[0,0] op_sel_hi:[1,0]
    v_pk_mul_f32 v[104:105], v[96:97], v[96:97] op_sel:[0,0] op_sel_hi:[1,0]
    v_pk_fma_f32 v[98:99], v[94:95], v[94:95], v[102:103] op_sel:[1,1,0] op_sel_hi:[0,1,1] neg_lo:[1,0,0]
    v_pk_fma_f32 v[100:101], v[96:97], v[96:97], v[104:105] op_sel:[1,1,0] op_sel_hi:[0,1,1] neg_lo:[1,0,0]
    v_pk_mul_f32 v[102:103], v[120:121], v[94:95] op_sel:[0,0] op_sel_hi:[1,0]
    v_pk_mul_f32 v[104:105], v[122:123], v[96:97] op_sel:[0,0] op_sel_hi:[1,0]
    v_pk_fma_f32 v[110:111], v[120:121], v[94:95], v[102:103] op_sel:[1,1,0] op_sel_hi:[0,1,1] neg_lo:[1,0,0]
    v_pk_fma_f32 v[112:113], v[122:123], v[96:97], v[104:105] op_sel:[1,1,0] op_sel_hi:[0,1,1] neg_lo:[1,0,0]
    v_cvt_pk_bf16_f32 v108, v110, v111
    v_cvt_pk_bf16_f32 v109, v112, v113
    ds_write_b64 v68, v[108:109] offset:42240
    v_pk_mul_f32 v[102:103], v[128:129], v[94:95] op_sel:[0,0] op_sel_hi:[1,0]
    v_pk_mul_f32 v[104:105], v[130:131], v[96:97] op_sel:[0,0] op_sel_hi:[1,0]
    v_pk_fma_f32 v[114:115], v[128:129], v[94:95], v[102:103] op_sel:[1,1,0] op_sel_hi:[0,1,1] neg_lo:[1,0,0]
    v_pk_fma_f32 v[116:117], v[130:131], v[96:97], v[104:105] op_sel:[1,1,0] op_sel_hi:[0,1,1] neg_lo:[1,0,0]
    v_cvt_pk_bf16_f32 v106, v114, v115
    v_cvt_pk_bf16_f32 v107, v116, v117
    ds_write_b64 v68, v[106:107] offset:43296
    global_load_dword v165, v158, s[8:9] offset:896
    v_pk_mul_f32 v[102:103], v[136:137], v[94:95] op_sel:[0,0] op_sel_hi:[1,0]
    v_pk_mul_f32 v[104:105], v[138:139], v[96:97] op_sel:[0,0] op_sel_hi:[1,0]
    v_pk_fma_f32 v[110:111], v[136:137], v[94:95], v[102:103] op_sel:[1,1,0] op_sel_hi:[0,1,1] neg_lo:[1,0,0]
    v_pk_fma_f32 v[112:113], v[138:139], v[96:97], v[104:105] op_sel:[1,1,0] op_sel_hi:[0,1,1] neg_lo:[1,0,0]
    v_cvt_pk_bf16_f32 v108, v110, v111
    v_cvt_pk_bf16_f32 v109, v112, v113
    ds_write_b64 v68, v[108:109] offset:44352
    v_pk_mul_f32 v[102:103], v[144:145], v[94:95] op_sel:[0,0] op_sel_hi:[1,0]
    v_pk_mul_f32 v[104:105], v[146:147], v[96:97] op_sel:[0,0] op_sel_hi:[1,0]
    v_pk_fma_f32 v[114:115], v[144:145], v[94:95], v[102:103] op_sel:[1,1,0] op_sel_hi:[0,1,1] neg_lo:[1,0,0]
    v_pk_fma_f32 v[116:117], v[146:147], v[96:97], v[104:105] op_sel:[1,1,0] op_sel_hi:[0,1,1] neg_lo:[1,0,0]
    v_cvt_pk_bf16_f32 v106, v114, v115
    v_cvt_pk_bf16_f32 v107, v116, v117
    ds_write_b64 v68, v[106:107] offset:45408
    v_pk_mul_f32 v[102:103], v[120:121], v[98:99] op_sel:[0,0] op_sel_hi:[1,0]
    v_pk_mul_f32 v[104:105], v[122:123], v[100:101] op_sel:[0,0] op_sel_hi:[1,0]
    v_pk_fma_f32 v[124:125], v[120:121], v[98:99], v[102:103] op_sel:[1,1,0] op_sel_hi:[0,1,1] neg_lo:[1,0,0]
    v_pk_fma_f32 v[126:127], v[122:123], v[100:101], v[104:105] op_sel:[1,1,0] op_sel_hi:[0,1,1] neg_lo:[1,0,0]
    v_cvt_pk_bf16_f32 v108, v124, v125
    v_cvt_pk_bf16_f32 v109, v126, v127
    ds_write_b64 v68, v[108:109] offset:46464
    v_pk_mul_f32 v[102:103], v[136:137], v[98:99] op_sel:[0,0] op_sel_hi:[1,0]
    v_pk_mul_f32 v[104:105], v[138:139], v[100:101] op_sel:[0,0] op_sel_hi:[1,0]
    v_pk_fma_f32 v[128:129], v[136:137], v[98:99], v[102:103] op_sel:[1,1,0] op_sel_hi:[0,1,1] neg_lo:[1,0,0]
    v_pk_fma_f32 v[130:131], v[138:139], v[100:101], v[104:105] op_sel:[1,1,0] op_sel_hi:[0,1,1] neg_lo:[1,0,0]
    v_cvt_pk_bf16_f32 v106, v128, v129
    v_cvt_pk_bf16_f32 v107, v130, v131
    ds_write_b64 v68, v[106:107] offset:47520
    v_pk_mul_f32 v[102:103], v[124:125], v[94:95] op_sel:[0,0] op_sel_hi:[1,0]
    v_pk_mul_f32 v[104:105], v[126:127], v[96:97] op_sel:[0,0] op_sel_hi:[1,0]
    v_pk_fma_f32 v[132:133], v[124:125], v[94:95], v[102:103] op_sel:[1,1,0] op_sel_hi:[0,1,1] neg_lo:[1,0,0]
    v_pk_fma_f32 v[134:135], v[126:127], v[96:97], v[104:105] op_sel:[1,1,0] op_sel_hi:[0,1,1] neg_lo:[1,0,0]
    v_cvt_pk_bf16_f32 v108, v132, v133
    v_cvt_pk_bf16_f32 v109, v134, v135
    ds_write_b64 v68, v[108:109] offset:48576
    v_pk_mul_f32 v[102:103], v[128:129], v[94:95] op_sel:[0,0] op_sel_hi:[1,0]
    v_pk_mul_f32 v[104:105], v[130:131], v[96:97] op_sel:[0,0] op_sel_hi:[1,0]
    v_pk_fma_f32 v[140:141], v[128:129], v[94:95], v[102:103] op_sel:[1,1,0] op_sel_hi:[0,1,1] neg_lo:[1,0,0]
    v_pk_fma_f32 v[142:143], v[130:131], v[96:97], v[104:105] op_sel:[1,1,0] op_sel_hi:[0,1,1] neg_lo:[1,0,0]
    v_cvt_pk_bf16_f32 v106, v140, v141
    v_cvt_pk_bf16_f32 v107, v142, v143
    ds_write_b64 v68, v[106:107] offset:49632
    v_pk_mul_f32 v[102:103], v[124:125], v[98:99] op_sel:[0,0] op_sel_hi:[1,0]
    v_pk_mul_f32 v[104:105], v[126:127], v[100:101] op_sel:[0,0] op_sel_hi:[1,0]
    v_pk_fma_f32 v[144:145], v[124:125], v[98:99], v[102:103] op_sel:[1,1,0] op_sel_hi:[0,1,1] neg_lo:[1,0,0]
    v_pk_fma_f32 v[146:147], v[126:127], v[100:101], v[104:105] op_sel:[1,1,0] op_sel_hi:[0,1,1] neg_lo:[1,0,0]
    v_cvt_pk_bf16_f32 v108, v144, v145
    v_cvt_pk_bf16_f32 v109, v146, v147
    ds_write_b64 v68, v[108:109] offset:50688
    v_pk_mul_f32 v[102:103], v[132:133], v[98:99] op_sel:[0,0] op_sel_hi:[1,0]
    v_pk_mul_f32 v[104:105], v[134:135], v[100:101] op_sel:[0,0] op_sel_hi:[1,0]
    v_pk_fma_f32 v[148:149], v[132:133], v[98:99], v[102:103] op_sel:[1,1,0] op_sel_hi:[0,1,1] neg_lo:[1,0,0]
    v_pk_fma_f32 v[150:151], v[134:135], v[100:101], v[104:105] op_sel:[1,1,0] op_sel_hi:[0,1,1] neg_lo:[1,0,0]
    v_cvt_pk_bf16_f32 v106, v148, v149
    v_cvt_pk_bf16_f32 v107, v150, v151
    ds_write_b64 v68, v[106:107] offset:51744
    v_pk_mul_f32 v[102:103], v[144:145], v[98:99] op_sel:[0,0] op_sel_hi:[1,0]
    v_pk_mul_f32 v[104:105], v[146:147], v[100:101] op_sel:[0,0] op_sel_hi:[1,0]
    v_pk_fma_f32 v[110:111], v[144:145], v[98:99], v[102:103] op_sel:[1,1,0] op_sel_hi:[0,1,1] neg_lo:[1,0,0]
    v_pk_fma_f32 v[112:113], v[146:147], v[100:101], v[104:105] op_sel:[1,1,0] op_sel_hi:[0,1,1] neg_lo:[1,0,0]
    v_cvt_pk_bf16_f32 v108, v110, v111
    v_cvt_pk_bf16_f32 v109, v112, v113
    ds_write_b64 v68, v[108:109] offset:52800
    v_pk_mul_f32 v[102:103], v[148:149], v[98:99] op_sel:[0,0] op_sel_hi:[1,0]
    v_pk_mul_f32 v[104:105], v[150:151], v[100:101] op_sel:[0,0] op_sel_hi:[1,0]
    v_pk_fma_f32 v[114:115], v[148:149], v[98:99], v[102:103] op_sel:[1,1,0] op_sel_hi:[0,1,1] neg_lo:[1,0,0]
    v_pk_fma_f32 v[116:117], v[150:151], v[100:101], v[104:105] op_sel:[1,1,0] op_sel_hi:[0,1,1] neg_lo:[1,0,0]
    v_cvt_pk_bf16_f32 v106, v114, v115
    v_cvt_pk_bf16_f32 v107, v116, v117
    ds_write_b64 v68, v[106:107] offset:53856
    v_pk_mul_f32 v[102:103], v[110:111], v[98:99] op_sel:[0,0] op_sel_hi:[1,0]
    v_pk_mul_f32 v[104:105], v[112:113], v[100:101] op_sel:[0,0] op_sel_hi:[1,0]
    v_pk_fma_f32 v[120:121], v[110:111], v[98:99], v[102:103] op_sel:[1,1,0] op_sel_hi:[0,1,1] neg_lo:[1,0,0]
    v_pk_fma_f32 v[122:123], v[112:113], v[100:101], v[104:105] op_sel:[1,1,0] op_sel_hi:[0,1,1] neg_lo:[1,0,0]
    v_cvt_pk_bf16_f32 v108, v120, v121
    v_cvt_pk_bf16_f32 v109, v122, v123
    ds_write_b64 v68, v[108:109] offset:54912
    global_load_dword v166, v158, s[8:9] offset:1792
    v_and_b32 v2, 15, v1
    v_lshrrev_b32 v4, 4, v1
    v_mul_u32_u24 v69, 1056, v2
    v_lshl_add_u32 v69, v4, 4, v69
    v_add_u32 v69, s36, v69
    s_mul_i32 s42, s6, 16896
    v_add_u32 v70, s42, v69
    v_lshlrev_b32 v6, 4, v0
    s_movk_i32 s51, 0x1000
    s_movk_i32 s52, 0x2000
    s_movk_i32 s53, 0x3000
    s_waitcnt lgkmcnt(0)
    s_barrier
    ds_read_b128 v[72:75], v70 offset:0
    ds_read_b128 v[76:79], v69 offset:33792
    ds_read_b128 v[80:83], v69 offset:50688
    ds_read_b128 v[84:87], v70 offset:64
    ds_read_b128 v[88:91], v69 offset:33856
    ds_read_b128 v[92:95], v69 offset:50752
    ds_read_b128 v[96:99], v70 offset:128
    ds_read_b128 v[100:103], v69 offset:33920
    ds_read_b128 v[104:107], v69 offset:50816
    ds_read_b128 v[108:111], v70 offset:192
    ds_read_b128 v[112:115], v69 offset:33984
    ds_read_b128 v[116:119], v69 offset:50880
    s_waitcnt lgkmcnt(10)
    v_mfma_f32_16x16x32_bf16 v[120:123], v[76:79], v[72:75], 0
    s_waitcnt lgkmcnt(9)
    v_mfma_f32_16x16x32_bf16 v[124:127], v[80:83], v[72:75], 0
    ds_read_b128 v[72:75], v70 offset:256
    ds_read_b128 v[76:79], v69 offset:34048
    ds_read_b128 v[80:83], v69 offset:50944
    s_waitcnt lgkmcnt(10)
    v_mfma_f32_16x16x32_bf16 v[120:123], v[88:91], v[84:87], v[120:123]
    s_waitcnt lgkmcnt(9)
    v_mfma_f32_16x16x32_bf16 v[124:127], v[92:95], v[84:87], v[124:127]
    ds_read_b128 v[84:87], v70 offset:320
    ds_read_b128 v[88:91], v69 offset:34112
    ds_read_b128 v[92:95], v69 offset:51008
    s_waitcnt lgkmcnt(10)
    v_mfma_f32_16x16x32_bf16 v[120:123], v[100:103], v[96:99], v[120:123]
    s_waitcnt lgkmcnt(9)
    v_mfma_f32_16x16x32_bf16 v[124:127], v[104:107], v[96:99], v[124:127]
    global_load_dword v167, v158, s[8:9] offset:2688
    ds_read_b128 v[96:99], v70 offset:384
    ds_read_b128 v[100:103], v69 offset:34176
    ds_read_b128 v[104:107], v69 offset:51072
    s_waitcnt lgkmcnt(10)
    v_mfma_f32_16x16x32_bf16 v[120:123], v[112:115], v[108:111], v[120:123]
    s_waitcnt lgkmcnt(9)
    v_mfma_f32_16x16x32_bf16 v[124:127], v[116:119], v[108:111], v[124:127]
    ds_read_b128 v[108:111], v70 offset:448
    ds_read_b128 v[112:115], v69 offset:34240
    ds_read_b128 v[116:119], v69 offset:51136
    s_waitcnt lgkmcnt(10)
    v_mfma_f32_16x16x32_bf16 v[120:123], v[76:79], v[72:75], v[120:123]
    s_waitcnt lgkmcnt(9)
    v_mfma_f32_16x16x32_bf16 v[124:127], v[80:83], v[72:75], v[124:127]
    ds_read_b128 v[72:75], v70 offset:512
    ds_read_b128 v[76:79], v69 offset:34304
    ds_read_b128 v[80:83], v69 offset:51200
    s_waitcnt lgkmcnt(10)
    v_mfma_f32_16x16x32_bf16 v[120:123], v[88:91], v[84:87], v[120:123]
    s_waitcnt lgkmcnt(9)
    v_mfma_f32_16x16x32_bf16 v[124:127], v[92:95], v[84:87], v[124:127]
    ds_read_b128 v[84:87], v70 offset:576
    ds_read_b128 v[88:91], v69 offset:34368
    ds_read_b128 v[92:95], v69 offset:51264
    s_waitcnt lgkmcnt(10)
    v_mfma_f32_16x16x32_bf16 v[120:123], v[100:103], v[96:99], v[120:123]
    s_waitcnt lgkmcnt(9)
    v_mfma_f32_16x16x32_bf16 v[124:127], v[104:107], v[96:99], v[124:127]
    ds_read_b128 v[96:99], v70 offset:640
    ds_read_b128 v[100:103], v69 offset:34432
    ds_read_b128 v[104:107], v69 offset:51328
    s_waitcnt lgkmcnt(10)
    v_mfma_f32_16x16x32_bf16 v[120:123], v[112:115], v[108:111], v[120:123]
    s_waitcnt lgkmcnt(9)
    v_mfma_f32_16x16x32_bf16 v[124:127], v[116:119], v[108:111], v[124:127]
    ds_read_b128 v[108:111], v70 offset:704
    ds_read_b128 v[112:115], v69 offset:34496
    ds_read_b128 v[116:119], v69 offset:51392
    s_waitcnt lgkmcnt(10)
    v_mfma_f32_16x16x32_bf16 v[120:123], v[76:79], v[72:75], v[120:123]
    s_waitcnt lgkmcnt(9)
    v_mfma_f32_16x16x32_bf16 v[124:127], v[80:83], v[72:75], v[124:127]
    ds_read_b128 v[72:75], v70 offset:768
    ds_read_b128 v[76:79], v69 offset:34560
    ds_read_b128 v[80:83], v69 offset:51456
    s_waitcnt lgkmcnt(10)
    v_mfma_f32_16x16x32_bf16 v[120:123], v[88:91], v[84:87], v[120:123]
    s_waitcnt lgkmcnt(9)
    v_mfma_f32_16x16x32_bf16 v[124:127], v[92:95], v[84:87], v[124:127]
    ds_read_b128 v[84:87], v70 offset:832
    ds_read_b128 v[88:91], v69 offset:34624
    ds_read_b128 v[92:95], v69 offset:51520
    s_waitcnt lgkmcnt(10)
    v_mfma_f32_16x16x32_bf16 v[120:123], v[100:103], v[96:99], v[120:123]
    s_waitcnt lgkmcnt(9)
    v_mfma_f32_16x16x32_bf16 v[124:127], v[104:107], v[96:99], v[124:127]
    ds_read_b128 v[96:99], v70 offset:896
    ds_read_b128 v[100:103], v69 offset:34688
    ds_read_b128 v[104:107], v69 offset:51584
    s_waitcnt lgkmcnt(10)
    v_mfma_f32_16x16x32_bf16 v[120:123], v[112:115], v[108:111], v[120:123]
    s_waitcnt lgkmcnt(9)
    v_mfma_f32_16x16x32_bf16 v[124:127], v[116:119], v[108:111], v[124:127]
    ds_read_b128 v[108:111], v70 offset:960
    ds_read_b128 v[112:115], v69 offset:34752
    ds_read_b128 v[116:119], v69 offset:51648
    s_waitcnt lgkmcnt(10)
    v_mfma_f32_16x16x32_bf16 v[120:123], v[76:79], v[72:75], v[120:123]
    s_waitcnt lgkmcnt(9)
    v_mfma_f32_16x16x32_bf16 v[124:127], v[80:83], v[72:75], v[124:127]
    s_waitcnt lgkmcnt(7)
    v_mfma_f32_16x16x32_bf16 v[120:123], v[88:91], v[84:87], v[120:123]
    s_waitcnt lgkmcnt(6)
    v_mfma_f32_16x16x32_bf16 v[124:127], v[92:95], v[84:87], v[124:127]
    s_waitcnt lgkmcnt(4)
    v_mfma_f32_16x16x32_bf16 v[120:123], v[100:103], v[96:99], v[120:123]
    s_waitcnt lgkmcnt(3)
    v_mfma_f32_16x16x32_bf16 v[124:127], v[104:107], v[96:99], v[124:127]
    s_waitcnt lgkmcnt(1)
    v_mfma_f32_16x16x32_bf16 v[120:123], v[112:115], v[108:111], v[120:123]
    s_waitcnt lgkmcnt(0)
    v_mfma_f32_16x16x32_bf16 v[124:127], v[116:119], v[108:111], v[124:127]
    v_mul_u32_u24 v71, 144, v2
    v_lshl_add_u32 v71, v4, 4, v71
    s_mul_i32 s42, s6, 2304
    s_add_u32 s42, s42, s38
    v_add_u32 v71, s42, v71
    s_nop 0
    ds_write_b128 v71, v[120:123]
    s_nop 0
    ds_write_b128 v71, v[124:127] offset:64
    buffer_load_dwordx4 v[16:19], v6, s[44:47], 0 offen sc0 sc1
    buffer_load_dwordx4 v[20:23], v6, s[44:47], s51 offen sc0 sc1
    buffer_load_dwordx4 v[24:27], v6, s[44:47], s52 offen sc0 sc1
    buffer_load_dwordx4 v[28:31], v6, s[44:47], s53 offen sc0 sc1
    s_mul_i32 s84, s4, 14336
    s_mul_i32 s85, s4, 401408
    s_lshl_b32 s30, s11, 7
    s_add_u32 s85, s85, s30
    v_lshrrev_b32 v10, 3, v1
    v_mul_u32_u24 v10, 3584, v10
    v_bfe_u32 v11, v1, 4, 1
    v_lshlrev_b32 v11, 1, v11
    v_and_b32 v13, 7, v1
    v_xor_b32 v11, v11, v13
    v_lshl_add_u32 v232, v11, 4, v10
    v_xor_b32 v233, 64, v232
    v_add_u32 v233, 27648, v233
    s_waitcnt lgkmcnt(0)
    s_barrier
    ds_read_b32 v72, v32
    ds_read_b32 v73, v33
    ds_read_b32 v74, v34
    ds_read_b32 v75, v35
    ds_read_b32 v76, v36
    ds_read_b32 v77, v37
    ds_read_b32 v78, v38
    ds_read_b32 v79, v39
    ds_read_b32 v80, v40
    ds_read_b32 v81, v41
    ds_read_b32 v82, v42
    ds_read_b32 v83, v43
    ds_read_b32 v84, v44
    ds_read_b32 v85, v45
    ds_read_b32 v86, v46
    ds_read_b32 v87, v47
    ds_read_b32 v88, v48
    ds_read_b32 v89, v49
    ds_read_b32 v90, v50
    s_mul_i32 s43, s5, 16512
    s_add_u32 s43, s43, 121152
    v_lshlrev_b32 v5, 5, v3
    v_add_u32 v5, s43, v5
    v_lshrrev_b32 v6, 1, v1
    v_mul_u32_u24 v6, 4128, v6
    v_and_b32 v7, 1, v1
    v_lshl_add_u32 v6, v7, 4, v6
    v_add_u32 v6, s43, v6
    v_mov_b32 v92, 0
    v_mov_b32 v93, 0
    v_mov_b32 v94, 0
    v_mov_b32 v95, 0
    v_lshlrev_b32 v7, 2, v3
    v_add_u32 v7, s37, v7
    ds_write_b32 v7, v92
    s_mov_b64 exec, 0xff
    ds_write_b128 v6, v[92:95] offset:4096
    s_mov_b64 exec, -1
    s_waitcnt lgkmcnt(15)
    v_cvt_pk_bf16_f32 v96, v72, v73
    v_cvt_pk_bf16_f32 v97, v74, v75
    v_cvt_pk_bf16_f32 v98, v76, v77
    s_waitcnt lgkmcnt(13)
    v_cvt_pk_bf16_f32 v99, v78, v79
    s_waitcnt lgkmcnt(11)
    v_cvt_pk_bf16_f32 v100, v80, v81
    s_waitcnt lgkmcnt(9)
    v_cvt_pk_bf16_f32 v101, v82, v83
    s_waitcnt lgkmcnt(7)
    v_cvt_pk_bf16_f32 v102, v84, v85
    s_waitcnt lgkmcnt(5)
    v_cvt_pk_bf16_f32 v103, v86, v87
    ds_write_b128 v5, v[96:99] offset:0
    ds_write_b128 v5, v[100:103] offset:16
    v_cvt_pk_bf16_f32 v104, v73, v74
    v_cvt_pk_bf16_f32 v105, v75, v76
    v_cvt_pk_bf16_f32 v106, v77, v78
    v_cvt_pk_bf16_f32 v107, v79, v80
    v_cvt_pk_bf16_f32 v108, v81, v82
    v_cvt_pk_bf16_f32 v109, v83, v84
    v_cvt_pk_bf16_f32 v110, v85, v86
    s_waitcnt lgkmcnt(6)
    v_cvt_pk_bf16_f32 v111, v87, v88
    ds_write_b128 v5, v[104:107] offset:4128
    ds_write_b128 v5, v[108:111] offset:4144
    v_cvt_pk_bf16_f32 v112, v74, v75
    v_cvt_pk_bf16_f32 v113, v76, v77
    v_cvt_pk_bf16_f32 v114, v78, v79
    v_cvt_pk_bf16_f32 v115, v80, v81
    v_cvt_pk_bf16_f32 v116, v82, v83
    v_cvt_pk_bf16_f32 v117, v84, v85
    v_cvt_pk_bf16_f32 v118, v86, v87
    s_waitcnt lgkmcnt(7)
    v_cvt_pk_bf16_f32 v119, v88, v89
    ds_write_b128 v5, v[112:115] offset:8256
    ds_write_b128 v5, v[116:119] offset:8272
    v_cvt_pk_bf16_f32 v120, v75, v76
    v_cvt_pk_bf16_f32 v121, v77, v78
    v_cvt_pk_bf16_f32 v122, v79, v80
    v_cvt_pk_bf16_f32 v123, v81, v82
    v_cvt_pk_bf16_f32 v124, v83, v84
    v_cvt_pk_bf16_f32 v125, v85, v86
    v_cvt_pk_bf16_f32 v126, v87, v88
    s_waitcnt lgkmcnt(8)
    v_cvt_pk_bf16_f32 v127, v89, v90
    ds_write_b128 v5, v[120:123] offset:12384
    ds_write_b128 v5, v[124:127] offset:12400
    v_lshlrev_b32 v6, 4, v0
    s_lshl_b32 s30, s10, 13
    s_cmp_ge_u32 s11, 7
    s_cselect_b32 s31, 4096, 0
    s_add_u32 s30, s30, 393216
    s_add_u32 s30, s30, s31
    v_min_u32 v12, 27, v1
    v_lshlrev_b32 v12, 7, v12
    v_add_u32 v12, s30, v12
    s_waitcnt vmcnt(0)
    s_mov_b64 s[56:57], 0
    v_cmp_ne_u32 vcc, s50, v17
    s_or_b64 s[56:57], s[56:57], vcc
    v_cmp_ne_u32 vcc, s50, v19
    s_or_b64 s[56:57], s[56:57], vcc
    v_cmp_ne_u32 vcc, s50, v21
    s_or_b64 s[56:57], s[56:57], vcc
    v_cmp_ne_u32 vcc, s50, v23
    s_or_b64 s[56:57], s[56:57], vcc
    v_cmp_ne_u32 vcc, s50, v25
    s_or_b64 s[56:57], s[56:57], vcc
    v_cmp_ne_u32 vcc, s50, v27
    s_or_b64 s[56:57], s[56:57], vcc
    v_cmp_ne_u32 vcc, s50, v29
    s_or_b64 s[56:57], s[56:57], vcc
    v_cmp_ne_u32 vcc, s50, v31
    s_or_b64 s[56:57], s[56:57], vcc
    s_cbranch_scc1 fz_poll
fz_go:
    v_and_b32 v17, 0xffff0000, v16
    v_and_b32 v19, 0xffff0000, v18
    v_and_b32 v21, 0xffff0000, v20
    v_and_b32 v23, 0xffff0000, v22
    v_and_b32 v25, 0xffff0000, v24
    v_and_b32 v27, 0xffff0000, v26
    v_and_b32 v29, 0xffff0000, v28
    v_and_b32 v31, 0xffff0000, v30
    v_rcp_f32 v17, v17
    v_lshlrev_b32 v16, 16, v16
    v_rcp_f32 v19, v19
    v_lshlrev_b32 v18, 16, v18
    v_rcp_f32 v21, v21
    v_lshlrev_b32 v20, 16, v20
    v_rcp_f32 v23, v23
    v_lshlrev_b32 v22, 16, v22
    v_rcp_f32 v25, v25
    v_lshlrev_b32 v24, 16, v24
    v_rcp_f32 v27, v27
    v_lshlrev_b32 v26, 16, v26
    v_rcp_f32 v29, v29
    v_lshlrev_b32 v28, 16, v28
    v_rcp_f32 v31, v31
    v_lshlrev_b32 v30, 16, v30
    s_mov_b32 s52, s84
    s_mov_b32 s51, s85
    v_lshrrev_b32 v10, 3, v1
    v_and_b32 v227, 7, v1
    v_lshlrev_b32 v227, 4, v227
    v_lshl_add_u32 v227, v10, 12, v227
    s_cmp_ge_u32 s11, 7
    s_addc_u32 s30, s10, s11
    s_cmp_ge_u32 s11, 7
    s_cselect_b32 s22, 8, 0
    s_and_b32 s30, s30, 7
    s_add_u32 s30, s30, s22
    s_lshl_b32 s30, s30, 8
    s_add_u32 s22, s21, s30
    s_add_u32 s23, s22, 0x8000
    s_add_u32 s96, s26, 0xa00000
    s_addc_u32 s97, s27, 0
    s_mov_b32 s98, 0x1d00000
    s_mov_b32 s99, 0x20000
    buffer_store_dwordx4 v[228:231], v9, s[96:99], s28 offen offset:0 sc1
    v_lshlrev_b32 v152, 16, v160
    v_and_b32 v153, 0xffff0000, v160
    v_sub_f32 v154, v152, v16
    v_sub_f32 v155, v153, v16
    v_cvt_pk_bf16_f32 v155, v154, v155
    v_lshlrev_b32 v154, 16, v155
    v_and_b32 v155, 0xffff0000, v155
    v_mul_f32 v154, v154, v17
    v_mul_f32 v155, v155, v17
    v_fma_f32 v136, v154, s40, v152
    v_fma_f32 v144, v155, s41, v153
    buffer_store_dwordx4 v[228:231], v9, s[96:99], s28 offen offset:1024 sc1
    v_lshlrev_b32 v152, 16, v161
    v_and_b32 v153, 0xffff0000, v161
    v_sub_f32 v156, v152, v18
    v_sub_f32 v157, v153, v18
    v_cvt_pk_bf16_f32 v157, v156, v157
    v_lshlrev_b32 v156, 16, v157
    v_and_b32 v157, 0xffff0000, v157
    v_mul_f32 v156, v156, v19
    v_mul_f32 v157, v157, v19
    v_fma_f32 v137, v156, s40, v152
    v_fma_f32 v145, v157, s41, v153
    v_cvt_pk_bf16_f32 v128, v154, v156
    v_cvt_pk_bf16_f32 v132, v155, v157
    buffer_store_dwordx4 v[228:231], v9, s[96:99], s28 offen offset:2048 sc1
    v_lshlrev_b32 v152, 16, v162
    v_and_b32 v153, 0xffff0000, v162
    v_sub_f32 v154, v152, v20
    v_sub_f32 v155, v153, v20
    v_cvt_pk_bf16_f32 v155, v154, v155
    v_lshlrev_b32 v154, 16, v155
    v_and_b32 v155, 0xffff0000, v155
    v_mul_f32 v154, v154, v21
    v_mul_f32 v155, v155, v21
    v_fma_f32 v138, v154, s40, v152
    v_fma_f32 v146, v155, s41, v153
    buffer_store_dwordx4 v[228:231], v9, s[96:99], s28 offen offset:3072 sc1
    v_lshlrev_b32 v152, 16, v163
    v_and_b32 v153, 0xffff0000, v163
    v_sub_f32 v156, v152, v22
    v_sub_f32 v157, v153, v22
    v_cvt_pk_bf16_f32 v157, v156, v157
    v_lshlrev_b32 v156, 16, v157
    v_and_b32 v157, 0xffff0000, v157
    v_mul_f32 v156, v156, v23
    v_mul_f32 v157, v157, v23
    v_fma_f32 v139, v156, s40, v152
    v_fma_f32 v147, v157, s41, v153
    v_cvt_pk_bf16_f32 v129, v154, v156
    v_cvt_pk_bf16_f32 v133, v155, v157
    s_mov_b64 exec, 0xffff
    buffer_store_dwordx4 v[228:231], v9, s[60:63], s35 offen sc1
    s_mov_b64 exec, -1
    v_lshlrev_b32 v152, 16, v164
    v_and_b32 v153, 0xffff0000, v164
    v_sub_f32 v154, v152, v24
    v_sub_f32 v155, v153, v24
    v_cvt_pk_bf16_f32 v155, v154, v155
    v_lshlrev_b32 v154, 16, v155
    v_and_b32 v155, 0xffff0000, v155
    v_mul_f32 v154, v154, v25
    v_mul_f32 v155, v155, v25
    v_fma_f32 v140, v154, s40, v152
    v_fma_f32 v148, v155, s41, v153
    v_lshlrev_b32 v152, 16, v165
    v_and_b32 v153, 0xffff0000, v165
    v_sub_f32 v156, v152, v26
    v_sub_f32 v157, v153, v26
    v_cvt_pk_bf16_f32 v157, v156, v157
    v_lshlrev_b32 v156, 16, v157
    v_and_b32 v157, 0xffff0000, v157
    v_mul_f32 v156, v156, v27
    v_mul_f32 v157, v157, v27
    v_fma_f32 v141, v156, s40, v152
    v_fma_f32 v149, v157, s41, v153
    v_cvt_pk_bf16_f32 v130, v154, v156
    v_cvt_pk_bf16_f32 v134, v155, v157
    v_lshlrev_b32 v152, 16, v166
    v_and_b32 v153, 0xffff0000, v166
    v_sub_f32 v154, v152, v28
    v_sub_f32 v155, v153, v28
    v_cvt_pk_bf16_f32 v155, v154, v155
    v_lshlrev_b32 v154, 16, v155
    v_and_b32 v155, 0xffff0000, v155
    v_mul_f32 v154, v154, v29
    v_mul_f32 v155, v155, v29
    v_fma_f32 v142, v154, s40, v152
    v_fma_f32 v150, v155, s41, v153
    v_lshlrev_b32 v152, 16, v167
    v_and_b32 v153, 0xffff0000, v167
    v_sub_f32 v156, v152, v30
    v_sub_f32 v157, v153, v30
    v_cvt_pk_bf16_f32 v157, v156, v157
    v_lshlrev_b32 v156, 16, v157
    v_and_b32 v157, 0xffff0000, v157
    v_mul_f32 v156, v156, v31
    v_mul_f32 v157, v157, v31
    v_fma_f32 v143, v156, s40, v152
    v_fma_f32 v151, v157, s41, v153
    v_cvt_pk_bf16_f32 v131, v154, v156
    v_cvt_pk_bf16_f32 v135, v155, v157
    v_lshlrev_b32 v6, 4, v0
    v_lshlrev_b32 v7, 5, v0
    v_add_u32 v6, 154688, v6
    v_add_u32 v7, 90112, v7
    ds_write_b128 v6, v[128:131]
    ds_write_b128 v6, v[132:135] offset:4608
    ds_write_b128 v7, v[136:139] offset:0
    ds_write_b128 v7, v[140:143] offset:16
    ds_write_b128 v7, v[144:147] offset:8192
    ds_write_b128 v7, v[148:151] offset:8208
    v_and_b32 v6, 3, v2
    v_sub_u32 v6, 3, v6
    v_mul_u32_u24 v6, 4128, v6
    v_lshrrev_b32 v7, 2, v2
    v_lshlrev_b32 v7, 3, v7
    v_sub_u32 v6, v6, v7
    v_lshl_add_u32 v6, v4, 4, v6
    s_lshl_b32 s44, s6, 8
    s_sub_u32 s44, s43, s44
    s_add_u32 s44, s44, 280
    v_add_u32 v6, s44, v6
    v_add_u32 v7, 2048, v6
    v_lshlrev_b32 v5, 5, v2
    v_lshl_add_u32 v5, v4, 4, v5
    s_lshl_b32 s45, s6, 8
    s_sub_u32 s45, s37, s45
    s_add_u32 s45, s45, 288
    v_add_u32 v5, s45, v5
    v_lshlrev_b32 v8, 6, v2
    v_lshl_add_u32 v8, v4, 4, v8
    s_lshl_b32 s46, s4, 12
    s_add_u32 s46, s46, 90112
    v_add_u32 v8, s46, v8
    s_waitcnt lgkmcnt(0)
    s_barrier
    s_or_b32 s54, s2, s4
    s_cmp_lg_u32 s54, 0
    s_cbranch_scc1 fz_nonb
    v_mov_b32 v10, 32768
    v_mov_b32 v11, s50
    s_mov_b64 exec, 1
    global_store_dword v10, v11, s[26:27] sc0 sc1
    s_mov_b64 exec, -1
fz_nonb:
    ds_read2_b64 v[64:67], v7 offset0:216 offset1:217
    ds_read_b128 v[96:99], v5 offset:192
    ds_read_b128 v[100:103], v5 offset:704
    ds_read_b128 v[104:107], v5 offset:1216
    ds_read_b128 v[108:111], v5 offset:1728
    ds_read_b128 v[112:115], v5 offset:2240
    ds_read_b128 v[116:119], v5 offset:2752
    ds_read_b128 v[120:123], v5 offset:3264
    ds_read_b128 v[124:127], v5 offset:3776
    ds_read2_b64 v[68:71], v7 offset0:152 offset1:153
    ds_read2_b64 v[72:75], v7 offset0:88 offset1:89
    ds_read2_b64 v[76:79], v7 offset0:24 offset1:25
    ds_read2_b64 v[80:83], v6 offset0:216 offset1:217
    ds_read2_b64 v[84:87], v6 offset0:152 offset1:153
    ds_read2_b64 v[88:91], v6 offset0:88 offset1:89
    ds_read2_b64 v[92:95], v6 offset0:24 offset1:25
    ds_read_b128 v[48:51], v8 offset:0
    ds_read_b128 v[52:55], v8 offset:1024
    ds_read_b128 v[56:59], v8 offset:2048
    ds_read_b128 v[60:63], v8 offset:3072
    s_waitcnt lgkmcnt(15)
    v_mfma_f32_16x16x32_bf16 v[16:19], v[64:67], v[96:99], 0
    s_add_u32 m0, s52, 0
    v_mfma_f32_16x16x32_bf16 v[20:23], v[64:67], v[100:103], 0
    ds_read2_b64 v[128:131], v7 offset0:208 offset1:209
    s_add_u32 s55, s51, 1792
    v_mfma_f32_16x16x32_bf16 v[24:27], v[64:67], v[104:107], 0
    v_mfma_f32_16x16x32_bf16 v[28:31], v[64:67], v[108:111], 0
    ds_read_b128 v[160:163], v5 offset:128
    buffer_load_dwordx4 v232, s[16:19], s55 offen lds
    s_waitcnt lgkmcnt(15)
    v_mfma_f32_16x16x32_bf16 v[32:35], v[64:67], v[112:115], 0
    v_mfma_f32_16x16x32_bf16 v[36:39], v[64:67], v[116:119], 0
    ds_read_b128 v[164:167], v5 offset:640
    s_waitcnt lgkmcnt(15)
    v_mfma_f32_16x16x32_bf16 v[40:43], v[64:67], v[120:123], 0
    s_waitcnt lgkmcnt(14)
    v_mfma_f32_16x16x32_bf16 v[44:47], v[64:67], v[124:127], 0
    ds_read_b128 v[168:171], v5 offset:1152
    buffer_load_dwordx4 v233, s[16:19], s55 offen offset:1024 lds
    s_waitcnt lgkmcnt(14)
    v_mfma_f32_16x16x32_bf16 v[20:23], v[68:71], v[96:99], v[20:23]
    s_add_u32 m0, s52, 2048
    v_mfma_f32_16x16x32_bf16 v[24:27], v[68:71], v[100:103], v[24:27]
    ds_read_b128 v[172:175], v5 offset:1664
    s_add_u32 s55, s51, 59136
    v_mfma_f32_16x16x32_bf16 v[28:31], v[68:71], v[104:107], v[28:31]
    v_mfma_f32_16x16x32_bf16 v[32:35], v[68:71], v[108:111], v[32:35]
    ds_read_b128 v[176:179], v5 offset:2176
    buffer_load_dwordx4 v232, s[16:19], s55 offen lds
    v_mfma_f32_16x16x32_bf16 v[36:39], v[68:71], v[112:115], v[36:39]
    v_mfma_f32_16x16x32_bf16 v[40:43], v[68:71], v[116:119], v[40:43]
    ds_read_b128 v[180:183], v5 offset:2688
    v_mfma_f32_16x16x32_bf16 v[44:47], v[68:71], v[120:123], v[44:47]
    s_waitcnt lgkmcnt(15)
    v_mfma_f32_16x16x32_bf16 v[24:27], v[72:75], v[96:99], v[24:27]
    ds_read_b128 v[184:187], v5 offset:3200
    buffer_load_dwordx4 v233, s[16:19], s55 offen offset:1024 lds
    v_mfma_f32_16x16x32_bf16 v[28:31], v[72:75], v[100:103], v[28:31]
    s_add_u32 m0, s52, 4096
    v_mfma_f32_16x16x32_bf16 v[32:35], v[72:75], v[104:107], v[32:35]
    ds_read_b128 v[188:191], v5 offset:3712
    s_add_u32 s55, s51, 116480
    v_mfma_f32_16x16x32_bf16 v[36:39], v[72:75], v[108:111], v[36:39]
    v_mfma_f32_16x16x32_bf16 v[40:43], v[72:75], v[112:115], v[40:43]
    ds_read2_b64 v[132:135], v7 offset0:144 offset1:145
    buffer_load_dwordx4 v232, s[16:19], s55 offen lds
    v_mfma_f32_16x16x32_bf16 v[44:47], v[72:75], v[116:119], v[44:47]
    v_mfma_f32_16x16x32_bf16 v[28:31], v[76:79], v[96:99], v[28:31]
    ds_read2_b64 v[136:139], v7 offset0:80 offset1:81
    v_mfma_f32_16x16x32_bf16 v[32:35], v[76:79], v[100:103], v[32:35]
    v_mfma_f32_16x16x32_bf16 v[36:39], v[76:79], v[104:107], v[36:39]
    ds_read2_b64 v[140:143], v7 offset0:16 offset1:17
    buffer_load_dwordx4 v233, s[16:19], s55 offen offset:1024 lds
    v_mfma_f32_16x16x32_bf16 v[40:43], v[76:79], v[108:111], v[40:43]
    s_add_u32 m0, s52, 6144
    v_mfma_f32_16x16x32_bf16 v[44:47], v[76:79], v[112:115], v[44:47]
    ds_read2_b64 v[144:147], v6 offset0:208 offset1:209
    s_add_u32 s55, s51, 173824
    s_waitcnt lgkmcnt(15)
    v_mfma_f32_16x16x32_bf16 v[32:35], v[80:83], v[96:99], v[32:35]
    v_mfma_f32_16x16x32_bf16 v[36:39], v[80:83], v[100:103], v[36:39]
    ds_read2_b64 v[148:151], v6 offset0:144 offset1:145
    buffer_load_dwordx4 v232, s[16:19], s55 offen lds
    v_mfma_f32_16x16x32_bf16 v[40:43], v[80:83], v[104:107], v[40:43]
    v_mfma_f32_16x16x32_bf16 v[44:47], v[80:83], v[108:111], v[44:47]
    ds_read2_b64 v[152:155], v6 offset0:80 offset1:81
    v_mfma_f32_16x16x32_bf16 v[36:39], v[84:87], v[96:99], v[36:39]
    v_mfma_f32_16x16x32_bf16 v[40:43], v[84:87], v[100:103], v[40:43]
    ds_read2_b64 v[156:159], v6 offset0:16 offset1:17
    buffer_load_dwordx4 v233, s[16:19], s55 offen offset:1024 lds
    v_mfma_f32_16x16x32_bf16 v[44:47], v[84:87], v[104:107], v[44:47]
    s_add_u32 m0, s52, 8192
    v_mfma_f32_16x16x32_bf16 v[40:43], v[88:91], v[96:99], v[40:43]
    s_add_u32 s55, s51, 231168
    v_mfma_f32_16x16x32_bf16 v[44:47], v[88:91], v[100:103], v[44:47]
    v_mfma_f32_16x16x32_bf16 v[44:47], v[92:95], v[96:99], v[44:47]
    buffer_load_dwordx4 v232, s[16:19], s55 offen lds
    s_waitcnt lgkmcnt(14)
    v_mfma_f32_16x16x32_bf16 v[16:19], v[128:131], v[160:163], v[16:19]
    s_waitcnt lgkmcnt(13)
    v_mfma_f32_16x16x32_bf16 v[20:23], v[128:131], v[164:167], v[20:23]
    ds_read2_b64 v[64:67], v7 offset0:200 offset1:201
    s_waitcnt lgkmcnt(13)
    v_mfma_f32_16x16x32_bf16 v[24:27], v[128:131], v[168:171], v[24:27]
    s_waitcnt lgkmcnt(12)
    v_mfma_f32_16x16x32_bf16 v[28:31], v[128:131], v[172:175], v[28:31]
    ds_read_b128 v[96:99], v5 offset:64
    buffer_load_dwordx4 v233, s[16:19], s55 offen offset:1024 lds
    s_waitcnt lgkmcnt(12)
    v_mfma_f32_16x16x32_bf16 v[32:35], v[128:131], v[176:179], v[32:35]
    s_add_u32 m0, s52, 10240
    s_waitcnt lgkmcnt(11)
    v_mfma_f32_16x16x32_bf16 v[36:39], v[128:131], v[180:183], v[36:39]
    ds_read_b128 v[100:103], v5 offset:576
    s_add_u32 s55, s51, 288512
    s_waitcnt lgkmcnt(11)
    v_mfma_f32_16x16x32_bf16 v[40:43], v[128:131], v[184:187], v[40:43]
    s_waitcnt lgkmcnt(10)
    v_mfma_f32_16x16x32_bf16 v[44:47], v[128:131], v[188:191], v[44:47]
    ds_read_b128 v[104:107], v5 offset:1088
    buffer_load_dwordx4 v232, s[16:19], s55 offen lds
    s_waitcnt lgkmcnt(10)
    v_mfma_f32_16x16x32_bf16 v[20:23], v[132:135], v[160:163], v[20:23]
    v_mfma_f32_16x16x32_bf16 v[24:27], v[132:135], v[164:167], v[24:27]
    ds_read_b128 v[108:111], v5 offset:1600
    v_mfma_f32_16x16x32_bf16 v[28:31], v[132:135], v[168:171], v[28:31]
    v_mfma_f32_16x16x32_bf16 v[32:35], v[132:135], v[172:175], v[32:35]
    ds_read_b128 v[112:115], v5 offset:2112
    buffer_load_dwordx4 v233, s[16:19], s55 offen offset:1024 lds
    v_mfma_f32_16x16x32_bf16 v[36:39], v[132:135], v[176:179], v[36:39]
    s_add_u32 m0, s52, 12288
    v_mfma_f32_16x16x32_bf16 v[40:43], v[132:135], v[180:183], v[40:43]
    ds_read_b128 v[116:119], v5 offset:2624
    s_add_u32 s55, s51, 345856
    v_mfma_f32_16x16x32_bf16 v[44:47], v[132:135], v[184:187], v[44:47]
    s_waitcnt lgkmcnt(12)
    v_mfma_f32_16x16x32_bf16 v[24:27], v[136:139], v[160:163], v[24:27]
    ds_read_b128 v[120:123], v5 offset:3136
    buffer_load_dwordx4 v232, s[16:19], s55 offen lds
    v_mfma_f32_16x16x32_bf16 v[28:31], v[136:139], v[164:167], v[28:31]
    v_mfma_f32_16x16x32_bf16 v[32:35], v[136:139], v[168:171], v[32:35]
    ds_read_b128 v[124:127], v5 offset:3648
    v_mfma_f32_16x16x32_bf16 v[36:39], v[136:139], v[172:175], v[36:39]
    v_mfma_f32_16x16x32_bf16 v[40:43], v[136:139], v[176:179], v[40:43]
    ds_read2_b64 v[68:71], v7 offset0:136 offset1:137
    buffer_load_dwordx4 v233, s[16:19], s55 offen offset:1024 lds
    v_mfma_f32_16x16x32_bf16 v[44:47], v[136:139], v[180:183], v[44:47]
    s_waitcnt lgkmcnt(14)
    v_mfma_f32_16x16x32_bf16 v[28:31], v[140:143], v[160:163], v[28:31]
    ds_read2_b64 v[72:75], v7 offset0:72 offset1:73
    v_mfma_f32_16x16x32_bf16 v[32:35], v[140:143], v[164:167], v[32:35]
    v_mfma_f32_16x16x32_bf16 v[36:39], v[140:143], v[168:171], v[36:39]
    ds_read2_b64 v[76:79], v7 offset0:8 offset1:9
    v_mfma_f32_16x16x32_bf16 v[40:43], v[140:143], v[172:175], v[40:43]
    v_mfma_f32_16x16x32_bf16 v[44:47], v[140:143], v[176:179], v[44:47]
    ds_read2_b64 v[80:83], v6 offset0:200 offset1:201
    s_waitcnt lgkmcnt(15)
    v_mfma_f32_16x16x32_bf16 v[32:35], v[144:147], v[160:163], v[32:35]
    v_mfma_f32_16x16x32_bf16 v[36:39], v[144:147], v[164:167], v[36:39]
    ds_read2_b64 v[84:87], v6 offset0:136 offset1:137
    v_mfma_f32_16x16x32_bf16 v[40:43], v[144:147], v[168:171], v[40:43]
    v_mfma_f32_16x16x32_bf16 v[44:47], v[144:147], v[172:175], v[44:47]
    ds_read2_b64 v[88:91], v6 offset0:72 offset1:73
    v_mfma_f32_16x16x32_bf16 v[36:39], v[148:151], v[160:163], v[36:39]
    v_mfma_f32_16x16x32_bf16 v[40:43], v[148:151], v[164:167], v[40:43]
    ds_read2_b64 v[92:95], v6 offset0:8 offset1:9
    v_mfma_f32_16x16x32_bf16 v[44:47], v[148:151], v[168:171], v[44:47]
    s_waitcnt lgkmcnt(15)
    v_mfma_f32_16x16x32_bf16 v[40:43], v[152:155], v[160:163], v[40:43]
    v_mfma_f32_16x16x32_bf16 v[44:47], v[152:155], v[164:167], v[44:47]
    v_mfma_f32_16x16x32_bf16 v[44:47], v[156:159], v[160:163], v[44:47]
    s_waitcnt lgkmcnt(14)
    v_mfma_f32_16x16x32_bf16 v[16:19], v[64:67], v[96:99], v[16:19]
    s_waitcnt lgkmcnt(13)
    v_mfma_f32_16x16x32_bf16 v[20:23], v[64:67], v[100:103], v[20:23]
    ds_read2_b64 v[128:131], v7 offset0:192 offset1:193
    s_waitcnt lgkmcnt(13)
    v_mfma_f32_16x16x32_bf16 v[24:27], v[64:67], v[104:107], v[24:27]
    s_waitcnt lgkmcnt(12)
    v_mfma_f32_16x16x32_bf16 v[28:31], v[64:67], v[108:111], v[28:31]
    ds_read_b128 v[160:163], v5 offset:0
    s_waitcnt lgkmcnt(12)
    v_mfma_f32_16x16x32_bf16 v[32:35], v[64:67], v[112:115], v[32:35]
    s_waitcnt lgkmcnt(11)
    v_mfma_f32_16x16x32_bf16 v[36:39], v[64:67], v[116:119], v[36:39]
    ds_read_b128 v[164:167], v5 offset:512
    s_waitcnt lgkmcnt(11)
    v_mfma_f32_16x16x32_bf16 v[40:43], v[64:67], v[120:123], v[40:43]
    s_waitcnt lgkmcnt(10)
    v_mfma_f32_16x16x32_bf16 v[44:47], v[64:67], v[124:127], v[44:47]
    ds_read_b128 v[168:171], v5 offset:1024
    s_waitcnt lgkmcnt(10)
    v_mfma_f32_16x16x32_bf16 v[20:23], v[68:71], v[96:99], v[20:23]
    v_mfma_f32_16x16x32_bf16 v[24:27], v[68:71], v[100:103], v[24:27]
    ds_read_b128 v[172:175], v5 offset:1536
    v_mfma_f32_16x16x32_bf16 v[28:31], v[68:71], v[104:107], v[28:31]
    v_mfma_f32_16x16x32_bf16 v[32:35], v[68:71], v[108:111], v[32:35]
    ds_read_b128 v[176:179], v5 offset:2048
    v_mfma_f32_16x16x32_bf16 v[36:39], v[68:71], v[112:115], v[36:39]
    v_mfma_f32_16x16x32_bf16 v[40:43], v[68:71], v[116:119], v[40:43]
    ds_read_b128 v[180:183], v5 offset:2560
    v_mfma_f32_16x16x32_bf16 v[44:47], v[68:71], v[120:123], v[44:47]
    s_waitcnt lgkmcnt(12)
    v_mfma_f32_16x16x32_bf16 v[24:27], v[72:75], v[96:99], v[24:27]
    ds_read_b128 v[184:187], v5 offset:3072
    v_mfma_f32_16x16x32_bf16 v[28:31], v[72:75], v[100:103], v[28:31]
    v_mfma_f32_16x16x32_bf16 v[32:35], v[72:75], v[104:107], v[32:35]
    ds_read_b128 v[188:191], v5 offset:3584
    v_mfma_f32_16x16x32_bf16 v[36:39], v[72:75], v[108:111], v[36:39]
    v_mfma_f32_16x16x32_bf16 v[40:43], v[72:75], v[112:115], v[40:43]
    ds_read2_b64 v[132:135], v7 offset0:128 offset1:129
    v_mfma_f32_16x16x32_bf16 v[44:47], v[72:75], v[116:119], v[44:47]
    s_waitcnt lgkmcnt(14)
    v_mfma_f32_16x16x32_bf16 v[28:31], v[76:79], v[96:99], v[28:31]
    ds_read2_b64 v[136:139], v7 offset0:64 offset1:65
    v_mfma_f32_16x16x32_bf16 v[32:35], v[76:79], v[100:103], v[32:35]
    v_mfma_f32_16x16x32_bf16 v[36:39], v[76:79], v[104:107], v[36:39]
    ds_read2_b64 v[140:143], v7 offset0:0 offset1:1
    v_mfma_f32_16x16x32_bf16 v[40:43], v[76:79], v[108:111], v[40:43]
    v_mfma_f32_16x16x32_bf16 v[44:47], v[76:79], v[112:115], v[44:47]
    ds_read2_b64 v[144:147], v6 offset0:192 offset1:193
    s_waitcnt lgkmcnt(15)
    v_mfma_f32_16x16x32_bf16 v[32:35], v[80:83], v[96:99], v[32:35]
    v_mfma_f32_16x16x32_bf16 v[36:39], v[80:83], v[100:103], v[36:39]
    ds_read2_b64 v[148:151], v6 offset0:128 offset1:129
    v_mfma_f32_16x16x32_bf16 v[40:43], v[80:83], v[104:107], v[40:43]
    v_mfma_f32_16x16x32_bf16 v[44:47], v[80:83], v[108:111], v[44:47]
    ds_read2_b64 v[152:155], v6 offset0:64 offset1:65
    v_mfma_f32_16x16x32_bf16 v[36:39], v[84:87], v[96:99], v[36:39]
    v_mfma_f32_16x16x32_bf16 v[40:43], v[84:87], v[100:103], v[40:43]
    ds_read2_b64 v[156:159], v6 offset0:0 offset1:1
    v_mfma_f32_16x16x32_bf16 v[44:47], v[84:87], v[104:107], v[44:47]
    s_waitcnt lgkmcnt(15)
    v_mfma_f32_16x16x32_bf16 v[40:43], v[88:91], v[96:99], v[40:43]
    v_mfma_f32_16x16x32_bf16 v[44:47], v[88:91], v[100:103], v[44:47]
    v_mfma_f32_16x16x32_bf16 v[44:47], v[92:95], v[96:99], v[44:47]
    s_waitcnt lgkmcnt(14)
    v_mfma_f32_16x16x32_bf16 v[16:19], v[128:131], v[160:163], v[16:19]
    s_waitcnt lgkmcnt(13)
    v_mfma_f32_16x16x32_bf16 v[20:23], v[128:131], v[164:167], v[20:23]
    s_waitcnt lgkmcnt(12)
    v_mfma_f32_16x16x32_bf16 v[24:27], v[128:131], v[168:171], v[24:27]
    s_waitcnt lgkmcnt(11)
    v_mfma_f32_16x16x32_bf16 v[28:31], v[128:131], v[172:175], v[28:31]
    s_waitcnt lgkmcnt(10)
    v_mfma_f32_16x16x32_bf16 v[32:35], v[128:131], v[176:179], v[32:35]
    s_waitcnt lgkmcnt(9)
    v_mfma_f32_16x16x32_bf16 v[36:39], v[128:131], v[180:183], v[36:39]
    s_waitcnt lgkmcnt(8)
    v_mfma_f32_16x16x32_bf16 v[40:43], v[128:131], v[184:187], v[40:43]
    s_waitcnt lgkmcnt(7)
    v_mfma_f32_16x16x32_bf16 v[44:47], v[128:131], v[188:191], v[44:47]
    s_waitcnt lgkmcnt(6)
    v_mfma_f32_16x16x32_bf16 v[20:23], v[132:135], v[160:163], v[20:23]
    v_mfma_f32_16x16x32_bf16 v[24:27], v[132:135], v[164:167], v[24:27]
    v_mfma_f32_16x16x32_bf16 v[28:31], v[132:135], v[168:171], v[28:31]
    v_mfma_f32_16x16x32_bf16 v[32:35], v[132:135], v[172:175], v[32:35]
    v_mfma_f32_16x16x32_bf16 v[36:39], v[132:135], v[176:179], v[36:39]
    v_mfma_f32_16x16x32_bf16 v[40:43], v[132:135], v[180:183], v[40:43]
    v_mfma_f32_16x16x32_bf16 v[44:47], v[132:135], v[184:187], v[44:47]
    s_waitcnt lgkmcnt(5)
    v_mfma_f32_16x16x32_bf16 v[24:27], v[136:139], v[160:163], v[24:27]
    v_mfma_f32_16x16x32_bf16 v[28:31], v[136:139], v[164:167], v[28:31]
    v_mfma_f32_16x16x32_bf16 v[32:35], v[136:139], v[168:171], v[32:35]
    v_mfma_f32_16x16x32_bf16 v[36:39], v[136:139], v[172:175], v[36:39]
    v_mfma_f32_16x16x32_bf16 v[40:43], v[136:139], v[176:179], v[40:43]
    v_mfma_f32_16x16x32_bf16 v[44:47], v[136:139], v[180:183], v[44:47]
    s_waitcnt lgkmcnt(4)
    v_mfma_f32_16x16x32_bf16 v[28:31], v[140:143], v[160:163], v[28:31]
    v_mfma_f32_16x16x32_bf16 v[32:35], v[140:143], v[164:167], v[32:35]
    v_mfma_f32_16x16x32_bf16 v[36:39], v[140:143], v[168:171], v[36:39]
    v_mfma_f32_16x16x32_bf16 v[40:43], v[140:143], v[172:175], v[40:43]
    v_mfma_f32_16x16x32_bf16 v[44:47], v[140:143], v[176:179], v[44:47]
    s_waitcnt lgkmcnt(3)
    v_mfma_f32_16x16x32_bf16 v[32:35], v[144:147], v[160:163], v[32:35]
    v_mfma_f32_16x16x32_bf16 v[36:39], v[144:147], v[164:167], v[36:39]
    v_mfma_f32_16x16x32_bf16 v[40:43], v[144:147], v[168:171], v[40:43]
    v_mfma_f32_16x16x32_bf16 v[44:47], v[144:147], v[172:175], v[44:47]
    s_waitcnt lgkmcnt(2)
    v_mfma_f32_16x16x32_bf16 v[36:39], v[148:151], v[160:163], v[36:39]
    v_mfma_f32_16x16x32_bf16 v[40:43], v[148:151], v[164:167], v[40:43]
    v_mfma_f32_16x16x32_bf16 v[44:47], v[148:151], v[168:171], v[44:47]
    s_waitcnt lgkmcnt(1)
    v_mfma_f32_16x16x32_bf16 v[40:43], v[152:155], v[160:163], v[40:43]
    v_mfma_f32_16x16x32_bf16 v[44:47], v[152:155], v[164:167], v[44:47]
    s_waitcnt lgkmcnt(0)
    v_mfma_f32_16x16x32_bf16 v[44:47], v[156:159], v[160:163], v[44:47]
    v_add_u32 v10, s46, v9
    s_xor_b32 s48, s46, 0x1000
    v_add_u32 v11, s48, v9
    v_and_b32 v13, 1, v1
    v_lshrrev_b32 v14, 5, v1
    v_lshl_add_u32 v13, v13, 1, v14
    v_bfe_u32 v14, v1, 1, 4
    v_lshl_add_u32 v13, v13, 4, v14
    v_lshlrev_b32 v13, 2, v13
    s_cmp_eq_u32 s6, 0
    s_nop 7
    s_cbranch_scc1 fz_h0
    ds_write_b128 v10, v[16:19] offset:0
    ds_write_b128 v10, v[20:23] offset:1024
    ds_write_b128 v10, v[24:27] offset:2048
    ds_write_b128 v10, v[28:31] offset:3072
    v_add_f32 v32, v32, v48
    v_add_f32 v33, v33, v49
    v_add_f32 v34, v34, v50
    v_add_f32 v35, v35, v51
    v_add_f32 v36, v36, v52
    v_add_f32 v37, v37, v53
    v_add_f32 v38, v38, v54
    v_add_f32 v39, v39, v55
    v_add_f32 v40, v40, v56
    v_add_f32 v41, v41, v57
    v_add_f32 v42, v42, v58
    v_add_f32 v43, v43, v59
    v_add_f32 v44, v44, v60
    v_add_f32 v45, v45, v61
    v_add_f32 v46, v46, v62
    v_add_f32 v47, v47, v63
    s_waitcnt vmcnt(15)
    s_waitcnt lgkmcnt(0)
    s_barrier
    ds_read_b128 v[48:51], v11 offset:0
    ds_read_b128 v[52:55], v11 offset:1024
    ds_read_b128 v[56:59], v11 offset:2048
    ds_read_b128 v[60:63], v11 offset:3072
    s_waitcnt lgkmcnt(3)
    v_add_f32 v32, v32, v48
    v_add_f32 v33, v33, v49
    v_add_f32 v34, v34, v50
    v_add_f32 v35, v35, v51
    v_cvt_pk_bf16_f32 v64, v32, v33
    v_cvt_pk_bf16_f32 v65, v34, v35
    s_waitcnt lgkmcnt(2)
    v_add_f32 v36, v36, v52
    v_add_f32 v37, v37, v53
    v_add_f32 v38, v38, v54
    v_add_f32 v39, v39, v55
    v_cvt_pk_bf16_f32 v66, v36, v37
    v_cvt_pk_bf16_f32 v67, v38, v39
    s_nop 0
    v_permlane16_swap_b32 v64, v66
    v_permlane16_swap_b32 v65, v67
    ds_bpermute_b32 v72, v13, v64
    ds_bpermute_b32 v73, v13, v65
    ds_bpermute_b32 v74, v13, v66
    ds_bpermute_b32 v75, v13, v67
    s_waitcnt lgkmcnt(5)
    v_add_f32 v40, v40, v56
    v_add_f32 v41, v41, v57
    v_add_f32 v42, v42, v58
    v_add_f32 v43, v43, v59
    v_cvt_pk_bf16_f32 v68, v40, v41
    v_cvt_pk_bf16_f32 v69, v42, v43
    s_waitcnt lgkmcnt(4)
    v_add_f32 v44, v44, v60
    v_add_f32 v45, v45, v61
    v_add_f32 v46, v46, v62
    v_add_f32 v47, v47, v63
    v_cvt_pk_bf16_f32 v70, v44, v45
    v_cvt_pk_bf16_f32 v71, v46, v47
    s_nop 0
    v_permlane16_swap_b32 v68, v70
    v_permlane16_swap_b32 v69, v71
    ds_bpermute_b32 v76, v13, v68
    ds_bpermute_b32 v77, v13, v69
    ds_bpermute_b32 v78, v13, v70
    ds_bpermute_b32 v79, v13, v71
    s_waitcnt lgkmcnt(4)
    buffer_store_dwordx4 v[72:75], v226, s[60:63], s100 offen sc1
    s_waitcnt lgkmcnt(0)
    buffer_store_dwordx4 v[76:79], v226, s[60:63], s101 offen sc1
    s_branch fz_h1
fz_h0:
    ds_write_b128 v10, v[32:35] offset:0
    ds_write_b128 v10, v[36:39] offset:1024
    ds_write_b128 v10, v[40:43] offset:2048
    ds_write_b128 v10, v[44:47] offset:3072
    v_add_f32 v16, v16, v48
    v_add_f32 v17, v17, v49
    v_add_f32 v18, v18, v50
    v_add_f32 v19, v19, v51
    v_add_f32 v20, v20, v52
    v_add_f32 v21, v21, v53
    v_add_f32 v22, v22, v54
    v_add_f32 v23, v23, v55
    v_add_f32 v24, v24, v56
    v_add_f32 v25, v25, v57
    v_add_f32 v26, v26, v58
    v_add_f32 v27, v27, v59
    v_add_f32 v28, v28, v60
    v_add_f32 v29, v29, v61
    v_add_f32 v30, v30, v62
    v_add_f32 v31, v31, v63
    s_waitcnt vmcnt(15)
    s_waitcnt lgkmcnt(0)
    s_barrier
    ds_read_b128 v[48:51], v11 offset:0
    ds_read_b128 v[52:55], v11 offset:1024
    ds_read_b128 v[56:59], v11 offset:2048
    ds_read_b128 v[60:63], v11 offset:3072
    s_waitcnt lgkmcnt(3)
    v_add_f32 v16, v16, v48
    v_add_f32 v17, v17, v49
    v_add_f32 v18, v18, v50
    v_add_f32 v19, v19, v51
    v_cvt_pk_bf16_f32 v64, v16, v17
    v_cvt_pk_bf16_f32 v65, v18, v19
    s_waitcnt lgkmcnt(2)
    v_add_f32 v20, v20, v52
    v_add_f32 v21, v21, v53
    v_add_f32 v22, v22, v54
    v_add_f32 v23, v23, v55
    v_cvt_pk_bf16_f32 v66, v20, v21
    v_cvt_pk_bf16_f32 v67, v22, v23
    s_nop 0
    v_permlane16_swap_b32 v64, v66
    v_permlane16_swap_b32 v65, v67
    ds_bpermute_b32 v72, v13, v64
    ds_bpermute_b32 v73, v13, v65
    ds_bpermute_b32 v74, v13, v66
    ds_bpermute_b32 v75, v13, v67
    s_waitcnt lgkmcnt(5)
    v_add_f32 v24, v24, v56
    v_add_f32 v25, v25, v57
    v_add_f32 v26, v26, v58
    v_add_f32 v27, v27, v59
    v_cvt_pk_bf16_f32 v68, v24, v25
    v_cvt_pk_bf16_f32 v69, v26, v27
    s_waitcnt lgkmcnt(4)
    v_add_f32 v28, v28, v60
    v_add_f32 v29, v29, v61
    v_add_f32 v30, v30, v62
    v_add_f32 v31, v31, v63
    v_cvt_pk_bf16_f32 v70, v28, v29
    v_cvt_pk_bf16_f32 v71, v30, v31
    s_nop 0
    v_permlane16_swap_b32 v68, v70
    v_permlane16_swap_b32 v69, v71
    ds_bpermute_b32 v76, v13, v68
    ds_bpermute_b32 v77, v13, v69
    ds_bpermute_b32 v78, v13, v70
    ds_bpermute_b32 v79, v13, v71
    s_waitcnt lgkmcnt(4)
    buffer_store_dwordx4 v[72:75], v226, s[60:63], s100 offen sc1
    s_waitcnt lgkmcnt(0)
    buffer_store_dwordx4 v[76:79], v226, s[60:63], s101 offen sc1
fz_h1:
    v_mov_b32 v3, v4
    v_mov_b32 v255, v12
    v_lshlrev_b32 v20, 16, v224
    v_lshlrev_b32 v21, 16, v225
    s_lshl_b32 s30, s4, 12
    s_add_u32 s6, s52, 57344
    s_mul_i32 s7, s4, 10240
    s_add_u32 s7, s7, 114688
    s_lshl_b32 s5, s4, 11
    s_add_u32 s5, s5, 155648
    v_lshrrev_b32 v4, 5, v1
    v_lshlrev_b32 v4, 1, v4
    v_and_b32 v5, 3, v1
    v_xor_b32 v4, v4, v5
    v_lshlrev_b32 v4, 4, v4
    v_lshrrev_b32 v5, 2, v1
    v_lshl_add_u32 v0, v5, 6, v4
    v_add_u32 v14, s5, v0
    v_lshrrev_b32 v5, 2, v2
    v_lshl_add_u32 v5, v3, 3, v5
    v_and_b32 v7, 3, v2
    v_mul_u32_u24 v127, 136, v5
    v_lshl_add_u32 v127, v7, 3, v127
    v_add_u32 v127, s30, v127
    v_lshrrev_b32 v126, 5, v1
    v_mul_u32_u24 v126, 14208, v126
    v_add_u32 v127, v126, v127
    v_mul_u32_u24 v126, 136, v2
    v_lshl_add_u32 v126, v3, 3, v126
    v_add_u32 v126, s30, v126
    v_and_b32 v6, 1, v3
    v_lshlrev_b32 v10, 7, v5
    v_lshl_add_u32 v10, v7, 3, v10
    v_lshl_add_u32 v10, v6, 6, v10
    v_lshrrev_b32 v8, 3, v2
    v_lshl_add_u32 v16, v8, 5, v10
    v_xor_b32 v11, 0, v16
    v_xor_b32 v8, 32, v16
    v_xor_b32 v15, 64, v16
    v_xor_b32 v252, 96, v16
    v_lshlrev_b32 v5, 6, v5
    v_lshl_add_u32 v5, v7, 3, v5
    v_lshl_add_u32 v10, v6, 5, v5
    v_cmp_eq_u32 s[28:29], 1, v7
    v_cmp_eq_u32 s[30:31], 2, v7
    v_cmp_eq_u32 s[32:33], 3, v7
    v_lshrrev_b32 v7, 2, v2
    v_cmp_eq_u32 s[34:35], v3, v7
    v_lshlrev_b32 v7, 4, v3
    v_add_u32 v7, 49152, v7
    v_lshrrev_b32 v17, 5, v1
    v_lshlrev_b32 v124, 7, v17
    v_lshl_add_u32 v124, v2, 3, v124
    v_mul_u32_u24 v125, 1792, v17
    v_and_b32 v17, 31, v1
    v_lshl_add_u32 v125, v17, 3, v125
    v_add_u32 v5, s6, v10
    v_xor_b32 v6, 32, v5
    v_add_u32 v2, s7, v10
    v_xor_b32 v3, 32, v2
    v_add_u32 v12, s5, v10
    v_xor_b32 v13, 32, v12
    v_add_u32 v4, s6, v9
    v_add_u32 v23, s7, v9
    v_mov_b32 v244, v232
    v_mov_b32 v245, v233
    v_mov_b32 v120, 0x3f803f80
    v_mov_b32 v121, 0x3f803f80
    v_mov_b32 v122, 0x3f803f80
    v_mov_b32 v123, 0x3f803f80
    v_mov_b32 v240, -1
    v_mov_b32 v241, -1
    v_mov_b32 v242, -1
    v_mov_b32 v243, -1
    v_min_u32 v253, 31, v1
    v_lshlrev_b32 v253, 7, v253
    v_add_u32 v253, 540672, v253
    s_add_u32 s36, s26, 0x2c0000
    s_addc_u32 s37, s27, 0
    s_mov_b32 s38, 0x38000
    s_mov_b32 s39, 0x20000
    s_lshr_b32 s53, s21, 17
    s_mul_i32 s40, s53, 3584
    s_lshl_b32 s41, s11, 8
    s_add_u32 s41, s41, s40
    s_add_u32 s44, s26, 0xa00000
    s_addc_u32 s45, s27, 0
    s_mov_b32 s46, 0x380000
    s_mov_b32 s47, 0x20000
    s_lshl_b32 s42, s11, 18
    s_lshl_b32 s43, s4, 12
    s_add_u32 s49, s42, s43
    s_lshl_b32 s43, s53, 12
    s_add_u32 s42, s42, s43
    s_mul_i32 s53, s53, 28672
    s_load_dwordx2 s[8:9], s[0:1], 112
    s_mul_i32 s84, s10, 14
    s_add_u32 s84, s84, s11
    s_lshl_b32 s84, s84, 2
    s_add_u32 s84, s84, s4
    s_lshl_b32 s84, s84, 12
    s_add_u32 s84, s84, 0x1600000
    v_lshrrev_b32 v16, 4, v1
    v_and_b32 v17, 7, v1
    v_xor_b32 v254, v16, v17
    v_lshlrev_b32 v254, 4, v254
    v_lshrrev_b32 v17, 3, v1
    v_lshl_add_u32 v254, v17, 12, v254
    v_xor_b32 v255, 64, v254
    v_add_u32 v255, 31744, v255
    v_lshrrev_b32 v16, 4, v1
    v_bfe_u32 v17, v1, 1, 3
    v_xor_b32 v16, v16, v17
    v_lshlrev_b32 v16, 4, v16
    v_and_b32 v17, 15, v1
    v_lshl_add_u32 v16, v17, 7, v16
    v_add_u32 v16, s7, v16
    v_xor_b32 v17, 64, v16
    s_lshr_b32 s20, s20, 4
    s_cmp_ge_u32 s11, 7
    s_cselect_b32 s87, 0x800, 0
    s_add_u32 s87, s87, s21
    s_waitcnt vmcnt(0)
    s_waitcnt lgkmcnt(0)
    s_barrier
    ds_read_b64_tr_b16 v[88:89], v11 offset:0
    ds_read_b64_tr_b16 v[90:91], v11 offset:512
    ds_read_b64_tr_b16 v[92:93], v8 offset:0
    ds_read_b64_tr_b16 v[94:95], v8 offset:512
    ds_read_b64_tr_b16 v[96:97], v15 offset:0
    ds_read_b64_tr_b16 v[98:99], v15 offset:512
    ds_read_b64_tr_b16 v[100:101], v252 offset:0
    ds_read_b64_tr_b16 v[102:103], v252 offset:512
    ds_read_b64_tr_b16 v[104:105], v11 offset:4096
    ds_read_b64_tr_b16 v[106:107], v11 offset:4608
    ds_read_b64_tr_b16 v[108:109], v8 offset:4096
    ds_read_b64_tr_b16 v[110:111], v8 offset:4608
    s_waitcnt lgkmcnt(10)
    v_mfma_f32_16x16x32_bf16 v[72:75], v[88:91], v[120:123], 0
    s_add_u32 m0, s7, 0
    s_add_u32 s23, s87, s20
    s_add_u32 s22, s23, 0x0
    buffer_load_dwordx4 v254, s[12:15], s22 offen lds
    ds_read_b64_tr_b16 v[88:89], v15 offset:4096
    ds_read_b64_tr_b16 v[90:91], v15 offset:4608
    s_waitcnt lgkmcnt(10)
    v_mfma_f32_16x16x32_bf16 v[76:79], v[92:95], v[120:123], 0
    ds_read_b64_tr_b16 v[92:93], v252 offset:4096
    ds_read_b64_tr_b16 v[94:95], v252 offset:4608
    s_waitcnt lgkmcnt(10)
    v_mfma_f32_16x16x32_bf16 v[80:83], v[96:99], v[120:123], 0
    buffer_load_dwordx4 v255, s[12:15], s22 offen offset:1024 lds
    ds_read_b64_tr_b16 v[96:97], v11 offset:8192
    ds_read_b64_tr_b16 v[98:99], v11 offset:8704
    s_waitcnt lgkmcnt(10)
    v_mfma_f32_16x16x32_bf16 v[84:87], v[100:103], v[120:123], 0
    ds_read_b64_tr_b16 v[100:101], v8 offset:8192
    ds_read_b64_tr_b16 v[102:103], v8 offset:8704
    s_waitcnt lgkmcnt(10)
    v_mfma_f32_16x16x32_bf16 v[72:75], v[104:107], v[120:123], v[72:75]
    s_add_u32 m0, s7, 2048
    s_add_u32 s22, s23, 0x10000
    buffer_load_dwordx4 v254, s[12:15], s22 offen lds
    ds_read_b64_tr_b16 v[104:105], v15 offset:8192
    ds_read_b64_tr_b16 v[106:107], v15 offset:8704
    s_waitcnt lgkmcnt(10)
    v_mfma_f32_16x16x32_bf16 v[76:79], v[108:111], v[120:123], v[76:79]
    ds_read_b64_tr_b16 v[108:109], v252 offset:8192
    ds_read_b64_tr_b16 v[110:111], v252 offset:8704
    s_waitcnt lgkmcnt(10)
    v_mfma_f32_16x16x32_bf16 v[80:83], v[88:91], v[120:123], v[80:83]
    buffer_load_dwordx4 v255, s[12:15], s22 offen offset:1024 lds
    ds_read_b64_tr_b16 v[88:89], v11 offset:12288
    ds_read_b64_tr_b16 v[90:91], v11 offset:12800
    s_waitcnt lgkmcnt(10)
    v_mfma_f32_16x16x32_bf16 v[84:87], v[92:95], v[120:123], v[84:87]
    ds_read_b64_tr_b16 v[92:93], v8 offset:12288
    ds_read_b64_tr_b16 v[94:95], v8 offset:12800
    s_waitcnt lgkmcnt(10)
    v_mfma_f32_16x16x32_bf16 v[72:75], v[96:99], v[120:123], v[72:75]
    s_add_u32 m0, s7, 4096
    s_add_u32 s22, s23, 0x80
    buffer_load_dwordx4 v254, s[12:15], s22 offen lds
    ds_read_b64_tr_b16 v[96:97], v15 offset:12288
    ds_read_b64_tr_b16 v[98:99], v15 offset:12800
    s_waitcnt lgkmcnt(10)
    v_mfma_f32_16x16x32_bf16 v[76:79], v[100:103], v[120:123], v[76:79]
    ds_read_b64_tr_b16 v[100:101], v252 offset:12288
    ds_read_b64_tr_b16 v[102:103], v252 offset:12800
    s_waitcnt lgkmcnt(10)
    v_mfma_f32_16x16x32_bf16 v[80:83], v[104:107], v[120:123], v[80:83]
    buffer_load_dwordx4 v255, s[12:15], s22 offen offset:1024 lds
    ds_read_b64_tr_b16 v[104:105], v11 offset:16384
    ds_read_b64_tr_b16 v[106:107], v11 offset:16896
    s_waitcnt lgkmcnt(10)
    v_mfma_f32_16x16x32_bf16 v[84:87], v[108:111], v[120:123], v[84:87]
    ds_read_b64_tr_b16 v[108:109], v8 offset:16384
    ds_read_b64_tr_b16 v[110:111], v8 offset:16896
    s_waitcnt lgkmcnt(10)
    v_mfma_f32_16x16x32_bf16 v[72:75], v[88:91], v[120:123], v[72:75]
    s_add_u32 m0, s7, 6144
    s_add_u32 s22, s23, 0x10080
    buffer_load_dwordx4 v254, s[12:15], s22 offen lds
    ds_read_b64_tr_b16 v[88:89], v15 offset:16384
    ds_read_b64_tr_b16 v[90:91], v15 offset:16896
    s_waitcnt lgkmcnt(10)
    v_mfma_f32_16x16x32_bf16 v[76:79], v[92:95], v[120:123], v[76:79]
    ds_read_b64_tr_b16 v[92:93], v252 offset:16384
    ds_read_b64_tr_b16 v[94:95], v252 offset:16896
    s_waitcnt lgkmcnt(10)
    v_mfma_f32_16x16x32_bf16 v[80:83], v[96:99], v[120:123], v[80:83]
    buffer_load_dwordx4 v255, s[12:15], s22 offen offset:1024 lds
    ds_read_b64_tr_b16 v[96:97], v11 offset:20480
    ds_read_b64_tr_b16 v[98:99], v11 offset:20992
    s_waitcnt lgkmcnt(10)
    v_mfma_f32_16x16x32_bf16 v[84:87], v[100:103], v[120:123], v[84:87]
    ds_read_b64_tr_b16 v[100:101], v8 offset:20480
    ds_read_b64_tr_b16 v[102:103], v8 offset:20992
    s_waitcnt lgkmcnt(10)
    v_mfma_f32_16x16x32_bf16 v[72:75], v[104:107], v[120:123], v[72:75]
    s_add_u32 m0, s7, 8192
    s_add_u32 s20, s20, 0x100
    s_and_b32 s20, s20, 0x700
    s_add_u32 s23, s87, s20
    s_add_u32 s22, s23, 0x0
    buffer_load_dwordx4 v254, s[12:15], s22 offen lds
    ds_read_b64_tr_b16 v[104:105], v15 offset:20480
    ds_read_b64_tr_b16 v[106:107], v15 offset:20992
    s_waitcnt lgkmcnt(10)
    v_mfma_f32_16x16x32_bf16 v[76:79], v[108:111], v[120:123], v[76:79]
    ds_read_b64_tr_b16 v[108:109], v252 offset:20480
    ds_read_b64_tr_b16 v[110:111], v252 offset:20992
    s_waitcnt lgkmcnt(10)
    v_mfma_f32_16x16x32_bf16 v[80:83], v[88:91], v[120:123], v[80:83]
    buffer_load_dwordx4 v255, s[12:15], s22 offen offset:1024 lds
    ds_read_b64_tr_b16 v[88:89], v11 offset:24576
    ds_read_b64_tr_b16 v[90:91], v11 offset:25088
    s_waitcnt lgkmcnt(10)
    v_mfma_f32_16x16x32_bf16 v[84:87], v[92:95], v[120:123], v[84:87]
    ds_read_b64_tr_b16 v[92:93], v8 offset:24576
    ds_read_b64_tr_b16 v[94:95], v8 offset:25088
    s_waitcnt lgkmcnt(10)
    v_mfma_f32_16x16x32_bf16 v[72:75], v[96:99], v[120:123], v[72:75]
    ds_read_b64_tr_b16 v[96:97], v15 offset:24576
    ds_read_b64_tr_b16 v[98:99], v15 offset:25088
    s_waitcnt lgkmcnt(10)
    v_mfma_f32_16x16x32_bf16 v[76:79], v[100:103], v[120:123], v[76:79]
    ds_read_b64_tr_b16 v[100:101], v252 offset:24576
    ds_read_b64_tr_b16 v[102:103], v252 offset:25088
    s_waitcnt lgkmcnt(10)
    v_mfma_f32_16x16x32_bf16 v[80:83], v[104:107], v[120:123], v[80:83]
    ds_read_b64_tr_b16 v[104:105], v11 offset:28672
    ds_read_b64_tr_b16 v[106:107], v11 offset:29184
    s_waitcnt lgkmcnt(10)
    v_mfma_f32_16x16x32_bf16 v[84:87], v[108:111], v[120:123], v[84:87]
    ds_read_b64_tr_b16 v[108:109], v8 offset:28672
    ds_read_b64_tr_b16 v[110:111], v8 offset:29184
    s_waitcnt lgkmcnt(10)
    v_mfma_f32_16x16x32_bf16 v[72:75], v[88:91], v[120:123], v[72:75]
    ds_read_b64_tr_b16 v[88:89], v15 offset:28672
    ds_read_b64_tr_b16 v[90:91], v15 offset:29184
    s_waitcnt lgkmcnt(10)
    v_mfma_f32_16x16x32_bf16 v[76:79], v[92:95], v[120:123], v[76:79]
    ds_read_b64_tr_b16 v[92:93], v252 offset:28672
    ds_read_b64_tr_b16 v[94:95], v252 offset:29184
    s_waitcnt lgkmcnt(10)
    v_mfma_f32_16x16x32_bf16 v[80:83], v[96:99], v[120:123], v[80:83]
    ds_read_b64_tr_b16 v[96:97], v11 offset:32768
    ds_read_b64_tr_b16 v[98:99], v11 offset:33280
    s_waitcnt lgkmcnt(10)
    v_mfma_f32_16x16x32_bf16 v[84:87], v[100:103], v[120:123], v[84:87]
    ds_read_b64_tr_b16 v[100:101], v8 offset:32768
    ds_read_b64_tr_b16 v[102:103], v8 offset:33280
    s_waitcnt lgkmcnt(10)
    v_mfma_f32_16x16x32_bf16 v[72:75], v[104:107], v[120:123], v[72:75]
    ds_read_b64_tr_b16 v[104:105], v15 offset:32768
    ds_read_b64_tr_b16 v[106:107], v15 offset:33280
    s_waitcnt lgkmcnt(10)
    v_mfma_f32_16x16x32_bf16 v[76:79], v[108:111], v[120:123], v[76:79]
    ds_read_b64_tr_b16 v[108:109], v252 offset:32768
    ds_read_b64_tr_b16 v[110:111], v252 offset:33280
    s_waitcnt lgkmcnt(10)
    v_mfma_f32_16x16x32_bf16 v[80:83], v[88:91], v[120:123], v[80:83]
    ds_read_b64_tr_b16 v[88:89], v11 offset:36864
    ds_read_b64_tr_b16 v[90:91], v11 offset:37376
    s_waitcnt lgkmcnt(10)
    v_mfma_f32_16x16x32_bf16 v[84:87], v[92:95], v[120:123], v[84:87]
    ds_read_b64_tr_b16 v[92:93], v8 offset:36864
    ds_read_b64_tr_b16 v[94:95], v8 offset:37376
    s_waitcnt lgkmcnt(10)
    v_mfma_f32_16x16x32_bf16 v[72:75], v[96:99], v[120:123], v[72:75]
    ds_read_b64_tr_b16 v[96:97], v15 offset:36864
    ds_read_b64_tr_b16 v[98:99], v15 offset:37376
    s_waitcnt lgkmcnt(10)
    v_mfma_f32_16x16x32_bf16 v[76:79], v[100:103], v[120:123], v[76:79]
    ds_read_b64_tr_b16 v[100:101], v252 offset:36864
    ds_read_b64_tr_b16 v[102:103], v252 offset:37376
    s_waitcnt lgkmcnt(10)
    v_mfma_f32_16x16x32_bf16 v[80:83], v[104:107], v[120:123], v[80:83]
    ds_read_b64_tr_b16 v[104:105], v11 offset:40960
    ds_read_b64_tr_b16 v[106:107], v11 offset:41472
    s_waitcnt lgkmcnt(10)
    v_mfma_f32_16x16x32_bf16 v[84:87], v[108:111], v[120:123], v[84:87]
    ds_read_b64_tr_b16 v[108:109], v8 offset:40960
    ds_read_b64_tr_b16 v[110:111], v8 offset:41472
    s_waitcnt lgkmcnt(10)
    v_mfma_f32_16x16x32_bf16 v[72:75], v[88:91], v[120:123], v[72:75]
    ds_read_b64_tr_b16 v[88:89], v15 offset:40960
    ds_read_b64_tr_b16 v[90:91], v15 offset:41472
    s_waitcnt lgkmcnt(10)
    v_mfma_f32_16x16x32_bf16 v[76:79], v[92:95], v[120:123], v[76:79]
    ds_read_b64_tr_b16 v[92:93], v252 offset:40960
    ds_read_b64_tr_b16 v[94:95], v252 offset:41472
    s_waitcnt lgkmcnt(10)
    v_mfma_f32_16x16x32_bf16 v[80:83], v[96:99], v[120:123], v[80:83]
    ds_read_b64_tr_b16 v[96:97], v11 offset:45056
    ds_read_b64_tr_b16 v[98:99], v11 offset:45568
    s_waitcnt lgkmcnt(10)
    v_mfma_f32_16x16x32_bf16 v[84:87], v[100:103], v[120:123], v[84:87]
    ds_read_b64_tr_b16 v[100:101], v8 offset:45056
    ds_read_b64_tr_b16 v[102:103], v8 offset:45568
    s_waitcnt lgkmcnt(10)
    v_mfma_f32_16x16x32_bf16 v[72:75], v[104:107], v[120:123], v[72:75]
    ds_read_b64_tr_b16 v[104:105], v15 offset:45056
    ds_read_b64_tr_b16 v[106:107], v15 offset:45568
    s_waitcnt lgkmcnt(10)
    v_mfma_f32_16x16x32_bf16 v[76:79], v[108:111], v[120:123], v[76:79]
    ds_read_b64_tr_b16 v[108:109], v252 offset:45056
    ds_read_b64_tr_b16 v[110:111], v252 offset:45568
    s_waitcnt lgkmcnt(10)
    v_mfma_f32_16x16x32_bf16 v[80:83], v[88:91], v[120:123], v[80:83]
    ds_read_b64_tr_b16 v[88:89], v11 offset:49152
    ds_read_b64_tr_b16 v[90:91], v11 offset:49664
    s_waitcnt lgkmcnt(10)
    v_mfma_f32_16x16x32_bf16 v[84:87], v[92:95], v[120:123], v[84:87]
    ds_read_b64_tr_b16 v[92:93], v8 offset:49152
    ds_read_b64_tr_b16 v[94:95], v8 offset:49664
    s_waitcnt lgkmcnt(10)
    v_mfma_f32_16x16x32_bf16 v[72:75], v[96:99], v[120:123], v[72:75]
    ds_read_b64_tr_b16 v[96:97], v15 offset:49152
    ds_read_b64_tr_b16 v[98:99], v15 offset:49664
    s_waitcnt lgkmcnt(10)
    v_mfma_f32_16x16x32_bf16 v[76:79], v[100:103], v[120:123], v[76:79]
    s_add_u32 s86, s53, 0
    buffer_load_dwordx4 v[128:131], v9, s[60:63], s86 offen offset:0 sc1
    ds_read_b64_tr_b16 v[100:101], v252 offset:49152
    ds_read_b64_tr_b16 v[102:103], v252 offset:49664
    s_waitcnt lgkmcnt(10)
    v_mfma_f32_16x16x32_bf16 v[80:83], v[104:107], v[120:123], v[80:83]
    ds_read_b64_tr_b16 v[104:105], v11 offset:53248
    ds_read_b64_tr_b16 v[106:107], v11 offset:53760
    s_waitcnt lgkmcnt(10)
    v_mfma_f32_16x16x32_bf16 v[84:87], v[108:111], v[120:123], v[84:87]
    buffer_load_dwordx4 v[132:135], v9, s[60:63], s86 offen offset:1024 sc1
    ds_read_b64_tr_b16 v[108:109], v8 offset:53248
    ds_read_b64_tr_b16 v[110:111], v8 offset:53760
    s_waitcnt lgkmcnt(10)
    v_mfma_f32_16x16x32_bf16 v[72:75], v[88:91], v[120:123], v[72:75]
    ds_read_b64_tr_b16 v[88:89], v15 offset:53248
    ds_read_b64_tr_b16 v[90:91], v15 offset:53760
    s_waitcnt lgkmcnt(10)
    v_mfma_f32_16x16x32_bf16 v[76:79], v[92:95], v[120:123], v[76:79]
    buffer_load_dwordx4 v[136:139], v9, s[60:63], s86 offen offset:2048 sc1
    ds_read_b64_tr_b16 v[92:93], v252 offset:53248
    ds_read_b64_tr_b16 v[94:95], v252 offset:53760
    s_waitcnt lgkmcnt(10)
    v_mfma_f32_16x16x32_bf16 v[80:83], v[96:99], v[120:123], v[80:83]
    s_waitcnt vmcnt(11)
    ds_read_b128 a[0:3], v16 offset:0
    ds_read_b128 a[8:11], v17 offset:0
    s_waitcnt lgkmcnt(10)
    v_mfma_f32_16x16x32_bf16 v[84:87], v[100:103], v[120:123], v[84:87]
    s_waitcnt vmcnt(9)
    ds_read_b128 a[4:7], v16 offset:2048
    ds_read_b128 a[12:15], v17 offset:2048
    buffer_load_dwordx4 v[140:143], v9, s[60:63], s86 offen offset:3072 sc1
    s_waitcnt lgkmcnt(10)
    v_mfma_f32_16x16x32_bf16 v[72:75], v[104:107], v[120:123], v[72:75]
    s_waitcnt vmcnt(8)
    ds_read_b128 a[16:19], v16 offset:4096
    ds_read_b128 a[24:27], v17 offset:4096
    s_waitcnt lgkmcnt(10)
    v_mfma_f32_16x16x32_bf16 v[76:79], v[108:111], v[120:123], v[76:79]
    s_waitcnt vmcnt(6)
    ds_read_b128 a[20:23], v16 offset:6144
    ds_read_b128 a[28:31], v17 offset:6144
    s_add_u32 s86, s53, 4096
    s_add_u32 m0, s6, 0
    s_nop 0
    buffer_load_dwordx4 v0, s[60:63], s86 offen offset:0 sc1 lds
    s_waitcnt lgkmcnt(10)
    v_mfma_f32_16x16x32_bf16 v[80:83], v[88:91], v[120:123], v[80:83]
    s_waitcnt vmcnt(5)
    ds_read_b128 a[32:35], v16 offset:8192
    ds_read_b128 a[40:43], v17 offset:8192
    s_waitcnt lgkmcnt(10)
    v_mfma_f32_16x16x32_bf16 v[84:87], v[92:95], v[120:123], v[84:87]
    buffer_load_dwordx4 v0, s[60:63], s86 offen offset:1024 sc1 lds
    buffer_load_dwordx4 v0, s[60:63], s86 offen offset:2048 sc1 lds
    buffer_load_dwordx4 v0, s[60:63], s86 offen offset:3072 sc1 lds
    s_add_u32 s86, s53, 8192
    s_add_u32 m0, s6, 4096
    s_nop 0
    buffer_load_dwordx4 v0, s[60:63], s86 offen offset:0 sc1 lds
    buffer_load_dwordx4 v0, s[60:63], s86 offen offset:1024 sc1 lds
    buffer_load_dwordx4 v0, s[60:63], s86 offen offset:2048 sc1 lds
    buffer_load_dwordx4 v0, s[60:63], s86 offen offset:3072 sc1 lds
    s_add_u32 s86, s53, 12288
    s_add_u32 m0, s6, 8192
    s_nop 0
    buffer_load_dwordx4 v0, s[60:63], s86 offen offset:0 sc1 lds
    buffer_load_dwordx4 v0, s[60:63], s86 offen offset:1024 sc1 lds
    buffer_load_dwordx4 v0, s[60:63], s86 offen offset:2048 sc1 lds
    buffer_load_dwordx4 v0, s[60:63], s86 offen offset:3072 sc1 lds
    s_mov_b32 s59, 99
    s_mov_b32 s101, -1
    ds_read_b64_tr_b16 v[88:89], v11 offset:0
    ds_read_b64_tr_b16 v[90:91], v11 offset:512
    ds_read_b64_tr_b16 v[92:93], v8 offset:0
    ds_read_b64_tr_b16 v[94:95], v8 offset:512
    ds_read_b64_tr_b16 v[96:97], v15 offset:0
    ds_read_b64_tr_b16 v[98:99], v15 offset:512
    ds_read_b64_tr_b16 v[100:101], v252 offset:0
    ds_read_b64_tr_b16 v[102:103], v252 offset:512
    s_waitcnt vmcnt(14)
    v_max_u32 v10, v128, v132
    v_cmp_le_u32 vcc, s101, v10
    s_cbranch_vccnz fz_rh0
fz_bh0:
    ds_write_b128 v14, v[128:131] offset:0
    ds_write_b128 v14, v[132:135] offset:1024
    ds_read_b64_tr_b16 v[128:129], v12 offset:0
    ds_read_b64_tr_b16 v[130:131], v12 offset:256
    ds_read_b64_tr_b16 v[132:133], v13 offset:0
    ds_read_b64_tr_b16 v[134:135], v13 offset:256
    s_waitcnt vmcnt(12)
    v_max_u32 v10, v136, v140
    v_cmp_le_u32 vcc, s101, v10
    s_cbranch_vccnz fz_rh1
fz_bh1:
    ds_write_b128 v14, v[136:139] offset:0
    ds_write_b128 v14, v[140:143] offset:1024
    ds_read_b64_tr_b16 v[136:137], v12 offset:0
    ds_read_b64_tr_b16 v[138:139], v12 offset:256
    ds_read_b64_tr_b16 v[140:141], v13 offset:0
    ds_read_b64_tr_b16 v[142:143], v13 offset:256
    s_waitcnt vmcnt(10)
    ds_read2st64_b32 v[18:19], v4 offset0:0 offset1:4
    s_waitcnt lgkmcnt(9)
    v_mfma_f32_16x16x32_bf16 v[60:63], v[128:131], v[128:131], 0
    ds_read_b64_tr_b16 v[104:105], v11 offset:4096
    ds_read_b64_tr_b16 v[106:107], v11 offset:4608
    v_mfma_f32_16x16x32_bf16 v[56:59], v[120:123], v[128:131], 0
    ds_read_b64_tr_b16 v[108:109], v8 offset:4096
    ds_read_b64_tr_b16 v[110:111], v8 offset:4608
    s_waitcnt lgkmcnt(11)
    v_mfma_f32_16x16x32_bf16 v[68:71], v[132:135], v[132:135], 0
    ds_read_b64_tr_b16 v[112:113], v15 offset:4096
    ds_read_b64_tr_b16 v[114:115], v15 offset:4608
    v_mfma_f32_16x16x32_bf16 v[64:67], v[120:123], v[132:135], 0
    ds_read_b64_tr_b16 v[116:117], v252 offset:4096
    ds_read_b64_tr_b16 v[118:119], v252 offset:4608
    v_mfma_f32_16x16x32_bf16 v[24:27], v[88:91], v[128:131], 0
    s_add_u32 s86, s53, 16384
    s_add_u32 m0, s6, 12288
    s_nop 0
    buffer_load_dwordx4 v0, s[60:63], s86 offen offset:0 sc1 lds
    s_waitcnt lgkmcnt(8)
    v_max_u32 v10, v18, v19
    v_cmp_le_u32 vcc, s101, v10
    v_mfma_f32_16x16x32_bf16 v[28:31], v[88:91], v[132:135], 0
    s_cbranch_vccnz fz_rh2
fz_bh2:
    v_mfma_f32_16x16x32_bf16 v[32:35], v[92:95], v[128:131], 0
    ds_read_b64_tr_b16 v[144:145], v5 offset:0
    v_mfma_f32_16x16x32_bf16 v[36:39], v[92:95], v[132:135], 0
    ds_read_b64_tr_b16 v[146:147], v5 offset:256
    v_mfma_f32_16x16x32_bf16 v[40:43], v[96:99], v[128:131], 0
    ds_read_b64_tr_b16 v[148:149], v6 offset:0
    v_mfma_f32_16x16x32_bf16 v[44:47], v[96:99], v[132:135], 0
    buffer_load_dwordx4 v0, s[60:63], s86 offen offset:1024 sc1 lds
    ds_read_b64_tr_b16 v[150:151], v6 offset:256
    v_mfma_f32_16x16x32_bf16 v[48:51], v[100:103], v[128:131], 0
    s_waitcnt vmcnt(10)
    v_mfma_f32_16x16x32_bf16 v[52:55], v[100:103], v[132:135], 0
    ds_read2st64_b32 v[18:19], v4 offset0:8 offset1:12
    v_mfma_f32_16x16x32_bf16 v[60:63], v[136:139], v[136:139], v[60:63]
    ds_read_b64_tr_b16 v[88:89], v11 offset:8192
    ds_read_b64_tr_b16 v[90:91], v11 offset:8704
    v_mfma_f32_16x16x32_bf16 v[56:59], v[120:123], v[136:139], v[56:59]
    ds_read_b64_tr_b16 v[92:93], v8 offset:8192
    ds_read_b64_tr_b16 v[94:95], v8 offset:8704
    v_mfma_f32_16x16x32_bf16 v[68:71], v[140:143], v[140:143], v[68:71]
    ds_read_b64_tr_b16 v[96:97], v15 offset:8192
    ds_read_b64_tr_b16 v[98:99], v15 offset:8704
    v_mfma_f32_16x16x32_bf16 v[64:67], v[120:123], v[140:143], v[64:67]
    ds_read_b64_tr_b16 v[100:101], v252 offset:8192
    ds_read_b64_tr_b16 v[102:103], v252 offset:8704
    s_waitcnt lgkmcnt(15)
    v_mfma_f32_16x16x32_bf16 v[24:27], v[104:107], v[136:139], v[24:27]
    s_waitcnt lgkmcnt(8)
    v_max_u32 v10, v18, v19
    v_cmp_le_u32 vcc, s101, v10
    v_mfma_f32_16x16x32_bf16 v[28:31], v[104:107], v[140:143], v[28:31]
    s_cbranch_vccnz fz_rh3
fz_bh3:
    v_mfma_f32_16x16x32_bf16 v[32:35], v[108:111], v[136:139], v[32:35]
    ds_read_b64_tr_b16 v[152:153], v5 offset:2048
    v_mfma_f32_16x16x32_bf16 v[36:39], v[108:111], v[140:143], v[36:39]
    s_sub_u32 m0, s7, 2048
    s_nop 0
    buffer_load_dwordx4 v0, s[60:63], s86 offen offset:2048 sc1 lds
    ds_read_b64_tr_b16 v[154:155], v5 offset:2304
    v_mfma_f32_16x16x32_bf16 v[40:43], v[112:115], v[136:139], v[40:43]
    ds_read_b64_tr_b16 v[156:157], v6 offset:2048
    v_mfma_f32_16x16x32_bf16 v[44:47], v[112:115], v[140:143], v[44:47]
    ds_read_b64_tr_b16 v[158:159], v6 offset:2304
    v_mfma_f32_16x16x32_bf16 v[48:51], v[116:119], v[136:139], v[48:51]
    s_waitcnt vmcnt(9)
    v_mfma_f32_16x16x32_bf16 v[52:55], v[116:119], v[140:143], v[52:55]
    ds_read2st64_b32 v[18:19], v4 offset0:16 offset1:20
    v_mfma_f32_16x16x32_bf16 v[60:63], v[144:147], v[144:147], v[60:63]
    buffer_load_dwordx4 v0, s[60:63], s86 offen offset:3072 sc1 lds
    ds_read_b64_tr_b16 v[104:105], v11 offset:12288
    ds_read_b64_tr_b16 v[106:107], v11 offset:12800
    v_mfma_f32_16x16x32_bf16 v[56:59], v[120:123], v[144:147], v[56:59]
    ds_read_b64_tr_b16 v[108:109], v8 offset:12288
    ds_read_b64_tr_b16 v[110:111], v8 offset:12800
    v_mfma_f32_16x16x32_bf16 v[68:71], v[148:151], v[148:151], v[68:71]
    ds_read_b64_tr_b16 v[112:113], v15 offset:12288
    ds_read_b64_tr_b16 v[114:115], v15 offset:12800
    v_mfma_f32_16x16x32_bf16 v[64:67], v[120:123], v[148:151], v[64:67]
    ds_read_b64_tr_b16 v[116:117], v252 offset:12288
    ds_read_b64_tr_b16 v[118:119], v252 offset:12800
    s_waitcnt lgkmcnt(15)
    v_mfma_f32_16x16x32_bf16 v[24:27], v[88:91], v[144:147], v[24:27]
    s_waitcnt lgkmcnt(8)
    v_max_u32 v10, v18, v19
    v_cmp_le_u32 vcc, s101, v10
    v_mfma_f32_16x16x32_bf16 v[28:31], v[88:91], v[148:151], v[28:31]
    s_add_u32 s86, s53, 20480
    s_add_u32 m0, s7, 2048
    s_nop 0
    buffer_load_dwordx4 v0, s[60:63], s86 offen offset:0 sc1 lds
    s_cbranch_vccnz fz_rh4
fz_bh4:
    v_mfma_f32_16x16x32_bf16 v[32:35], v[92:95], v[144:147], v[32:35]
    ds_read_b64_tr_b16 v[160:161], v5 offset:4096
    v_mfma_f32_16x16x32_bf16 v[36:39], v[92:95], v[148:151], v[36:39]
    ds_read_b64_tr_b16 v[162:163], v5 offset:4352
    v_mfma_f32_16x16x32_bf16 v[40:43], v[96:99], v[144:147], v[40:43]
    ds_read_b64_tr_b16 v[164:165], v6 offset:4096
    v_mfma_f32_16x16x32_bf16 v[44:47], v[96:99], v[148:151], v[44:47]
    ds_read_b64_tr_b16 v[166:167], v6 offset:4352
    v_mfma_f32_16x16x32_bf16 v[48:51], v[100:103], v[144:147], v[48:51]
    buffer_load_dwordx4 v0, s[60:63], s86 offen offset:1024 sc1 lds
    s_waitcnt vmcnt(10)
    v_mfma_f32_16x16x32_bf16 v[52:55], v[100:103], v[148:151], v[52:55]
    ds_read2st64_b32 v[18:19], v4 offset0:24 offset1:28
    v_mfma_f32_16x16x32_bf16 v[60:63], v[152:155], v[152:155], v[60:63]
    ds_read_b64_tr_b16 v[88:89], v11 offset:16384
    ds_read_b64_tr_b16 v[90:91], v11 offset:16896
    v_mfma_f32_16x16x32_bf16 v[56:59], v[120:123], v[152:155], v[56:59]
    ds_read_b64_tr_b16 v[92:93], v8 offset:16384
    ds_read_b64_tr_b16 v[94:95], v8 offset:16896
    v_mfma_f32_16x16x32_bf16 v[68:71], v[156:159], v[156:159], v[68:71]
    ds_read_b64_tr_b16 v[96:97], v15 offset:16384
    ds_read_b64_tr_b16 v[98:99], v15 offset:16896
    v_mfma_f32_16x16x32_bf16 v[64:67], v[120:123], v[156:159], v[64:67]
    buffer_load_dwordx4 v0, s[60:63], s86 offen offset:2048 sc1 lds
    ds_read_b64_tr_b16 v[100:101], v252 offset:16384
    ds_read_b64_tr_b16 v[102:103], v252 offset:16896
    s_waitcnt lgkmcnt(15)
    v_mfma_f32_16x16x32_bf16 v[24:27], v[104:107], v[152:155], v[24:27]
    s_waitcnt lgkmcnt(8)
    v_max_u32 v10, v18, v19
    v_cmp_le_u32 vcc, s101, v10
    v_mfma_f32_16x16x32_bf16 v[28:31], v[104:107], v[156:159], v[28:31]
    s_cbranch_vccnz fz_rh5
fz_bh5:
    v_mfma_f32_16x16x32_bf16 v[32:35], v[108:111], v[152:155], v[32:35]
    ds_read_b64_tr_b16 v[168:169], v5 offset:6144
    v_mfma_f32_16x16x32_bf16 v[36:39], v[108:111], v[156:159], v[36:39]
    ds_read_b64_tr_b16 v[170:171], v5 offset:6400
    v_mfma_f32_16x16x32_bf16 v[40:43], v[112:115], v[152:155], v[40:43]
    buffer_load_dwordx4 v0, s[60:63], s86 offen offset:3072 sc1 lds
    ds_read_b64_tr_b16 v[172:173], v6 offset:6144
    v_mfma_f32_16x16x32_bf16 v[44:47], v[112:115], v[156:159], v[44:47]
    ds_read_b64_tr_b16 v[174:175], v6 offset:6400
    v_mfma_f32_16x16x32_bf16 v[48:51], v[116:119], v[152:155], v[48:51]
    s_waitcnt vmcnt(10)
    v_mfma_f32_16x16x32_bf16 v[52:55], v[116:119], v[156:159], v[52:55]
    ds_read2st64_b32 v[18:19], v4 offset0:32 offset1:36
    v_mfma_f32_16x16x32_bf16 v[60:63], v[160:163], v[160:163], v[60:63]
    ds_read_b64_tr_b16 v[104:105], v11 offset:20480
    ds_read_b64_tr_b16 v[106:107], v11 offset:20992
    v_mfma_f32_16x16x32_bf16 v[56:59], v[120:123], v[160:163], v[56:59]
    s_add_u32 s86, s53, 24576
    s_add_u32 m0, s7, 6144
    s_nop 0
    buffer_load_dwordx4 v0, s[60:63], s86 offen offset:0 sc1 lds
    ds_read_b64_tr_b16 v[108:109], v8 offset:20480
    ds_read_b64_tr_b16 v[110:111], v8 offset:20992
    v_mfma_f32_16x16x32_bf16 v[68:71], v[164:167], v[164:167], v[68:71]
    ds_read_b64_tr_b16 v[112:113], v15 offset:20480
    ds_read_b64_tr_b16 v[114:115], v15 offset:20992
    v_mfma_f32_16x16x32_bf16 v[64:67], v[120:123], v[164:167], v[64:67]
    ds_read_b64_tr_b16 v[116:117], v252 offset:20480
    ds_read_b64_tr_b16 v[118:119], v252 offset:20992
    s_waitcnt lgkmcnt(15)
    v_mfma_f32_16x16x32_bf16 v[24:27], v[88:91], v[160:163], v[24:27]
    s_waitcnt lgkmcnt(8)
    v_max_u32 v10, v18, v19
    v_cmp_le_u32 vcc, s101, v10
    v_mfma_f32_16x16x32_bf16 v[28:31], v[88:91], v[164:167], v[28:31]
    s_cbranch_vccnz fz_rh6
fz_bh6:
    v_mfma_f32_16x16x32_bf16 v[32:35], v[92:95], v[160:163], v[32:35]
    buffer_load_dwordx4 v0, s[60:63], s86 offen offset:1024 sc1 lds
    ds_read_b64_tr_b16 v[176:177], v5 offset:8192
    v_mfma_f32_16x16x32_bf16 v[36:39], v[92:95], v[164:167], v[36:39]
    ds_read_b64_tr_b16 v[178:179], v5 offset:8448
    v_mfma_f32_16x16x32_bf16 v[40:43], v[96:99], v[160:163], v[40:43]
    ds_read_b64_tr_b16 v[180:181], v6 offset:8192
    v_mfma_f32_16x16x32_bf16 v[44:47], v[96:99], v[164:167], v[44:47]
    ds_read_b64_tr_b16 v[182:183], v6 offset:8448
    v_mfma_f32_16x16x32_bf16 v[48:51], v[100:103], v[160:163], v[48:51]
    s_waitcnt vmcnt(10)
    v_mfma_f32_16x16x32_bf16 v[52:55], v[100:103], v[164:167], v[52:55]
    ds_read2st64_b32 v[18:19], v4 offset0:40 offset1:44
    v_mfma_f32_16x16x32_bf16 v[60:63], v[168:171], v[168:171], v[60:63]
    buffer_load_dwordx4 v0, s[60:63], s86 offen offset:2048 sc1 lds
    ds_read_b64_tr_b16 v[88:89], v11 offset:24576
    ds_read_b64_tr_b16 v[90:91], v11 offset:25088
    v_mfma_f32_16x16x32_bf16 v[56:59], v[120:123], v[168:171], v[56:59]
    ds_read_b64_tr_b16 v[92:93], v8 offset:24576
    ds_read_b64_tr_b16 v[94:95], v8 offset:25088
    v_mfma_f32_16x16x32_bf16 v[68:71], v[172:175], v[172:175], v[68:71]
    ds_read_b64_tr_b16 v[96:97], v15 offset:24576
    ds_read_b64_tr_b16 v[98:99], v15 offset:25088
    v_mfma_f32_16x16x32_bf16 v[64:67], v[120:123], v[172:175], v[64:67]
    ds_read_b64_tr_b16 v[100:101], v252 offset:24576
    ds_read_b64_tr_b16 v[102:103], v252 offset:25088
    s_waitcnt lgkmcnt(15)
    v_mfma_f32_16x16x32_bf16 v[24:27], v[104:107], v[168:171], v[24:27]
    s_waitcnt lgkmcnt(8)
    v_max_u32 v10, v18, v19
    v_cmp_le_u32 vcc, s101, v10
    v_mfma_f32_16x16x32_bf16 v[28:31], v[104:107], v[172:175], v[28:31]
    buffer_load_dwordx4 v0, s[60:63], s86 offen offset:3072 sc1 lds
    s_cbranch_vccnz fz_rh7
fz_bh7:
    v_mfma_f32_16x16x32_bf16 v[32:35], v[108:111], v[168:171], v[32:35]
    ds_read_b64_tr_b16 v[184:185], v5 offset:10240
    v_mfma_f32_16x16x32_bf16 v[36:39], v[108:111], v[172:175], v[36:39]
    ds_read_b64_tr_b16 v[186:187], v5 offset:10496
    v_mfma_f32_16x16x32_bf16 v[40:43], v[112:115], v[168:171], v[40:43]
    ds_read_b64_tr_b16 v[188:189], v6 offset:10240
    v_mfma_f32_16x16x32_bf16 v[44:47], v[112:115], v[172:175], v[44:47]
    ds_read_b64_tr_b16 v[190:191], v6 offset:10496
    v_mfma_f32_16x16x32_bf16 v[48:51], v[116:119], v[168:171], v[48:51]
    s_waitcnt vmcnt(10)
    v_mfma_f32_16x16x32_bf16 v[52:55], v[116:119], v[172:175], v[52:55]
    ds_read2st64_b32 v[18:19], v4 offset0:48 offset1:52
    v_mfma_f32_16x16x32_bf16 v[60:63], v[176:179], v[176:179], v[60:63]
    s_add_u32 m0, s52, 57344
    s_add_u32 s55, s51, 0
    buffer_load_dwordx4 v244, s[16:19], s55 offen lds
    ds_read_b64_tr_b16 v[104:105], v11 offset:28672
    ds_read_b64_tr_b16 v[106:107], v11 offset:29184
    v_mfma_f32_16x16x32_bf16 v[56:59], v[120:123], v[176:179], v[56:59]
    ds_read_b64_tr_b16 v[108:109], v8 offset:28672
    ds_read_b64_tr_b16 v[110:111], v8 offset:29184
    v_mfma_f32_16x16x32_bf16 v[68:71], v[180:183], v[180:183], v[68:71]
    ds_read_b64_tr_b16 v[112:113], v15 offset:28672
    ds_read_b64_tr_b16 v[114:115], v15 offset:29184
    v_mfma_f32_16x16x32_bf16 v[64:67], v[120:123], v[180:183], v[64:67]
    ds_read_b64_tr_b16 v[116:117], v252 offset:28672
    ds_read_b64_tr_b16 v[118:119], v252 offset:29184
    s_waitcnt lgkmcnt(15)
    v_mfma_f32_16x16x32_bf16 v[24:27], v[88:91], v[176:179], v[24:27]
    s_waitcnt lgkmcnt(8)
    v_max_u32 v10, v18, v19
    v_cmp_le_u32 vcc, s101, v10
    v_mfma_f32_16x16x32_bf16 v[28:31], v[88:91], v[180:183], v[28:31]
    buffer_load_dwordx4 v245, s[16:19], s55 offen offset:1024 lds
    s_cbranch_vccnz fz_rh8
fz_bh8:
    v_mfma_f32_16x16x32_bf16 v[32:35], v[92:95], v[176:179], v[32:35]
    ds_read_b64_tr_b16 v[192:193], v5 offset:12288
    v_mfma_f32_16x16x32_bf16 v[36:39], v[92:95], v[180:183], v[36:39]
    ds_read_b64_tr_b16 v[194:195], v5 offset:12544
    v_mfma_f32_16x16x32_bf16 v[40:43], v[96:99], v[176:179], v[40:43]
    ds_read_b64_tr_b16 v[196:197], v6 offset:12288
    v_mfma_f32_16x16x32_bf16 v[44:47], v[96:99], v[180:183], v[44:47]
    ds_read_b64_tr_b16 v[198:199], v6 offset:12544
    v_mfma_f32_16x16x32_bf16 v[48:51], v[100:103], v[176:179], v[48:51]
    s_waitcnt vmcnt(10)
    v_mfma_f32_16x16x32_bf16 v[52:55], v[100:103], v[180:183], v[52:55]
    ds_read2st64_b32 v[18:19], v23 offset0:0 offset1:4
    v_mfma_f32_16x16x32_bf16 v[60:63], v[184:187], v[184:187], v[60:63]
    s_add_u32 m0, s52, 59392
    s_add_u32 s55, s51, 57344
    buffer_load_dwordx4 v244, s[16:19], s55 offen lds
    ds_read_b64_tr_b16 v[88:89], v11 offset:32768
    ds_read_b64_tr_b16 v[90:91], v11 offset:33280
    v_mfma_f32_16x16x32_bf16 v[56:59], v[120:123], v[184:187], v[56:59]
    ds_read_b64_tr_b16 v[92:93], v8 offset:32768
    ds_read_b64_tr_b16 v[94:95], v8 offset:33280
    v_mfma_f32_16x16x32_bf16 v[68:71], v[188:191], v[188:191], v[68:71]
    ds_read_b64_tr_b16 v[96:97], v15 offset:32768
    ds_read_b64_tr_b16 v[98:99], v15 offset:33280
    v_mfma_f32_16x16x32_bf16 v[64:67], v[120:123], v[188:191], v[64:67]
    ds_read_b64_tr_b16 v[100:101], v252 offset:32768
    ds_read_b64_tr_b16 v[102:103], v252 offset:33280
    s_waitcnt lgkmcnt(15)
    v_mfma_f32_16x16x32_bf16 v[24:27], v[104:107], v[184:187], v[24:27]
    s_waitcnt lgkmcnt(8)
    v_max_u32 v10, v18, v19
    v_cmp_le_u32 vcc, s101, v10
    v_mfma_f32_16x16x32_bf16 v[28:31], v[104:107], v[188:191], v[28:31]
    buffer_load_dwordx4 v245, s[16:19], s55 offen offset:1024 lds
    s_cbranch_vccnz fz_rh9
fz_bh9:
    v_mfma_f32_16x16x32_bf16 v[32:35], v[108:111], v[184:187], v[32:35]
    ds_read_b64_tr_b16 v[200:201], v2 offset:0
    v_mfma_f32_16x16x32_bf16 v[36:39], v[108:111], v[188:191], v[36:39]
    ds_read_b64_tr_b16 v[202:203], v2 offset:256
    v_mfma_f32_16x16x32_bf16 v[40:43], v[112:115], v[184:187], v[40:43]
    ds_read_b64_tr_b16 v[204:205], v3 offset:0
    v_mfma_f32_16x16x32_bf16 v[44:47], v[112:115], v[188:191], v[44:47]
    ds_read_b64_tr_b16 v[206:207], v3 offset:256
    v_mfma_f32_16x16x32_bf16 v[48:51], v[116:119], v[184:187], v[48:51]
    s_waitcnt vmcnt(10)
    v_mfma_f32_16x16x32_bf16 v[52:55], v[116:119], v[188:191], v[52:55]
    ds_read2st64_b32 v[18:19], v23 offset0:8 offset1:12
    v_mfma_f32_16x16x32_bf16 v[60:63], v[192:195], v[192:195], v[60:63]
    s_add_u32 m0, s52, 61440
    s_add_u32 s55, s51, 114688
    buffer_load_dwordx4 v244, s[16:19], s55 offen lds
    ds_read_b64_tr_b16 v[104:105], v11 offset:36864
    ds_read_b64_tr_b16 v[106:107], v11 offset:37376
    v_mfma_f32_16x16x32_bf16 v[56:59], v[120:123], v[192:195], v[56:59]
    ds_read_b64_tr_b16 v[108:109], v8 offset:36864
    ds_read_b64_tr_b16 v[110:111], v8 offset:37376
    v_mfma_f32_16x16x32_bf16 v[68:71], v[196:199], v[196:199], v[68:71]
    ds_read_b64_tr_b16 v[112:113], v15 offset:36864
    ds_read_b64_tr_b16 v[114:115], v15 offset:37376
    v_mfma_f32_16x16x32_bf16 v[64:67], v[120:123], v[196:199], v[64:67]
    ds_read_b64_tr_b16 v[116:117], v252 offset:36864
    ds_read_b64_tr_b16 v[118:119], v252 offset:37376
    s_waitcnt lgkmcnt(15)
    v_mfma_f32_16x16x32_bf16 v[24:27], v[88:91], v[192:195], v[24:27]
    s_waitcnt lgkmcnt(8)
    v_max_u32 v10, v18, v19
    v_cmp_le_u32 vcc, s101, v10
    v_mfma_f32_16x16x32_bf16 v[28:31], v[88:91], v[196:199], v[28:31]
    buffer_load_dwordx4 v245, s[16:19], s55 offen offset:1024 lds
    s_cbranch_vccnz fz_rh10
fz_bh10:
    v_mfma_f32_16x16x32_bf16 v[32:35], v[92:95], v[192:195], v[32:35]
    ds_read_b64_tr_b16 v[208:209], v2 offset:2048
    v_mfma_f32_16x16x32_bf16 v[36:39], v[92:95], v[196:199], v[36:39]
    ds_read_b64_tr_b16 v[210:211], v2 offset:2304
    v_mfma_f32_16x16x32_bf16 v[40:43], v[96:99], v[192:195], v[40:43]
    ds_read_b64_tr_b16 v[212:213], v3 offset:2048
    v_mfma_f32_16x16x32_bf16 v[44:47], v[96:99], v[196:199], v[44:47]
    ds_read_b64_tr_b16 v[214:215], v3 offset:2304
    v_mfma_f32_16x16x32_bf16 v[48:51], v[100:103], v[192:195], v[48:51]
    s_waitcnt vmcnt(10)
    v_mfma_f32_16x16x32_bf16 v[52:55], v[100:103], v[196:199], v[52:55]
    ds_read2st64_b32 v[18:19], v23 offset0:16 offset1:20
    v_mfma_f32_16x16x32_bf16 v[60:63], v[200:203], v[200:203], v[60:63]
    s_add_u32 m0, s52, 63488
    s_add_u32 s55, s51, 172032
    buffer_load_dwordx4 v244, s[16:19], s55 offen lds
    ds_read_b64_tr_b16 v[88:89], v11 offset:40960
    ds_read_b64_tr_b16 v[90:91], v11 offset:41472
    v_mfma_f32_16x16x32_bf16 v[56:59], v[120:123], v[200:203], v[56:59]
    ds_read_b64_tr_b16 v[92:93], v8 offset:40960
    ds_read_b64_tr_b16 v[94:95], v8 offset:41472
    v_mfma_f32_16x16x32_bf16 v[68:71], v[204:207], v[204:207], v[68:71]
    ds_read_b64_tr_b16 v[96:97], v15 offset:40960
    ds_read_b64_tr_b16 v[98:99], v15 offset:41472
    v_mfma_f32_16x16x32_bf16 v[64:67], v[120:123], v[204:207], v[64:67]
    ds_read_b64_tr_b16 v[100:101], v252 offset:40960
    ds_read_b64_tr_b16 v[102:103], v252 offset:41472
    s_waitcnt lgkmcnt(15)
    v_mfma_f32_16x16x32_bf16 v[24:27], v[104:107], v[200:203], v[24:27]
    s_waitcnt lgkmcnt(8)
    v_max_u32 v10, v18, v19
    v_cmp_le_u32 vcc, s101, v10
    v_mfma_f32_16x16x32_bf16 v[28:31], v[104:107], v[204:207], v[28:31]
    buffer_load_dwordx4 v245, s[16:19], s55 offen offset:1024 lds
    s_cbranch_vccnz fz_rh11
fz_bh11:
    v_mfma_f32_16x16x32_bf16 v[32:35], v[108:111], v[200:203], v[32:35]
    ds_read_b64_tr_b16 v[216:217], v2 offset:4096
    v_mfma_f32_16x16x32_bf16 v[36:39], v[108:111], v[204:207], v[36:39]
    ds_read_b64_tr_b16 v[218:219], v2 offset:4352
    v_mfma_f32_16x16x32_bf16 v[40:43], v[112:115], v[200:203], v[40:43]
    ds_read_b64_tr_b16 v[220:221], v3 offset:4096
    v_mfma_f32_16x16x32_bf16 v[44:47], v[112:115], v[204:207], v[44:47]
    ds_read_b64_tr_b16 v[222:223], v3 offset:4352
    v_mfma_f32_16x16x32_bf16 v[48:51], v[116:119], v[200:203], v[48:51]
    s_waitcnt vmcnt(10)
    v_mfma_f32_16x16x32_bf16 v[52:55], v[116:119], v[204:207], v[52:55]
    ds_read2st64_b32 v[18:19], v23 offset0:24 offset1:28
    v_mfma_f32_16x16x32_bf16 v[60:63], v[208:211], v[208:211], v[60:63]
    s_add_u32 m0, s52, 65536
    s_add_u32 s55, s51, 229376
    buffer_load_dwordx4 v244, s[16:19], s55 offen lds
    ds_read_b64_tr_b16 v[104:105], v11 offset:45056
    ds_read_b64_tr_b16 v[106:107], v11 offset:45568
    v_mfma_f32_16x16x32_bf16 v[56:59], v[120:123], v[208:211], v[56:59]
    ds_read_b64_tr_b16 v[108:109], v8 offset:45056
    ds_read_b64_tr_b16 v[110:111], v8 offset:45568
    v_mfma_f32_16x16x32_bf16 v[68:71], v[212:215], v[212:215], v[68:71]
    ds_read_b64_tr_b16 v[112:113], v15 offset:45056
    ds_read_b64_tr_b16 v[114:115], v15 offset:45568
    v_mfma_f32_16x16x32_bf16 v[64:67], v[120:123], v[212:215], v[64:67]
    ds_read_b64_tr_b16 v[116:117], v252 offset:45056
    ds_read_b64_tr_b16 v[118:119], v252 offset:45568
    s_waitcnt lgkmcnt(15)
    v_mfma_f32_16x16x32_bf16 v[24:27], v[88:91], v[208:211], v[24:27]
    s_waitcnt lgkmcnt(8)
    v_max_u32 v10, v18, v19
    v_cmp_le_u32 vcc, s101, v10
    v_mfma_f32_16x16x32_bf16 v[28:31], v[88:91], v[212:215], v[28:31]
    buffer_load_dwordx4 v245, s[16:19], s55 offen offset:1024 lds
    s_cbranch_vccnz fz_rh12
fz_bh12:
    v_mfma_f32_16x16x32_bf16 v[32:35], v[92:95], v[208:211], v[32:35]
    ds_read_b64_tr_b16 v[224:225], v2 offset:6144
    v_mfma_f32_16x16x32_bf16 v[36:39], v[92:95], v[212:215], v[36:39]
    ds_read_b64_tr_b16 v[226:227], v2 offset:6400
    v_mfma_f32_16x16x32_bf16 v[40:43], v[96:99], v[208:211], v[40:43]
    ds_read_b64_tr_b16 v[228:229], v3 offset:6144
    v_mfma_f32_16x16x32_bf16 v[44:47], v[96:99], v[212:215], v[44:47]
    ds_read_b64_tr_b16 v[230:231], v3 offset:6400
    v_mfma_f32_16x16x32_bf16 v[48:51], v[100:103], v[208:211], v[48:51]
    s_waitcnt vmcnt(10)
    v_mfma_f32_16x16x32_bf16 v[52:55], v[100:103], v[212:215], v[52:55]
    ds_read2st64_b32 v[18:19], v23 offset0:32 offset1:36
    v_mfma_f32_16x16x32_bf16 v[60:63], v[216:219], v[216:219], v[60:63]
    s_add_u32 m0, s52, 67584
    s_add_u32 s55, s51, 286720
    buffer_load_dwordx4 v244, s[16:19], s55 offen lds
    ds_read_b64_tr_b16 v[88:89], v11 offset:49152
    ds_read_b64_tr_b16 v[90:91], v11 offset:49664
    v_mfma_f32_16x16x32_bf16 v[56:59], v[120:123], v[216:219], v[56:59]
    ds_read_b64_tr_b16 v[92:93], v8 offset:49152
    ds_read_b64_tr_b16 v[94:95], v8 offset:49664
    v_mfma_f32_16x16x32_bf16 v[68:71], v[220:223], v[220:223], v[68:71]
    ds_read_b64_tr_b16 v[96:97], v15 offset:49152
    ds_read_b64_tr_b16 v[98:99], v15 offset:49664
    v_mfma_f32_16x16x32_bf16 v[64:67], v[120:123], v[220:223], v[64:67]
    ds_read_b64_tr_b16 v[100:101], v252 offset:49152
    s_waitcnt lgkmcnt(15)
    v_mfma_f32_16x16x32_bf16 v[24:27], v[104:107], v[216:219], v[24:27]
    ds_read_b64_tr_b16 v[102:103], v252 offset:49664
    v_mfma_f32_16x16x32_bf16 v[28:31], v[104:107], v[220:223], v[28:31]
    buffer_load_dwordx4 v245, s[16:19], s55 offen offset:1024 lds
    s_waitcnt lgkmcnt(8)
    v_max_u32 v10, v18, v19
    v_mfma_f32_16x16x32_bf16 v[32:35], v[108:111], v[216:219], v[32:35]
    v_cmp_le_u32 vcc, s101, v10
    v_mfma_f32_16x16x32_bf16 v[36:39], v[108:111], v[220:223], v[36:39]
    s_cbranch_vccnz fz_rh13
fz_bh13:
    v_mfma_f32_16x16x32_bf16 v[40:43], v[112:115], v[216:219], v[40:43]
    ds_read_b64_tr_b16 v[232:233], v2 offset:8192
    v_mfma_f32_16x16x32_bf16 v[44:47], v[112:115], v[220:223], v[44:47]
    ds_read_b64_tr_b16 v[234:235], v2 offset:8448
    v_mfma_f32_16x16x32_bf16 v[48:51], v[116:119], v[216:219], v[48:51]
    ds_read_b64_tr_b16 v[236:237], v3 offset:8192
    v_mfma_f32_16x16x32_bf16 v[52:55], v[116:119], v[220:223], v[52:55]
    ds_read_b64_tr_b16 v[238:239], v3 offset:8448
    v_mfma_f32_16x16x32_bf16 v[60:63], v[224:227], v[224:227], v[60:63]
    s_add_u32 m0, s52, 69632
    s_add_u32 s55, s51, 344064
    buffer_load_dwordx4 v244, s[16:19], s55 offen lds
    ds_read_b64_tr_b16 v[104:105], v11 offset:53248
    v_mfma_f32_16x16x32_bf16 v[56:59], v[120:123], v[224:227], v[56:59]
    ds_read_b64_tr_b16 v[106:107], v11 offset:53760
    v_mfma_f32_16x16x32_bf16 v[68:71], v[228:231], v[228:231], v[68:71]
    ds_read_b64_tr_b16 v[108:109], v8 offset:53248
    v_mfma_f32_16x16x32_bf16 v[64:67], v[120:123], v[228:231], v[64:67]
    ds_read_b64_tr_b16 v[110:111], v8 offset:53760
    s_waitcnt lgkmcnt(14)
    v_mfma_f32_16x16x32_bf16 v[24:27], v[88:91], v[224:227], v[24:27]
    ds_read_b64_tr_b16 v[112:113], v15 offset:53248
    v_mfma_f32_16x16x32_bf16 v[28:31], v[88:91], v[228:231], v[28:31]
    buffer_load_dwordx4 v245, s[16:19], s55 offen offset:1024 lds
    ds_read_b64_tr_b16 v[114:115], v15 offset:53760
    s_waitcnt lgkmcnt(14)
    v_mfma_f32_16x16x32_bf16 v[32:35], v[92:95], v[224:227], v[32:35]
    ds_read_b64_tr_b16 v[116:117], v252 offset:53248
    v_mfma_f32_16x16x32_bf16 v[36:39], v[92:95], v[228:231], v[36:39]
    ds_read_b64_tr_b16 v[118:119], v252 offset:53760
    s_waitcnt lgkmcnt(14)
    v_mfma_f32_16x16x32_bf16 v[40:43], v[96:99], v[224:227], v[40:43]
    v_mfma_f32_16x16x32_bf16 v[44:47], v[96:99], v[228:231], v[44:47]
    s_waitcnt lgkmcnt(12)
    v_mfma_f32_16x16x32_bf16 v[48:51], v[100:103], v[224:227], v[48:51]
    v_mfma_f32_16x16x32_bf16 v[52:55], v[100:103], v[228:231], v[52:55]
    s_waitcnt lgkmcnt(10)
    v_mfma_f32_16x16x32_bf16 v[60:63], v[232:235], v[232:235], v[60:63]
    v_mfma_f32_16x16x32_bf16 v[56:59], v[120:123], v[232:235], v[56:59]
    s_waitcnt lgkmcnt(8)
    v_mfma_f32_16x16x32_bf16 v[68:71], v[236:239], v[236:239], v[68:71]
    v_mfma_f32_16x16x32_bf16 v[64:67], v[120:123], v[236:239], v[64:67]
    s_waitcnt lgkmcnt(6)
    v_mfma_f32_16x16x32_bf16 v[24:27], v[104:107], v[232:235], v[24:27]
    v_mfma_f32_16x16x32_bf16 v[28:31], v[104:107], v[236:239], v[28:31]
    s_nop 0
    v_cndmask_b32 v60, v60, v61, s[28:29]
    v_cndmask_b32 v60, v60, v62, s[30:31]
    s_waitcnt lgkmcnt(4)
    v_mfma_f32_16x16x32_bf16 v[32:35], v[108:111], v[232:235], v[32:35]
    v_cndmask_b32 v60, v60, v63, s[32:33]
    v_mfma_f32_16x16x32_bf16 v[36:39], v[108:111], v[236:239], v[36:39]
    v_cndmask_b32 v60, 0, v60, s[34:35]
    s_waitcnt lgkmcnt(2)
    v_mfma_f32_16x16x32_bf16 v[40:43], v[112:115], v[232:235], v[40:43]
    v_cndmask_b32 v68, v68, v69, s[28:29]
    v_mfma_f32_16x16x32_bf16 v[44:47], v[112:115], v[236:239], v[44:47]
    v_cndmask_b32 v68, v68, v70, s[30:31]
    s_waitcnt lgkmcnt(0)
    v_mfma_f32_16x16x32_bf16 v[48:51], v[116:119], v[232:235], v[48:51]
    v_cndmask_b32 v68, v68, v71, s[32:33]
    v_mfma_f32_16x16x32_bf16 v[52:55], v[116:119], v[236:239], v[52:55]
    v_cndmask_b32 v68, 0, v68, s[34:35]
    s_lshl_b32 s5, s4, 6
    v_add_u32 v0, s5, v7
    v_add_u32 v2, 57344, v11
    v_add_u32 v3, 57344, v8
    v_add_u32 v4, 57344, v15
    v_add_u32 v5, 57344, v252
    v_mov_b32 v8, v9
    s_lshl_b32 s5, s4, 5
    v_xor_b32 v6, s5, v2
    v_permlane32_swap_b32 v60, v68
    v_permlane32_swap_b32 v56, v64
    v_add_f32 v60, v60, v68
    v_mov_b32 v68, v60
    s_nop 1
    v_permlane16_swap_b32 v60, v68
    v_mov_b32 v12, v56
    v_add_f32 v13, v60, v68
    v_mul_f32 v12, 0x3b124925, v12
    v_mul_f32 v13, 0x3b124925, v13
    v_fma_f32 v13, -v12, v12, v13
    v_max_f32 v13, 0, v13
    v_cvt_pk_bf16_f32 v14, v12, v13
    v_lshlrev_b32 v12, 16, v14
    v_and_b32 v13, 0xffff0000, v14
    v_add_f32 v13, 0x3727c5ac, v13
    v_cvt_pk_bf16_f32 v13, v13, v13
    v_lshlrev_b32 v13, 16, v13
    v_sqrt_f32 v13, v13
    s_nop 0
    v_cvt_pk_bf16_f32 v13, v13, v13
    v_lshlrev_b32 v13, 16, v13
    v_rcp_f32 v17, v13
    v_mov_b32 v14, v12
    v_mov_b32 v15, v13
    v_mul_f32 v16, v17, v17
    v_mul_f32 v17, 0xc0135761, v17
    v_mul_f32 v16, 0x3d372713, v16
    v_mul_f32 v16, v16, v17
    v_mov_b32 v19, v17
    v_mov_b32 v18, v16
    v_permlane32_swap_b32 v12, v14
    v_permlane32_swap_b32 v13, v15
    v_permlane32_swap_b32 v16, v18
    v_permlane32_swap_b32 v17, v19
    v_pk_fma_f32 v[24:25], v[72:73], v[12:13], v[24:25] op_sel_hi:[1,0,1] neg_lo:[0,1,0] neg_hi:[0,1,0]
    v_pk_fma_f32 v[26:27], v[74:75], v[12:13], v[26:27] op_sel_hi:[1,0,1] neg_lo:[0,1,0] neg_hi:[0,1,0]
    v_pk_mul_f32 v[104:105], v[24:25], v[24:25]
    v_pk_mul_f32 v[106:107], v[26:27], v[26:27]
    v_pk_fma_f32 v[104:105], v[104:105], v[16:17], v[16:17] op_sel:[0,0,1] op_sel_hi:[1,0,1]
    v_pk_fma_f32 v[106:107], v[106:107], v[16:17], v[16:17] op_sel:[0,0,1] op_sel_hi:[1,0,1]
    v_pk_mul_f32 v[104:105], v[104:105], v[24:25]
    v_pk_mul_f32 v[106:107], v[106:107], v[26:27]
    v_exp_f32 v104, v104
    v_pk_fma_f32 v[28:29], v[72:73], v[14:15], v[28:29] op_sel_hi:[1,0,1] neg_lo:[0,1,0] neg_hi:[0,1,0]
    v_pk_fma_f32 v[30:31], v[74:75], v[14:15], v[30:31] op_sel_hi:[1,0,1] neg_lo:[0,1,0] neg_hi:[0,1,0]
    v_exp_f32 v105, v105
    v_pk_mul_f32 v[108:109], v[28:29], v[28:29]
    v_pk_mul_f32 v[110:111], v[30:31], v[30:31]
    v_exp_f32 v106, v106
    v_pk_fma_f32 v[108:109], v[108:109], v[18:19], v[18:19] op_sel:[0,0,1] op_sel_hi:[1,0,1]
    v_pk_fma_f32 v[110:111], v[110:111], v[18:19], v[18:19] op_sel:[0,0,1] op_sel_hi:[1,0,1]
    v_exp_f32 v107, v107
    v_pk_mul_f32 v[108:109], v[108:109], v[28:29]
    v_pk_mul_f32 v[110:111], v[110:111], v[30:31]
    v_pk_fma_f32 v[104:105], v[104:105], v[12:13], v[12:13] op_sel:[0,1,1] op_sel_hi:[1,1,1]
    v_pk_fma_f32 v[106:107], v[106:107], v[12:13], v[12:13] op_sel:[0,1,1] op_sel_hi:[1,1,1]
    v_rcp_f32 v104, v104
    v_pk_fma_f32 v[32:33], v[76:77], v[12:13], v[32:33] op_sel_hi:[1,0,1] neg_lo:[0,1,0] neg_hi:[0,1,0]
    v_rcp_f32 v105, v105
    v_pk_fma_f32 v[34:35], v[78:79], v[12:13], v[34:35] op_sel_hi:[1,0,1] neg_lo:[0,1,0] neg_hi:[0,1,0]
    v_rcp_f32 v106, v106
    v_pk_mul_f32 v[112:113], v[32:33], v[32:33]
    v_rcp_f32 v107, v107
    v_pk_mul_f32 v[114:115], v[34:35], v[34:35]
    v_exp_f32 v108, v108
    v_pk_fma_f32 v[112:113], v[112:113], v[16:17], v[16:17] op_sel:[0,0,1] op_sel_hi:[1,0,1]
    v_exp_f32 v109, v109
    v_pk_fma_f32 v[114:115], v[114:115], v[16:17], v[16:17] op_sel:[0,0,1] op_sel_hi:[1,0,1]
    v_exp_f32 v110, v110
    v_pk_mul_f32 v[112:113], v[112:113], v[32:33]
    v_exp_f32 v111, v111
    v_pk_mul_f32 v[114:115], v[114:115], v[34:35]
    v_pk_fma_f32 v[108:109], v[108:109], v[14:15], v[14:15] op_sel:[0,1,1] op_sel_hi:[1,1,1]
    v_pk_fma_f32 v[110:111], v[110:111], v[14:15], v[14:15] op_sel:[0,1,1] op_sel_hi:[1,1,1]
    v_rcp_f32 v108, v108
    v_pk_mul_f32 v[24:25], v[24:25], v[104:105]
    v_pk_mul_f32 v[26:27], v[26:27], v[106:107]
    v_rcp_f32 v109, v109
    v_pk_fma_f32 v[36:37], v[76:77], v[14:15], v[36:37] op_sel_hi:[1,0,1] neg_lo:[0,1,0] neg_hi:[0,1,0]
    v_pk_fma_f32 v[38:39], v[78:79], v[14:15], v[38:39] op_sel_hi:[1,0,1] neg_lo:[0,1,0] neg_hi:[0,1,0]
    v_rcp_f32 v110, v110
    v_pk_add_f32 v[88:89], v[24:25], v[26:27]
    v_pk_mul_f32 v[90:91], v[24:25], v[24:25]
    v_rcp_f32 v111, v111
    v_pk_fma_f32 v[90:91], v[26:27], v[26:27], v[90:91]
    v_pk_mul_f32 v[104:105], v[36:37], v[36:37]
    v_exp_f32 v112, v112
    v_pk_mul_f32 v[106:107], v[38:39], v[38:39]
    v_exp_f32 v113, v113
    v_pk_fma_f32 v[104:105], v[104:105], v[18:19], v[18:19] op_sel:[0,0,1] op_sel_hi:[1,0,1]
    v_exp_f32 v114, v114
    v_pk_fma_f32 v[106:107], v[106:107], v[18:19], v[18:19] op_sel:[0,0,1] op_sel_hi:[1,0,1]
    v_exp_f32 v115, v115
    v_pk_mul_f32 v[104:105], v[104:105], v[36:37]
    v_pk_mul_f32 v[106:107], v[106:107], v[38:39]
    v_pk_fma_f32 v[112:113], v[112:113], v[12:13], v[12:13] op_sel:[0,1,1] op_sel_hi:[1,1,1]
    v_pk_fma_f32 v[114:115], v[114:115], v[12:13], v[12:13] op_sel:[0,1,1] op_sel_hi:[1,1,1]
    v_rcp_f32 v112, v112
    v_pk_mul_f32 v[28:29], v[28:29], v[108:109]
    v_pk_mul_f32 v[30:31], v[30:31], v[110:111]
    v_rcp_f32 v113, v113
    v_pk_fma_f32 v[40:41], v[80:81], v[12:13], v[40:41] op_sel_hi:[1,0,1] neg_lo:[0,1,0] neg_hi:[0,1,0]
    v_pk_fma_f32 v[42:43], v[82:83], v[12:13], v[42:43] op_sel_hi:[1,0,1] neg_lo:[0,1,0] neg_hi:[0,1,0]
    v_rcp_f32 v114, v114
    v_pk_add_f32 v[92:93], v[28:29], v[30:31]
    v_pk_mul_f32 v[94:95], v[28:29], v[28:29]
    v_rcp_f32 v115, v115
    v_pk_fma_f32 v[94:95], v[30:31], v[30:31], v[94:95]
    v_pk_mul_f32 v[108:109], v[40:41], v[40:41]
    v_exp_f32 v104, v104
    v_pk_mul_f32 v[110:111], v[42:43], v[42:43]
    v_exp_f32 v105, v105
    v_pk_fma_f32 v[108:109], v[108:109], v[16:17], v[16:17] op_sel:[0,0,1] op_sel_hi:[1,0,1]
    v_exp_f32 v106, v106
    v_pk_fma_f32 v[110:111], v[110:111], v[16:17], v[16:17] op_sel:[0,0,1] op_sel_hi:[1,0,1]
    v_exp_f32 v107, v107
    v_pk_mul_f32 v[108:109], v[108:109], v[40:41]
    v_pk_mul_f32 v[110:111], v[110:111], v[42:43]
    v_pk_fma_f32 v[104:105], v[104:105], v[14:15], v[14:15] op_sel:[0,1,1] op_sel_hi:[1,1,1]
    v_pk_fma_f32 v[106:107], v[106:107], v[14:15], v[14:15] op_sel:[0,1,1] op_sel_hi:[1,1,1]
    v_rcp_f32 v104, v104
    v_pk_mul_f32 v[32:33], v[32:33], v[112:113]
    v_pk_mul_f32 v[34:35], v[34:35], v[114:115]
    v_rcp_f32 v105, v105
    v_pk_fma_f32 v[44:45], v[80:81], v[14:15], v[44:45] op_sel_hi:[1,0,1] neg_lo:[0,1,0] neg_hi:[0,1,0]
    v_pk_fma_f32 v[46:47], v[82:83], v[14:15], v[46:47] op_sel_hi:[1,0,1] neg_lo:[0,1,0] neg_hi:[0,1,0]
    v_rcp_f32 v106, v106
    v_pk_add_f32 v[88:89], v[88:89], v[32:33]
    v_pk_fma_f32 v[90:91], v[32:33], v[32:33], v[90:91]
    v_rcp_f32 v107, v107
    v_pk_add_f32 v[88:89], v[88:89], v[34:35]
    v_pk_fma_f32 v[90:91], v[34:35], v[34:35], v[90:91]
    v_exp_f32 v108, v108
    v_pk_mul_f32 v[112:113], v[44:45], v[44:45]
    v_pk_mul_f32 v[114:115], v[46:47], v[46:47]
    v_exp_f32 v109, v109
    v_pk_fma_f32 v[112:113], v[112:113], v[18:19], v[18:19] op_sel:[0,0,1] op_sel_hi:[1,0,1]
    v_exp_f32 v110, v110
    v_pk_fma_f32 v[114:115], v[114:115], v[18:19], v[18:19] op_sel:[0,0,1] op_sel_hi:[1,0,1]
    v_exp_f32 v111, v111
    v_pk_mul_f32 v[112:113], v[112:113], v[44:45]
    v_pk_mul_f32 v[114:115], v[114:115], v[46:47]
    v_pk_fma_f32 v[108:109], v[108:109], v[12:13], v[12:13] op_sel:[0,1,1] op_sel_hi:[1,1,1]
    v_pk_fma_f32 v[110:111], v[110:111], v[12:13], v[12:13] op_sel:[0,1,1] op_sel_hi:[1,1,1]
    v_rcp_f32 v108, v108
    v_pk_mul_f32 v[36:37], v[36:37], v[104:105]
    v_pk_mul_f32 v[38:39], v[38:39], v[106:107]
    v_rcp_f32 v109, v109
    v_pk_fma_f32 v[48:49], v[84:85], v[12:13], v[48:49] op_sel_hi:[1,0,1] neg_lo:[0,1,0] neg_hi:[0,1,0]
    v_pk_fma_f32 v[50:51], v[86:87], v[12:13], v[50:51] op_sel_hi:[1,0,1] neg_lo:[0,1,0] neg_hi:[0,1,0]
    v_rcp_f32 v110, v110
    v_pk_add_f32 v[92:93], v[92:93], v[36:37]
    v_pk_fma_f32 v[94:95], v[36:37], v[36:37], v[94:95]
    v_rcp_f32 v111, v111
    v_pk_add_f32 v[92:93], v[92:93], v[38:39]
    v_pk_fma_f32 v[94:95], v[38:39], v[38:39], v[94:95]
    v_exp_f32 v112, v112
    v_pk_mul_f32 v[104:105], v[48:49], v[48:49]
    v_pk_mul_f32 v[106:107], v[50:51], v[50:51]
    v_exp_f32 v113, v113
    v_pk_fma_f32 v[104:105], v[104:105], v[16:17], v[16:17] op_sel:[0,0,1] op_sel_hi:[1,0,1]
    v_exp_f32 v114, v114
    v_pk_fma_f32 v[106:107], v[106:107], v[16:17], v[16:17] op_sel:[0,0,1] op_sel_hi:[1,0,1]
    v_exp_f32 v115, v115
    v_pk_mul_f32 v[104:105], v[104:105], v[48:49]
    v_pk_mul_f32 v[106:107], v[106:107], v[50:51]
    v_pk_fma_f32 v[112:113], v[112:113], v[14:15], v[14:15] op_sel:[0,1,1] op_sel_hi:[1,1,1]
    v_pk_fma_f32 v[114:115], v[114:115], v[14:15], v[14:15] op_sel:[0,1,1] op_sel_hi:[1,1,1]
    v_rcp_f32 v112, v112
    v_pk_mul_f32 v[40:41], v[40:41], v[108:109]
    v_pk_mul_f32 v[42:43], v[42:43], v[110:111]
    v_rcp_f32 v113, v113
    v_pk_fma_f32 v[52:53], v[84:85], v[14:15], v[52:53] op_sel_hi:[1,0,1] neg_lo:[0,1,0] neg_hi:[0,1,0]
    v_pk_fma_f32 v[54:55], v[86:87], v[14:15], v[54:55] op_sel_hi:[1,0,1] neg_lo:[0,1,0] neg_hi:[0,1,0]
    v_rcp_f32 v114, v114
    v_pk_add_f32 v[88:89], v[88:89], v[40:41]
    v_pk_fma_f32 v[90:91], v[40:41], v[40:41], v[90:91]
    v_rcp_f32 v115, v115
    v_pk_add_f32 v[88:89], v[88:89], v[42:43]
    v_pk_fma_f32 v[90:91], v[42:43], v[42:43], v[90:91]
    v_exp_f32 v104, v104
    v_pk_mul_f32 v[108:109], v[52:53], v[52:53]
    v_pk_mul_f32 v[110:111], v[54:55], v[54:55]
    v_exp_f32 v105, v105
    v_pk_fma_f32 v[108:109], v[108:109], v[18:19], v[18:19] op_sel:[0,0,1] op_sel_hi:[1,0,1]
    v_exp_f32 v106, v106
    v_pk_fma_f32 v[110:111], v[110:111], v[18:19], v[18:19] op_sel:[0,0,1] op_sel_hi:[1,0,1]
    v_exp_f32 v107, v107
    v_pk_mul_f32 v[108:109], v[108:109], v[52:53]
    v_pk_mul_f32 v[110:111], v[110:111], v[54:55]
    v_pk_fma_f32 v[104:105], v[104:105], v[12:13], v[12:13] op_sel:[0,1,1] op_sel_hi:[1,1,1]
    v_pk_fma_f32 v[106:107], v[106:107], v[12:13], v[12:13] op_sel:[0,1,1] op_sel_hi:[1,1,1]
    v_rcp_f32 v104, v104
    v_pk_mul_f32 v[44:45], v[44:45], v[112:113]
    v_rcp_f32 v105, v105
    v_pk_mul_f32 v[46:47], v[46:47], v[114:115]
    v_rcp_f32 v106, v106
    v_pk_add_f32 v[92:93], v[92:93], v[44:45]
    v_rcp_f32 v107, v107
    v_pk_fma_f32 v[94:95], v[44:45], v[44:45], v[94:95]
    v_exp_f32 v108, v108
    v_pk_add_f32 v[92:93], v[92:93], v[46:47]
    v_exp_f32 v109, v109
    v_pk_fma_f32 v[94:95], v[46:47], v[46:47], v[94:95]
    v_exp_f32 v110, v110
    v_exp_f32 v111, v111
    v_pk_fma_f32 v[108:109], v[108:109], v[14:15], v[14:15] op_sel:[0,1,1] op_sel_hi:[1,1,1]
    v_pk_fma_f32 v[110:111], v[110:111], v[14:15], v[14:15] op_sel:[0,1,1] op_sel_hi:[1,1,1]
    v_rcp_f32 v108, v108
    v_pk_mul_f32 v[48:49], v[48:49], v[104:105]
    v_pk_mul_f32 v[50:51], v[50:51], v[106:107]
    v_rcp_f32 v109, v109
    v_pk_add_f32 v[88:89], v[88:89], v[48:49]
    v_rcp_f32 v110, v110
    v_pk_fma_f32 v[90:91], v[48:49], v[48:49], v[90:91]
    v_rcp_f32 v111, v111
    v_pk_add_f32 v[88:89], v[88:89], v[50:51]
    v_pk_fma_f32 v[90:91], v[50:51], v[50:51], v[90:91]
    v_pk_mul_f32 v[52:53], v[52:53], v[108:109]
    v_pk_mul_f32 v[54:55], v[54:55], v[110:111]
    v_pk_add_f32 v[92:93], v[92:93], v[52:53]
    v_pk_fma_f32 v[94:95], v[52:53], v[52:53], v[94:95]
    v_pk_add_f32 v[92:93], v[92:93], v[54:55]
    v_pk_fma_f32 v[94:95], v[54:55], v[54:55], v[94:95]
    v_add_f32 v88, v88, v89
    v_add_f32 v90, v90, v91
    v_add_f32 v92, v92, v93
    v_add_f32 v94, v94, v95
    s_nop 0
    v_permlane32_swap_b32 v88, v92
    v_permlane32_swap_b32 v90, v94
    v_add_f32 v88, v88, v92
    v_add_f32 v90, v90, v94
    s_nop 1
    v_permlane16_swap_b32 v88, v90
    v_add_f32 v88, v88, v90
    v_mov_b32 v89, v88
    s_nop 1
    v_permlane16_swap_b32 v88, v89
    v_and_b32 v89, 0x7fffffff, v89
    s_mov_b32 exec_lo, 0xffff
    s_mov_b32 exec_hi, 0xffff
    buffer_store_dwordx2 v[88:89], v124, s[36:39], s41 offen sc0 sc1
    s_mov_b64 exec, -1
    s_mul_i32 s86, s4, 12288
    s_add_u32 s86, s86, 114688
    v_lshrrev_b32 v23, 4, v1
    v_bfe_u32 v124, v1, 1, 3
    v_xor_b32 v23, v23, v124
    v_lshlrev_b32 v23, 4, v23
    v_and_b32 v124, 15, v1
    v_lshl_add_u32 v23, v124, 7, v23
    v_add_u32 v23, s86, v23
    v_xor_b32 v124, 64, v23
    s_waitcnt vmcnt(1)
    s_barrier
    s_lshl_b32 s33, s4, 12
    s_cmp_ge_u32 s11, 7
    s_cselect_b32 s30, 0x20000, 0
    s_cselect_b32 s31, -7, 7
    s_lshl_b32 s31, s31, 18
    s_add_u32 s49, s49, s30
    s_add_u32 s101, s49, s31
    s_sub_u32 s49, s49, s33
    s_and_b32 s30, s4, 1
    s_lshl_b32 s30, s30, 13
    s_add_u32 s49, s49, s30
    s_lshl_b32 s30, s25, 14
    s_mov_b32 s31, s25
    ds_read_b64_tr_b16 v[88:89], v2 offset:0
    ds_read_b64_tr_b16 v[90:91], v2 offset:512
    ds_read_b64_tr_b16 v[92:93], v3 offset:0
    ds_read_b64_tr_b16 v[94:95], v3 offset:512
    ds_read_b64_tr_b16 v[96:97], v4 offset:0
    ds_read_b64_tr_b16 v[98:99], v4 offset:512
    ds_read_b64_tr_b16 v[100:101], v5 offset:0
    ds_read_b64_tr_b16 v[102:103], v5 offset:512
    ds_read_b64_tr_b16 v[240:241], v6 offset:0
    ds_read_b64_tr_b16 v[242:243], v6 offset:512
    s_waitcnt lgkmcnt(8)
    v_mfma_f32_16x16x32_bf16 v[56:59], v[88:91], v[128:131], 0
    s_add_u32 m0, s86, 0
    s_add_u32 s22, s23, 0x10000
    buffer_load_dwordx4 v254, s[12:15], s22 offen lds
    ds_read_b64_tr_b16 v[104:105], v2 offset:4096
    ds_read_b64_tr_b16 v[106:107], v2 offset:4608
    v_mfma_f32_16x16x32_bf16 v[60:63], v[88:91], v[132:135], 0
    ds_read_b64_tr_b16 v[108:109], v3 offset:4096
    s_waitcnt lgkmcnt(9)
    v_mfma_f32_16x16x32_bf16 v[64:67], v[92:95], v[128:131], 0
    ds_read_b64_tr_b16 v[110:111], v3 offset:4608
    v_mfma_f32_16x16x32_bf16 v[68:71], v[92:95], v[132:135], 0
    buffer_load_dwordx4 v255, s[12:15], s22 offen offset:1024 lds
    ds_read_b64_tr_b16 v[112:113], v4 offset:4096
    s_waitcnt lgkmcnt(9)
    v_mfma_f32_16x16x32_bf16 v[72:75], v[96:99], v[128:131], 0
    ds_read_b64_tr_b16 v[114:115], v4 offset:4608
    v_mfma_f32_16x16x32_bf16 v[76:79], v[96:99], v[132:135], 0
    ds_read_b64_tr_b16 v[116:117], v5 offset:4096
    s_waitcnt lgkmcnt(9)
    v_mfma_f32_16x16x32_bf16 v[80:83], v[100:103], v[128:131], 0
    s_add_u32 m0, s86, 2048
    s_add_u32 s22, s23, 0x80
    buffer_load_dwordx4 v254, s[12:15], s22 offen lds
    ds_read_b64_tr_b16 v[118:119], v5 offset:4608
    v_mfma_f32_16x16x32_bf16 v[84:87], v[100:103], v[132:135], 0
    ds_read_b64_tr_b16 v[244:245], v6 offset:4096
    s_waitcnt lgkmcnt(9)
    v_mfma_f32_16x16x32_bf16 v[248:251], v[240:243], v[120:123], 0
    ds_read_b64_tr_b16 v[246:247], v6 offset:4608
    s_waitcnt lgkmcnt(8)
    v_mfma_f32_16x16x32_bf16 v[56:59], v[104:107], v[136:139], v[56:59]
    buffer_load_dwordx4 v255, s[12:15], s22 offen offset:1024 lds
    ds_read_b64_tr_b16 v[88:89], v2 offset:8192
    ds_read_b64_tr_b16 v[90:91], v2 offset:8704
    v_mfma_f32_16x16x32_bf16 v[60:63], v[104:107], v[140:143], v[60:63]
    ds_read_b64_tr_b16 v[92:93], v3 offset:8192
    s_waitcnt lgkmcnt(9)
    v_mfma_f32_16x16x32_bf16 v[64:67], v[108:111], v[136:139], v[64:67]
    ds_read_b64_tr_b16 v[94:95], v3 offset:8704
    v_mfma_f32_16x16x32_bf16 v[68:71], v[108:111], v[140:143], v[68:71]
    s_add_u32 m0, s86, 4096
    s_add_u32 s22, s23, 0x10080
    buffer_load_dwordx4 v254, s[12:15], s22 offen lds
    ds_read_b64_tr_b16 v[96:97], v4 offset:8192
    s_waitcnt lgkmcnt(9)
    v_mfma_f32_16x16x32_bf16 v[72:75], v[112:115], v[136:139], v[72:75]
    ds_read_b64_tr_b16 v[98:99], v4 offset:8704
    v_mfma_f32_16x16x32_bf16 v[76:79], v[112:115], v[140:143], v[76:79]
    ds_read_b64_tr_b16 v[100:101], v5 offset:8192
    s_waitcnt lgkmcnt(9)
    v_mfma_f32_16x16x32_bf16 v[80:83], v[116:119], v[136:139], v[80:83]
    buffer_load_dwordx4 v255, s[12:15], s22 offen offset:1024 lds
    ds_read_b64_tr_b16 v[102:103], v5 offset:8704
    v_mfma_f32_16x16x32_bf16 v[84:87], v[116:119], v[140:143], v[84:87]
    ds_read_b64_tr_b16 v[240:241], v6 offset:8192
    s_waitcnt lgkmcnt(9)
    v_mfma_f32_16x16x32_bf16 v[248:251], v[244:247], v[120:123], v[248:251]
    ds_read_b64_tr_b16 v[242:243], v6 offset:8704
    s_waitcnt lgkmcnt(8)
    v_mfma_f32_16x16x32_bf16 v[56:59], v[88:91], v[144:147], v[56:59]
    s_add_u32 m0, s86, 6144
    s_add_u32 s20, s20, 0x100
    s_and_b32 s20, s20, 0x700
    s_add_u32 s23, s87, s20
    s_add_u32 s22, s23, 0x0
    buffer_load_dwordx4 v254, s[12:15], s22 offen lds
    ds_read_b64_tr_b16 v[104:105], v2 offset:12288
    ds_read_b64_tr_b16 v[106:107], v2 offset:12800
    v_mfma_f32_16x16x32_bf16 v[60:63], v[88:91], v[148:151], v[60:63]
    ds_read_b64_tr_b16 v[108:109], v3 offset:12288
    s_waitcnt lgkmcnt(9)
    v_mfma_f32_16x16x32_bf16 v[64:67], v[92:95], v[144:147], v[64:67]
    ds_read_b64_tr_b16 v[110:111], v3 offset:12800
    v_mfma_f32_16x16x32_bf16 v[68:71], v[92:95], v[148:151], v[68:71]
    buffer_load_dwordx4 v255, s[12:15], s22 offen offset:1024 lds
    ds_read_b64_tr_b16 v[112:113], v4 offset:12288
    s_waitcnt lgkmcnt(9)
    v_mfma_f32_16x16x32_bf16 v[72:75], v[96:99], v[144:147], v[72:75]
    ds_read_b64_tr_b16 v[114:115], v4 offset:12800
    v_mfma_f32_16x16x32_bf16 v[76:79], v[96:99], v[148:151], v[76:79]
    ds_read_b64_tr_b16 v[116:117], v5 offset:12288
    s_waitcnt lgkmcnt(9)
    v_mfma_f32_16x16x32_bf16 v[80:83], v[100:103], v[144:147], v[80:83]
    s_add_u32 m0, s86, 8192
    s_add_u32 s22, s23, 0x10000
    buffer_load_dwordx4 v254, s[12:15], s22 offen lds
    ds_read_b64_tr_b16 v[118:119], v5 offset:12800
    v_mfma_f32_16x16x32_bf16 v[84:87], v[100:103], v[148:151], v[84:87]
    ds_read_b64_tr_b16 v[244:245], v6 offset:12288
    s_waitcnt lgkmcnt(9)
    v_mfma_f32_16x16x32_bf16 v[248:251], v[240:243], v[120:123], v[248:251]
    ds_read_b64_tr_b16 v[246:247], v6 offset:12800
    s_waitcnt lgkmcnt(8)
    v_mfma_f32_16x16x32_bf16 v[56:59], v[104:107], v[152:155], v[56:59]
    buffer_load_dwordx4 v255, s[12:15], s22 offen offset:1024 lds
    ds_read_b64_tr_b16 v[88:89], v2 offset:16384
    ds_read_b64_tr_b16 v[90:91], v2 offset:16896
    v_mfma_f32_16x16x32_bf16 v[60:63], v[104:107], v[156:159], v[60:63]
    ds_read_b64_tr_b16 v[92:93], v3 offset:16384
    ds_read_b64_tr_b16 v[94:95], v3 offset:16896
    s_waitcnt lgkmcnt(10)
    v_mfma_f32_16x16x32_bf16 v[64:67], v[108:111], v[152:155], v[64:67]
    ds_read_b64_tr_b16 v[96:97], v4 offset:16384
    ds_read_b64_tr_b16 v[98:99], v4 offset:16896
    v_mfma_f32_16x16x32_bf16 v[68:71], v[108:111], v[156:159], v[68:71]
    s_add_u32 m0, s86, 10240
    s_add_u32 s22, s23, 0x80
    buffer_load_dwordx4 v254, s[12:15], s22 offen lds
    ds_read_b64_tr_b16 v[100:101], v5 offset:16384
    ds_read_b64_tr_b16 v[102:103], v5 offset:16896
    s_waitcnt lgkmcnt(12)
    v_mfma_f32_16x16x32_bf16 v[72:75], v[112:115], v[152:155], v[72:75]
    ds_read_b64_tr_b16 v[240:241], v6 offset:16384
    v_mfma_f32_16x16x32_bf16 v[76:79], v[112:115], v[156:159], v[76:79]
    ds_read_b64_tr_b16 v[242:243], v6 offset:16896
    s_waitcnt lgkmcnt(12)
    v_mfma_f32_16x16x32_bf16 v[80:83], v[116:119], v[152:155], v[80:83]
    buffer_load_dwordx4 v255, s[12:15], s22 offen offset:1024 lds
    s_waitcnt vmcnt(10)
    v_mfma_f32_16x16x32_bf16 v[84:87], v[116:119], v[156:159], v[84:87]
    ds_read_b128 a[36:39], v23 offset:0
    s_waitcnt lgkmcnt(11)
    v_mfma_f32_16x16x32_bf16 v[248:251], v[244:247], v[120:123], v[248:251]
    ds_read_b128 a[44:47], v124 offset:0
    s_waitcnt lgkmcnt(10)
    v_mfma_f32_16x16x32_bf16 v[56:59], v[88:91], v[160:163], v[56:59]
    s_waitcnt lgkmcnt(0)
    s_add_u32 m0, s86, 0
    s_add_u32 s22, s23, 0x10080
    buffer_load_dwordx4 v254, s[12:15], s22 offen lds
    ds_read_b64_tr_b16 v[104:105], v2 offset:20480
    ds_read_b64_tr_b16 v[106:107], v2 offset:20992
    v_mfma_f32_16x16x32_bf16 v[60:63], v[88:91], v[164:167], v[60:63]
    ds_read_b64_tr_b16 v[108:109], v3 offset:20480
    ds_read_b64_tr_b16 v[110:111], v3 offset:20992
    v_mfma_f32_16x16x32_bf16 v[64:67], v[92:95], v[160:163], v[64:67]
    ds_read_b64_tr_b16 v[112:113], v4 offset:20480
    ds_read_b64_tr_b16 v[114:115], v4 offset:20992
    v_mfma_f32_16x16x32_bf16 v[68:71], v[92:95], v[164:167], v[68:71]
    buffer_load_dwordx4 v255, s[12:15], s22 offen offset:1024 lds
    ds_read_b64_tr_b16 v[116:117], v5 offset:20480
    ds_read_b64_tr_b16 v[118:119], v5 offset:20992
    v_mfma_f32_16x16x32_bf16 v[72:75], v[96:99], v[160:163], v[72:75]
    ds_read_b64_tr_b16 v[244:245], v6 offset:20480
    ds_read_b64_tr_b16 v[246:247], v6 offset:20992
    v_mfma_f32_16x16x32_bf16 v[76:79], v[96:99], v[164:167], v[76:79]
    s_waitcnt vmcnt(10)
    ds_read_b128 a[48:51], v23 offset:2048
    v_mfma_f32_16x16x32_bf16 v[80:83], v[100:103], v[160:163], v[80:83]
    ds_read_b128 a[56:59], v124 offset:2048
    s_waitcnt vmcnt(8)
    v_mfma_f32_16x16x32_bf16 v[84:87], v[100:103], v[164:167], v[84:87]
    ds_read_b128 a[52:55], v23 offset:4096
    v_mfma_f32_16x16x32_bf16 v[248:251], v[240:243], v[120:123], v[248:251]
    ds_read_b128 a[60:63], v124 offset:4096
    s_waitcnt lgkmcnt(12)
    v_mfma_f32_16x16x32_bf16 v[56:59], v[104:107], v[168:171], v[56:59]
    s_waitcnt lgkmcnt(2)
    s_add_u32 m0, s86, 2048
    s_add_u32 s20, s20, 0x100
    s_and_b32 s20, s20, 0x700
    s_add_u32 s23, s87, s20
    s_add_u32 s22, s23, 0x0
    buffer_load_dwordx4 v254, s[12:15], s22 offen lds
    ds_read_b64_tr_b16 v[88:89], v2 offset:24576
    ds_read_b64_tr_b16 v[90:91], v2 offset:25088
    v_mfma_f32_16x16x32_bf16 v[60:63], v[104:107], v[172:175], v[60:63]
    ds_read_b64_tr_b16 v[92:93], v3 offset:24576
    ds_read_b64_tr_b16 v[94:95], v3 offset:25088
    v_mfma_f32_16x16x32_bf16 v[64:67], v[108:111], v[168:171], v[64:67]
    ds_read_b64_tr_b16 v[96:97], v4 offset:24576
    ds_read_b64_tr_b16 v[98:99], v4 offset:25088
    v_mfma_f32_16x16x32_bf16 v[68:71], v[108:111], v[172:175], v[68:71]
    buffer_load_dwordx4 v255, s[12:15], s22 offen offset:1024 lds
    ds_read_b64_tr_b16 v[100:101], v5 offset:24576
    ds_read_b64_tr_b16 v[102:103], v5 offset:25088
    v_mfma_f32_16x16x32_bf16 v[72:75], v[112:115], v[168:171], v[72:75]
    ds_read_b64_tr_b16 v[240:241], v6 offset:24576
    v_mfma_f32_16x16x32_bf16 v[76:79], v[112:115], v[172:175], v[76:79]
    ds_read_b64_tr_b16 v[242:243], v6 offset:25088
    v_mfma_f32_16x16x32_bf16 v[80:83], v[116:119], v[168:171], v[80:83]
    s_waitcnt lgkmcnt(10)
    s_add_u32 m0, s86, 4096
    s_add_u32 s22, s23, 0x10000
    buffer_load_dwordx4 v254, s[12:15], s22 offen lds
    s_waitcnt vmcnt(9)
    v_mfma_f32_16x16x32_bf16 v[84:87], v[116:119], v[172:175], v[84:87]
    ds_read_b128 a[64:67], v23 offset:6144
    v_mfma_f32_16x16x32_bf16 v[248:251], v[244:247], v[120:123], v[248:251]
    ds_read_b128 a[72:75], v124 offset:6144
    s_waitcnt lgkmcnt(10)
    v_mfma_f32_16x16x32_bf16 v[56:59], v[88:91], v[176:179], v[56:59]
    buffer_load_dwordx4 v255, s[12:15], s22 offen offset:1024 lds
    ds_read_b64_tr_b16 v[104:105], v2 offset:28672
    ds_read_b64_tr_b16 v[106:107], v2 offset:29184
    v_mfma_f32_16x16x32_bf16 v[60:63], v[88:91], v[180:183], v[60:63]
    ds_read_b64_tr_b16 v[108:109], v3 offset:28672
    ds_read_b64_tr_b16 v[110:111], v3 offset:29184
    s_waitcnt lgkmcnt(12)
    v_mfma_f32_16x16x32_bf16 v[64:67], v[92:95], v[176:179], v[64:67]
    buffer_load_dwordx2 v[128:129], v125, s[36:39], s40 offen offset:0 sc0 sc1
    buffer_load_dwordx2 v[130:131], v125, s[36:39], s40 offen offset:256 sc0 sc1
    v_mfma_f32_16x16x32_bf16 v[68:71], v[92:95], v[180:183], v[68:71]
    s_waitcnt lgkmcnt(4)
    s_add_u32 m0, s86, 6144
    s_add_u32 s22, s23, 0x80
    buffer_load_dwordx4 v254, s[12:15], s22 offen lds
    buffer_load_dwordx2 v[132:133], v125, s[36:39], s40 offen offset:512 sc0 sc1
    buffer_load_dwordx2 v[134:135], v125, s[36:39], s40 offen offset:768 sc0 sc1
    v_mfma_f32_16x16x32_bf16 v[72:75], v[96:99], v[176:179], v[72:75]
    buffer_load_dwordx2 v[136:137], v125, s[36:39], s40 offen offset:1024 sc0 sc1
    buffer_load_dwordx2 v[138:139], v125, s[36:39], s40 offen offset:1280 sc0 sc1
    v_mfma_f32_16x16x32_bf16 v[76:79], v[96:99], v[180:183], v[76:79]
    buffer_load_dwordx2 v[140:141], v125, s[36:39], s40 offen offset:1536 sc0 sc1
    ds_read_b64_tr_b16 v[112:113], v4 offset:28672
    v_mfma_f32_16x16x32_bf16 v[80:83], v[100:103], v[176:179], v[80:83]
    buffer_load_dwordx4 v255, s[12:15], s22 offen offset:1024 lds
    ds_read_b64_tr_b16 v[114:115], v4 offset:29184
    ds_read_b64_tr_b16 v[116:117], v5 offset:28672
    v_mfma_f32_16x16x32_bf16 v[84:87], v[100:103], v[180:183], v[84:87]
    ds_read_b64_tr_b16 v[118:119], v5 offset:29184
    ds_read_b64_tr_b16 v[244:245], v6 offset:28672
    v_mfma_f32_16x16x32_bf16 v[248:251], v[240:243], v[120:123], v[248:251]
    ds_read_b64_tr_b16 v[246:247], v6 offset:29184
    s_waitcnt vmcnt(17)
    ds_read_b128 a[68:71], v23 offset:8192
    ds_read_b128 a[76:79], v124 offset:8192
    s_waitcnt vmcnt(15)
    ds_read_b128 a[80:83], v23 offset:10240
    ds_read_b128 a[88:91], v124 offset:10240
    s_waitcnt lgkmcnt(12)
    v_mfma_f32_16x16x32_bf16 v[56:59], v[104:107], v[184:187], v[56:59]
    s_waitcnt lgkmcnt(2)
    s_add_u32 m0, s86, 8192
    s_add_u32 s22, s23, 0x10080
    buffer_load_dwordx4 v254, s[12:15], s22 offen lds
    ds_read_b64_tr_b16 v[88:89], v2 offset:32768
    ds_read_b64_tr_b16 v[90:91], v2 offset:33280
    v_mfma_f32_16x16x32_bf16 v[60:63], v[104:107], v[188:191], v[60:63]
    ds_read_b64_tr_b16 v[92:93], v3 offset:32768
    ds_read_b64_tr_b16 v[94:95], v3 offset:33280
    v_mfma_f32_16x16x32_bf16 v[64:67], v[108:111], v[184:187], v[64:67]
    ds_read_b64_tr_b16 v[96:97], v4 offset:32768
    ds_read_b64_tr_b16 v[98:99], v4 offset:33280
    v_mfma_f32_16x16x32_bf16 v[68:71], v[108:111], v[188:191], v[68:71]
    buffer_load_dwordx4 v255, s[12:15], s22 offen offset:1024 lds
    ds_read_b64_tr_b16 v[100:101], v5 offset:32768
    ds_read_b64_tr_b16 v[102:103], v5 offset:33280
    v_mfma_f32_16x16x32_bf16 v[72:75], v[112:115], v[184:187], v[72:75]
    ds_read_b64_tr_b16 v[240:241], v6 offset:32768
    v_mfma_f32_16x16x32_bf16 v[76:79], v[112:115], v[188:191], v[76:79]
    ds_read_b64_tr_b16 v[242:243], v6 offset:33280
    v_mfma_f32_16x16x32_bf16 v[80:83], v[116:119], v[184:187], v[80:83]
    s_waitcnt lgkmcnt(10)
    s_add_u32 m0, s86, 10240
    s_add_u32 s20, s20, 0x100
    s_and_b32 s20, s20, 0x700
    s_add_u32 s23, s87, s20
    s_add_u32 s22, s23, 0x0
    buffer_load_dwordx4 v254, s[12:15], s22 offen lds
    s_waitcnt vmcnt(16)
    v_mfma_f32_16x16x32_bf16 v[84:87], v[116:119], v[188:191], v[84:87]
    ds_read_b128 a[84:87], v23 offset:0
    v_mfma_f32_16x16x32_bf16 v[248:251], v[244:247], v[120:123], v[248:251]
    ds_read_b128 a[92:95], v124 offset:0
    s_waitcnt lgkmcnt(10)
    v_mfma_f32_16x16x32_bf16 v[56:59], v[88:91], v[192:195], v[56:59]
    buffer_load_dwordx4 v255, s[12:15], s22 offen offset:1024 lds
    ds_read_b64_tr_b16 v[104:105], v2 offset:36864
    ds_read_b64_tr_b16 v[106:107], v2 offset:37376
    v_mfma_f32_16x16x32_bf16 v[60:63], v[88:91], v[196:199], v[60:63]
    ds_read_b64_tr_b16 v[108:109], v3 offset:36864
    ds_read_b64_tr_b16 v[110:111], v3 offset:37376
    s_waitcnt lgkmcnt(12)
    v_mfma_f32_16x16x32_bf16 v[64:67], v[92:95], v[192:195], v[64:67]
    ds_read_b64_tr_b16 v[112:113], v4 offset:36864
    ds_read_b64_tr_b16 v[114:115], v4 offset:37376
    v_mfma_f32_16x16x32_bf16 v[68:71], v[92:95], v[196:199], v[68:71]
    s_waitcnt lgkmcnt(6)
    s_add_u32 m0, s86, 0
    s_add_u32 s22, s23, 0x10000
    buffer_load_dwordx4 v254, s[12:15], s22 offen lds
    ds_read_b64_tr_b16 v[116:117], v5 offset:36864
    ds_read_b64_tr_b16 v[118:119], v5 offset:37376
    v_mfma_f32_16x16x32_bf16 v[72:75], v[96:99], v[192:195], v[72:75]
    ds_read_b64_tr_b16 v[244:245], v6 offset:36864
    v_mfma_f32_16x16x32_bf16 v[76:79], v[96:99], v[196:199], v[76:79]
    ds_read_b64_tr_b16 v[246:247], v6 offset:37376
    v_mfma_f32_16x16x32_bf16 v[80:83], v[100:103], v[192:195], v[80:83]
    buffer_load_dwordx4 v255, s[12:15], s22 offen offset:1024 lds
    s_waitcnt vmcnt(17)
    v_mfma_f32_16x16x32_bf16 v[84:87], v[100:103], v[196:199], v[84:87]
    ds_read_b128 a[96:99], v23 offset:2048
    v_mfma_f32_16x16x32_bf16 v[248:251], v[240:243], v[120:123], v[248:251]
    ds_read_b128 a[104:107], v124 offset:2048
    s_waitcnt lgkmcnt(10)
    v_mfma_f32_16x16x32_bf16 v[56:59], v[104:107], v[200:203], v[56:59]
    s_waitcnt lgkmcnt(0)
    s_add_u32 m0, s86, 2048
    s_add_u32 s22, s23, 0x80
    buffer_load_dwordx4 v254, s[12:15], s22 offen lds
    ds_read_b64_tr_b16 v[88:89], v2 offset:40960
    ds_read_b64_tr_b16 v[90:91], v2 offset:41472
    v_mfma_f32_16x16x32_bf16 v[60:63], v[104:107], v[204:207], v[60:63]
    ds_read_b64_tr_b16 v[92:93], v3 offset:40960
    ds_read_b64_tr_b16 v[94:95], v3 offset:41472
    v_mfma_f32_16x16x32_bf16 v[64:67], v[108:111], v[200:203], v[64:67]
    ds_read_b64_tr_b16 v[96:97], v4 offset:40960
    ds_read_b64_tr_b16 v[98:99], v4 offset:41472
    v_mfma_f32_16x16x32_bf16 v[68:71], v[108:111], v[204:207], v[68:71]
    buffer_load_dwordx4 v255, s[12:15], s22 offen offset:1024 lds
    ds_read_b64_tr_b16 v[100:101], v5 offset:40960
    ds_read_b64_tr_b16 v[102:103], v5 offset:41472
    v_mfma_f32_16x16x32_bf16 v[72:75], v[112:115], v[200:203], v[72:75]
    ds_read_b64_tr_b16 v[240:241], v6 offset:40960
    ds_read_b64_tr_b16 v[242:243], v6 offset:41472
    v_mfma_f32_16x16x32_bf16 v[76:79], v[112:115], v[204:207], v[76:79]
    s_waitcnt vmcnt(17)
    ds_read_b128 a[100:103], v23 offset:4096
    v_mfma_f32_16x16x32_bf16 v[80:83], v[116:119], v[200:203], v[80:83]
    ds_read_b128 a[108:111], v124 offset:4096
    s_waitcnt vmcnt(8)
    v_mfma_f32_16x16x32_bf16 v[84:87], v[116:119], v[204:207], v[84:87]
    ds_read_b128 a[112:115], v23 offset:6144
    v_mfma_f32_16x16x32_bf16 v[248:251], v[244:247], v[120:123], v[248:251]
    ds_read_b128 a[120:123], v124 offset:6144
    v_or3_b32 v10, v129, v131, v133
    v_or3_b32 v10, v10, v135, v137
    v_or3_b32 v10, v10, v139, v141
    v_cmp_gt_i32 vcc, 0, v10
    s_cbranch_vccnz fz_rx
fz_bx:
    v_pk_add_f32 v[128:129], v[128:129], v[130:131]
    v_pk_add_f32 v[132:133], v[132:133], v[134:135]
    v_pk_add_f32 v[136:137], v[136:137], v[138:139]
    v_pk_add_f32 v[128:129], v[128:129], v[132:133]
    v_pk_add_f32 v[136:137], v[136:137], v[140:141]
    v_pk_add_f32 v[128:129], v[128:129], v[136:137]
    s_nop 1
    v_permlane32_swap_b32 v128, v129
    v_add_f32 v128, v128, v129
    v_mov_b32 v129, v128
    s_nop 1
    v_permlane32_swap_b32 v128, v129
    v_mul_f32 v128, 0x3a924925, v128
    v_mul_f32 v129, 0x3a924925, v129
    v_fma_f32 v129, -v128, v128, v129
    v_max_f32 v129, 0, v129
    v_cvt_pk_bf16_f32 v130, v128, v129
    v_lshlrev_b32 v128, 16, v130
    v_and_b32 v129, 0xffff0000, v130
    v_add_f32 v129, 0x3727c5ac, v129
    v_cvt_pk_bf16_f32 v129, v129, v129
    v_lshlrev_b32 v129, 16, v129
    v_sqrt_f32 v129, v129
    s_nop 0
    v_cvt_pk_bf16_f32 v129, v129, v129
    v_lshlrev_b32 v129, 16, v129
    v_rcp_f32 v132, v129
    s_nop 0
    v_mul_f32_e64 v133, -v128, v132
    v_mov_b32 v134, v132
    v_mov_b32 v135, v133
    s_nop 0
    v_permlane16_swap_b32 v132, v134
    v_permlane16_swap_b32 v133, v135
    v_pk_fma_f32 v[24:25], v[24:25], v[132:133], v[132:133] op_sel:[0,0,1] op_sel_hi:[1,0,1]
    v_pk_fma_f32 v[26:27], v[26:27], v[132:133], v[132:133] op_sel:[0,0,1] op_sel_hi:[1,0,1]
    v_pk_fma_f32 v[28:29], v[28:29], v[134:135], v[134:135] op_sel:[0,0,1] op_sel_hi:[1,0,1]
    v_pk_fma_f32 v[30:31], v[30:31], v[134:135], v[134:135] op_sel:[0,0,1] op_sel_hi:[1,0,1]
    v_cvt_pk_bf16_f32 v144, v24, v25
    v_cvt_pk_bf16_f32 v145, v26, v27
    ds_write_b64 v126, v[144:145] offset:0
    v_cvt_pk_bf16_f32 v146, v28, v29
    v_cvt_pk_bf16_f32 v147, v30, v31
    ds_write_b64 v126, v[146:147] offset:16384
    ds_read_b64_tr_b16 v[160:161], v127 offset:0
    ds_read_b64_tr_b16 v[162:163], v127 offset:544
    v_pk_fma_f32 v[32:33], v[32:33], v[132:133], v[132:133] op_sel:[0,0,1] op_sel_hi:[1,0,1]
    v_pk_fma_f32 v[34:35], v[34:35], v[132:133], v[132:133] op_sel:[0,0,1] op_sel_hi:[1,0,1]
    v_pk_fma_f32 v[36:37], v[36:37], v[134:135], v[134:135] op_sel:[0,0,1] op_sel_hi:[1,0,1]
    v_pk_fma_f32 v[38:39], v[38:39], v[134:135], v[134:135] op_sel:[0,0,1] op_sel_hi:[1,0,1]
    v_cvt_pk_bf16_f32 v148, v32, v33
    v_cvt_pk_bf16_f32 v149, v34, v35
    ds_write_b64 v126, v[148:149] offset:32
    v_cvt_pk_bf16_f32 v150, v36, v37
    v_cvt_pk_bf16_f32 v151, v38, v39
    ds_write_b64 v126, v[150:151] offset:16416
    ds_read_b64_tr_b16 v[164:165], v127 offset:32
    ds_read_b64_tr_b16 v[166:167], v127 offset:576
    v_pk_fma_f32 v[40:41], v[40:41], v[132:133], v[132:133] op_sel:[0,0,1] op_sel_hi:[1,0,1]
    v_pk_fma_f32 v[42:43], v[42:43], v[132:133], v[132:133] op_sel:[0,0,1] op_sel_hi:[1,0,1]
    v_pk_fma_f32 v[44:45], v[44:45], v[134:135], v[134:135] op_sel:[0,0,1] op_sel_hi:[1,0,1]
    v_pk_fma_f32 v[46:47], v[46:47], v[134:135], v[134:135] op_sel:[0,0,1] op_sel_hi:[1,0,1]
    v_cvt_pk_bf16_f32 v152, v40, v41
    v_cvt_pk_bf16_f32 v153, v42, v43
    ds_write_b64 v126, v[152:153] offset:64
    v_cvt_pk_bf16_f32 v154, v44, v45
    v_cvt_pk_bf16_f32 v155, v46, v47
    ds_write_b64 v126, v[154:155] offset:16448
    ds_read_b64_tr_b16 v[168:169], v127 offset:64
    ds_read_b64_tr_b16 v[170:171], v127 offset:608
    v_pk_fma_f32 v[48:49], v[48:49], v[132:133], v[132:133] op_sel:[0,0,1] op_sel_hi:[1,0,1]
    v_pk_fma_f32 v[50:51], v[50:51], v[132:133], v[132:133] op_sel:[0,0,1] op_sel_hi:[1,0,1]
    v_pk_fma_f32 v[52:53], v[52:53], v[134:135], v[134:135] op_sel:[0,0,1] op_sel_hi:[1,0,1]
    v_pk_fma_f32 v[54:55], v[54:55], v[134:135], v[134:135] op_sel:[0,0,1] op_sel_hi:[1,0,1]
    v_cvt_pk_bf16_f32 v156, v48, v49
    v_cvt_pk_bf16_f32 v157, v50, v51
    ds_write_b64 v126, v[156:157] offset:96
    v_cvt_pk_bf16_f32 v158, v52, v53
    v_cvt_pk_bf16_f32 v159, v54, v55
    ds_write_b64 v126, v[158:159] offset:16480
    ds_read_b64_tr_b16 v[172:173], v127 offset:96
    ds_read_b64_tr_b16 v[174:175], v127 offset:640
    s_waitcnt lgkmcnt(12)
    buffer_store_dwordx4 v[160:163], v9, s[44:47], s42 offen offset:0 sc1
    s_waitcnt lgkmcnt(8)
    buffer_store_dwordx4 v[164:167], v9, s[44:47], s42 offen offset:1024 sc1
    s_waitcnt lgkmcnt(4)
    buffer_store_dwordx4 v[168:171], v9, s[44:47], s42 offen offset:2048 sc1
    s_waitcnt lgkmcnt(0)
    buffer_store_dwordx4 v[172:175], v9, s[44:47], s42 offen offset:3072 sc1
    v_mfma_f32_16x16x32_bf16 v[56:59], v[88:91], v[208:211], v[56:59]
    ds_read_b64_tr_b16 v[104:105], v2 offset:45056
    ds_read_b64_tr_b16 v[106:107], v2 offset:45568
    v_mfma_f32_16x16x32_bf16 v[60:63], v[88:91], v[212:215], v[60:63]
    ds_read_b64_tr_b16 v[108:109], v3 offset:45056
    ds_read_b64_tr_b16 v[110:111], v3 offset:45568
    v_mfma_f32_16x16x32_bf16 v[64:67], v[92:95], v[208:211], v[64:67]
    ds_read_b64_tr_b16 v[112:113], v4 offset:45056
    ds_read_b64_tr_b16 v[114:115], v4 offset:45568
    v_mfma_f32_16x16x32_bf16 v[68:71], v[92:95], v[212:215], v[68:71]
    ds_read_b64_tr_b16 v[116:117], v5 offset:45056
    ds_read_b64_tr_b16 v[118:119], v5 offset:45568
    v_mfma_f32_16x16x32_bf16 v[72:75], v[96:99], v[208:211], v[72:75]
    ds_read_b64_tr_b16 v[244:245], v6 offset:45056
    v_mfma_f32_16x16x32_bf16 v[76:79], v[96:99], v[212:215], v[76:79]
    ds_read_b64_tr_b16 v[246:247], v6 offset:45568
    v_mfma_f32_16x16x32_bf16 v[80:83], v[100:103], v[208:211], v[80:83]
    s_waitcnt vmcnt(10)
    v_mfma_f32_16x16x32_bf16 v[84:87], v[100:103], v[212:215], v[84:87]
    ds_read_b128 a[116:119], v23 offset:8192
    v_mfma_f32_16x16x32_bf16 v[248:251], v[240:243], v[120:123], v[248:251]
    ds_read_b128 a[124:127], v124 offset:8192
    s_waitcnt lgkmcnt(10)
    v_mfma_f32_16x16x32_bf16 v[56:59], v[104:107], v[216:219], v[56:59]
    ds_read_b64_tr_b16 v[88:89], v2 offset:49152
    ds_read_b64_tr_b16 v[90:91], v2 offset:49664
    v_mfma_f32_16x16x32_bf16 v[60:63], v[104:107], v[220:223], v[60:63]
    ds_read_b64_tr_b16 v[92:93], v3 offset:49152
    ds_read_b64_tr_b16 v[94:95], v3 offset:49664
    s_waitcnt lgkmcnt(12)
    v_mfma_f32_16x16x32_bf16 v[64:67], v[108:111], v[216:219], v[64:67]
    ds_read_b64_tr_b16 v[96:97], v4 offset:49152
    ds_read_b64_tr_b16 v[98:99], v4 offset:49664
    v_mfma_f32_16x16x32_bf16 v[68:71], v[108:111], v[220:223], v[68:71]
    ds_read_b64_tr_b16 v[100:101], v5 offset:49152
    ds_read_b64_tr_b16 v[102:103], v5 offset:49664
    s_waitcnt lgkmcnt(14)
    v_mfma_f32_16x16x32_bf16 v[72:75], v[112:115], v[216:219], v[72:75]
    ds_read_b64_tr_b16 v[240:241], v6 offset:49152
    ds_read_b64_tr_b16 v[242:243], v6 offset:49664
    v_mfma_f32_16x16x32_bf16 v[76:79], v[112:115], v[220:223], v[76:79]
    s_waitcnt vmcnt(8)
    ds_read_b128 a[128:131], v23 offset:10240
    s_waitcnt lgkmcnt(15)
    v_mfma_f32_16x16x32_bf16 v[80:83], v[116:119], v[216:219], v[80:83]
    ds_read_b128 a[136:139], v124 offset:10240
    s_waitcnt vmcnt(6)
    v_mfma_f32_16x16x32_bf16 v[84:87], v[116:119], v[220:223], v[84:87]
    ds_read_b128 a[132:135], v23 offset:0
    s_waitcnt lgkmcnt(15)
    v_mfma_f32_16x16x32_bf16 v[248:251], v[244:247], v[120:123], v[248:251]
    ds_read_b128 a[140:143], v124 offset:0
    s_waitcnt lgkmcnt(12)
    v_mfma_f32_16x16x32_bf16 v[56:59], v[88:91], v[224:227], v[56:59]
    ds_read_b64_tr_b16 v[104:105], v2 offset:53248
    ds_read_b64_tr_b16 v[106:107], v2 offset:53760
    v_mfma_f32_16x16x32_bf16 v[60:63], v[88:91], v[228:231], v[60:63]
    ds_read_b64_tr_b16 v[108:109], v3 offset:53248
    ds_read_b64_tr_b16 v[110:111], v3 offset:53760
    s_waitcnt lgkmcnt(14)
    v_mfma_f32_16x16x32_bf16 v[64:67], v[92:95], v[224:227], v[64:67]
    ds_read_b64_tr_b16 v[112:113], v4 offset:53248
    ds_read_b64_tr_b16 v[114:115], v4 offset:53760
    v_mfma_f32_16x16x32_bf16 v[68:71], v[92:95], v[228:231], v[68:71]
    ds_read_b64_tr_b16 v[116:117], v5 offset:53248
    ds_read_b64_tr_b16 v[118:119], v5 offset:53760
    s_waitcnt lgkmcnt(15)
    v_mfma_f32_16x16x32_bf16 v[72:75], v[96:99], v[224:227], v[72:75]
    ds_read_b64_tr_b16 v[244:245], v6 offset:53248
    v_mfma_f32_16x16x32_bf16 v[76:79], v[96:99], v[228:231], v[76:79]
    ds_read_b64_tr_b16 v[246:247], v6 offset:53760
    s_waitcnt lgkmcnt(15)
    v_mfma_f32_16x16x32_bf16 v[80:83], v[100:103], v[224:227], v[80:83]
    s_waitcnt vmcnt(4)
    v_mfma_f32_16x16x32_bf16 v[84:87], v[100:103], v[228:231], v[84:87]
    ds_read_b128 a[144:147], v23 offset:2048
    s_waitcnt lgkmcnt(15)
    v_mfma_f32_16x16x32_bf16 v[248:251], v[240:243], v[120:123], v[248:251]
    ds_read_b128 a[152:155], v124 offset:2048
    s_waitcnt lgkmcnt(10)
    v_mfma_f32_16x16x32_bf16 v[56:59], v[104:107], v[232:235], v[56:59]
    v_mfma_f32_16x16x32_bf16 v[60:63], v[104:107], v[236:239], v[60:63]
    s_waitcnt lgkmcnt(8)
    v_mfma_f32_16x16x32_bf16 v[64:67], v[108:111], v[232:235], v[64:67]
    v_mfma_f32_16x16x32_bf16 v[68:71], v[108:111], v[236:239], v[68:71]
    s_waitcnt lgkmcnt(6)
    v_mfma_f32_16x16x32_bf16 v[72:75], v[112:115], v[232:235], v[72:75]
    v_mfma_f32_16x16x32_bf16 v[76:79], v[112:115], v[236:239], v[76:79]
    s_waitcnt lgkmcnt(4)
    v_mfma_f32_16x16x32_bf16 v[80:83], v[116:119], v[232:235], v[80:83]
    v_mfma_f32_16x16x32_bf16 v[84:87], v[116:119], v[236:239], v[84:87]
    s_waitcnt lgkmcnt(2)
    v_mfma_f32_16x16x32_bf16 v[248:251], v[244:247], v[120:123], v[248:251]
    s_waitcnt vmcnt(0)
    s_mov_b32 exec_lo, 0x00010001
    s_mov_b32 exec_hi, 0x00010001
    s_nop 4
    ds_write_b128 v0, v[248:251]
    s_mov_b64 exec, -1
    s_waitcnt lgkmcnt(0)
    s_barrier
    ds_read_b128 v[88:91], v7 offset:0
    ds_read_b128 v[92:95], v7 offset:64
    ds_read_b128 v[96:99], v7 offset:128
    ds_read_b128 v[100:103], v7 offset:192
    v_add_u32 v4, s33, v9
    v_add_u32 v5, 0x10000, v4
    v_mov_b32 v2, v8
    v_add_u32 v3, 0x10000, v8
    s_waitcnt lgkmcnt(0)
    v_pk_fma_f32 v[84:85], v[100:101], v[14:15], v[84:85] op_sel_hi:[1,0,1] neg_lo:[0,1,0] neg_hi:[0,1,0]
    v_pk_fma_f32 v[86:87], v[102:103], v[14:15], v[86:87] op_sel_hi:[1,0,1] neg_lo:[0,1,0] neg_hi:[0,1,0]
    v_pk_mul_f32 v[104:105], v[84:85], v[84:85]
    v_pk_mul_f32 v[106:107], v[86:87], v[86:87]
    v_pk_fma_f32 v[104:105], v[104:105], v[18:19], v[18:19] op_sel:[0,0,1] op_sel_hi:[1,0,1]
    v_pk_fma_f32 v[106:107], v[106:107], v[18:19], v[18:19] op_sel:[0,0,1] op_sel_hi:[1,0,1]
    v_pk_mul_f32 v[104:105], v[104:105], v[84:85]
    v_pk_mul_f32 v[106:107], v[106:107], v[86:87]
    v_exp_f32 v104, v104
    v_pk_fma_f32 v[80:81], v[100:101], v[12:13], v[80:81] op_sel_hi:[1,0,1] neg_lo:[0,1,0] neg_hi:[0,1,0]
    v_pk_fma_f32 v[82:83], v[102:103], v[12:13], v[82:83] op_sel_hi:[1,0,1] neg_lo:[0,1,0] neg_hi:[0,1,0]
    s_add_u32 s32, s101, s30
    s_add_u32 m0, s33, 0
    s_nop 0
    buffer_load_dwordx4 v9, s[44:47], s32 offen offset:0 sc1 lds
    v_exp_f32 v105, v105
    v_pk_mul_f32 v[108:109], v[80:81], v[80:81]
    v_pk_mul_f32 v[110:111], v[82:83], v[82:83]
    v_exp_f32 v106, v106
    v_pk_fma_f32 v[108:109], v[108:109], v[16:17], v[16:17] op_sel:[0,0,1] op_sel_hi:[1,0,1]
    v_pk_fma_f32 v[110:111], v[110:111], v[16:17], v[16:17] op_sel:[0,0,1] op_sel_hi:[1,0,1]
    v_exp_f32 v107, v107
    v_pk_mul_f32 v[108:109], v[108:109], v[80:81]
    buffer_load_dwordx4 v9, s[44:47], s32 offen offset:1024 sc1 lds
    v_pk_mul_f32 v[110:111], v[110:111], v[82:83]
    v_pk_fma_f32 v[104:105], v[104:105], v[14:15], v[14:15] op_sel:[0,1,1] op_sel_hi:[1,1,1]
    v_pk_fma_f32 v[106:107], v[106:107], v[14:15], v[14:15] op_sel:[0,1,1] op_sel_hi:[1,1,1]
    v_rcp_f32 v104, v104
    v_pk_fma_f32 v[76:77], v[96:97], v[14:15], v[76:77] op_sel_hi:[1,0,1] neg_lo:[0,1,0] neg_hi:[0,1,0]
    v_rcp_f32 v105, v105
    v_pk_fma_f32 v[78:79], v[98:99], v[14:15], v[78:79] op_sel_hi:[1,0,1] neg_lo:[0,1,0] neg_hi:[0,1,0]
    buffer_load_dwordx4 v9, s[44:47], s32 offen offset:2048 sc1 lds
    v_rcp_f32 v106, v106
    v_pk_mul_f32 v[112:113], v[76:77], v[76:77]
    v_rcp_f32 v107, v107
    v_pk_mul_f32 v[114:115], v[78:79], v[78:79]
    v_exp_f32 v108, v108
    v_pk_fma_f32 v[112:113], v[112:113], v[18:19], v[18:19] op_sel:[0,0,1] op_sel_hi:[1,0,1]
    buffer_load_dwordx4 v9, s[44:47], s32 offen offset:3072 sc1 lds
    v_exp_f32 v109, v109
    v_pk_fma_f32 v[114:115], v[114:115], v[18:19], v[18:19] op_sel:[0,0,1] op_sel_hi:[1,0,1]
    v_exp_f32 v110, v110
    v_pk_mul_f32 v[112:113], v[112:113], v[76:77]
    v_exp_f32 v111, v111
    v_pk_mul_f32 v[114:115], v[114:115], v[78:79]
    s_add_u32 s30, s30, 0x4000
    s_and_b32 s30, s30, 0x1c000
    s_add_u32 s32, s101, s30
    s_add_u32 m0, s33, 16384
    s_nop 0
    buffer_load_dwordx4 v9, s[44:47], s32 offen offset:0 sc1 lds
    v_pk_fma_f32 v[108:109], v[108:109], v[12:13], v[12:13] op_sel:[0,1,1] op_sel_hi:[1,1,1]
    v_pk_fma_f32 v[110:111], v[110:111], v[12:13], v[12:13] op_sel:[0,1,1] op_sel_hi:[1,1,1]
    v_rcp_f32 v108, v108
    v_pk_mul_f32 v[84:85], v[84:85], v[104:105]
    v_pk_mul_f32 v[86:87], v[86:87], v[106:107]
    v_rcp_f32 v109, v109
    v_pk_fma_f32 v[72:73], v[96:97], v[12:13], v[72:73] op_sel_hi:[1,0,1] neg_lo:[0,1,0] neg_hi:[0,1,0]
    v_pk_fma_f32 v[74:75], v[98:99], v[12:13], v[74:75] op_sel_hi:[1,0,1] neg_lo:[0,1,0] neg_hi:[0,1,0]
    v_rcp_f32 v110, v110
    v_cvt_pk_bf16_f32 v87, v86, v87
    v_cvt_pk_bf16_f32 v86, v84, v85
    buffer_load_dwordx4 v9, s[44:47], s32 offen offset:1024 sc1 lds
    v_rcp_f32 v111, v111
    v_pk_mul_f32 v[104:105], v[72:73], v[72:73]
    v_exp_f32 v112, v112
    v_pk_mul_f32 v[106:107], v[74:75], v[74:75]
    v_exp_f32 v113, v113
    v_pk_fma_f32 v[104:105], v[104:105], v[16:17], v[16:17] op_sel:[0,0,1] op_sel_hi:[1,0,1]
    buffer_load_dwordx4 v9, s[44:47], s32 offen offset:2048 sc1 lds
    v_exp_f32 v114, v114
    v_pk_fma_f32 v[106:107], v[106:107], v[16:17], v[16:17] op_sel:[0,0,1] op_sel_hi:[1,0,1]
    v_exp_f32 v115, v115
    v_pk_mul_f32 v[104:105], v[104:105], v[72:73]
    v_pk_mul_f32 v[106:107], v[106:107], v[74:75]
    buffer_load_dwordx4 v9, s[44:47], s32 offen offset:3072 sc1 lds
    v_pk_fma_f32 v[112:113], v[112:113], v[14:15], v[14:15] op_sel:[0,1,1] op_sel_hi:[1,1,1]
    v_pk_fma_f32 v[114:115], v[114:115], v[14:15], v[14:15] op_sel:[0,1,1] op_sel_hi:[1,1,1]
    v_rcp_f32 v112, v112
    v_pk_mul_f32 v[80:81], v[80:81], v[108:109]
    v_pk_mul_f32 v[82:83], v[82:83], v[110:111]
    v_rcp_f32 v113, v113
    v_pk_fma_f32 v[68:69], v[92:93], v[14:15], v[68:69] op_sel_hi:[1,0,1] neg_lo:[0,1,0] neg_hi:[0,1,0]
    v_pk_fma_f32 v[70:71], v[94:95], v[14:15], v[70:71] op_sel_hi:[1,0,1] neg_lo:[0,1,0] neg_hi:[0,1,0]
    v_rcp_f32 v114, v114
    v_cvt_pk_bf16_f32 v85, v82, v83
    v_cvt_pk_bf16_f32 v84, v80, v81
    s_add_u32 s30, s30, 0x4000
    s_and_b32 s30, s30, 0x1c000
    s_add_u32 s32, s101, s30
    s_add_u32 m0, s33, 32768
    s_nop 0
    buffer_load_dwordx4 v9, s[44:47], s32 offen offset:0 sc1 lds
    v_rcp_f32 v115, v115
    v_pk_mul_f32 v[108:109], v[68:69], v[68:69]
    v_exp_f32 v104, v104
    v_pk_mul_f32 v[110:111], v[70:71], v[70:71]
    v_exp_f32 v105, v105
    v_pk_fma_f32 v[108:109], v[108:109], v[18:19], v[18:19] op_sel:[0,0,1] op_sel_hi:[1,0,1]
    buffer_load_dwordx4 v9, s[44:47], s32 offen offset:1024 sc1 lds
    v_exp_f32 v106, v106
    v_pk_fma_f32 v[110:111], v[110:111], v[18:19], v[18:19] op_sel:[0,0,1] op_sel_hi:[1,0,1]
    v_exp_f32 v107, v107
    v_pk_mul_f32 v[108:109], v[108:109], v[68:69]
    v_pk_mul_f32 v[110:111], v[110:111], v[70:71]
    buffer_load_dwordx4 v9, s[44:47], s32 offen offset:2048 sc1 lds
    v_pk_fma_f32 v[104:105], v[104:105], v[12:13], v[12:13] op_sel:[0,1,1] op_sel_hi:[1,1,1]
    v_pk_fma_f32 v[106:107], v[106:107], v[12:13], v[12:13] op_sel:[0,1,1] op_sel_hi:[1,1,1]
    v_rcp_f32 v104, v104
    v_pk_mul_f32 v[76:77], v[76:77], v[112:113]
    v_pk_mul_f32 v[78:79], v[78:79], v[114:115]
    v_rcp_f32 v105, v105
    v_pk_fma_f32 v[64:65], v[92:93], v[12:13], v[64:65] op_sel_hi:[1,0,1] neg_lo:[0,1,0] neg_hi:[0,1,0]
    v_pk_fma_f32 v[66:67], v[94:95], v[12:13], v[66:67] op_sel_hi:[1,0,1] neg_lo:[0,1,0] neg_hi:[0,1,0]
    v_rcp_f32 v106, v106
    v_cvt_pk_bf16_f32 v83, v78, v79
    v_cvt_pk_bf16_f32 v82, v76, v77
    buffer_load_dwordx4 v9, s[44:47], s32 offen offset:3072 sc1 lds
    v_rcp_f32 v107, v107
    v_pk_mul_f32 v[112:113], v[64:65], v[64:65]
    v_exp_f32 v108, v108
    v_pk_mul_f32 v[114:115], v[66:67], v[66:67]
    v_exp_f32 v109, v109
    v_pk_fma_f32 v[112:113], v[112:113], v[16:17], v[16:17] op_sel:[0,0,1] op_sel_hi:[1,0,1]
    v_exp_f32 v110, v110
    v_pk_fma_f32 v[114:115], v[114:115], v[16:17], v[16:17] op_sel:[0,0,1] op_sel_hi:[1,0,1]
    v_exp_f32 v111, v111
    v_pk_mul_f32 v[112:113], v[112:113], v[64:65]
    v_pk_mul_f32 v[114:115], v[114:115], v[66:67]
    v_pk_fma_f32 v[108:109], v[108:109], v[14:15], v[14:15] op_sel:[0,1,1] op_sel_hi:[1,1,1]
    v_pk_fma_f32 v[110:111], v[110:111], v[14:15], v[14:15] op_sel:[0,1,1] op_sel_hi:[1,1,1]
    v_rcp_f32 v108, v108
    v_pk_mul_f32 v[72:73], v[72:73], v[104:105]
    v_pk_mul_f32 v[74:75], v[74:75], v[106:107]
    v_rcp_f32 v109, v109
    v_pk_fma_f32 v[60:61], v[88:89], v[14:15], v[60:61] op_sel_hi:[1,0,1] neg_lo:[0,1,0] neg_hi:[0,1,0]
    v_pk_fma_f32 v[62:63], v[90:91], v[14:15], v[62:63] op_sel_hi:[1,0,1] neg_lo:[0,1,0] neg_hi:[0,1,0]
    v_rcp_f32 v110, v110
    v_cvt_pk_bf16_f32 v81, v74, v75
    v_cvt_pk_bf16_f32 v80, v72, v73
    v_rcp_f32 v111, v111
    v_pk_mul_f32 v[104:105], v[60:61], v[60:61]
    v_exp_f32 v112, v112
    v_pk_mul_f32 v[106:107], v[62:63], v[62:63]
    v_exp_f32 v113, v113
    v_pk_fma_f32 v[104:105], v[104:105], v[18:19], v[18:19] op_sel:[0,0,1] op_sel_hi:[1,0,1]
    v_exp_f32 v114, v114
    v_pk_fma_f32 v[106:107], v[106:107], v[18:19], v[18:19] op_sel:[0,0,1] op_sel_hi:[1,0,1]
    v_exp_f32 v115, v115
    v_pk_mul_f32 v[104:105], v[104:105], v[60:61]
    v_pk_mul_f32 v[106:107], v[106:107], v[62:63]
    v_pk_fma_f32 v[112:113], v[112:113], v[12:13], v[12:13] op_sel:[0,1,1] op_sel_hi:[1,1,1]
    v_pk_fma_f32 v[114:115], v[114:115], v[12:13], v[12:13] op_sel:[0,1,1] op_sel_hi:[1,1,1]
    v_rcp_f32 v112, v112
    v_pk_mul_f32 v[68:69], v[68:69], v[108:109]
    v_pk_mul_f32 v[70:71], v[70:71], v[110:111]
    v_rcp_f32 v113, v113
    v_pk_fma_f32 v[56:57], v[88:89], v[12:13], v[56:57] op_sel_hi:[1,0,1] neg_lo:[0,1,0] neg_hi:[0,1,0]
    v_pk_fma_f32 v[58:59], v[90:91], v[12:13], v[58:59] op_sel_hi:[1,0,1] neg_lo:[0,1,0] neg_hi:[0,1,0]
    v_rcp_f32 v114, v114
    v_cvt_pk_bf16_f32 v79, v70, v71
    v_cvt_pk_bf16_f32 v78, v68, v69
    v_rcp_f32 v115, v115
    v_pk_mul_f32 v[108:109], v[56:57], v[56:57]
    v_exp_f32 v104, v104
    v_pk_mul_f32 v[110:111], v[58:59], v[58:59]
    v_exp_f32 v105, v105
    v_pk_fma_f32 v[108:109], v[108:109], v[16:17], v[16:17] op_sel:[0,0,1] op_sel_hi:[1,0,1]
    v_exp_f32 v106, v106
    v_pk_fma_f32 v[110:111], v[110:111], v[16:17], v[16:17] op_sel:[0,0,1] op_sel_hi:[1,0,1]
    v_exp_f32 v107, v107
    v_pk_mul_f32 v[108:109], v[108:109], v[56:57]
    v_pk_mul_f32 v[110:111], v[110:111], v[58:59]
    v_pk_fma_f32 v[104:105], v[104:105], v[14:15], v[14:15] op_sel:[0,1,1] op_sel_hi:[1,1,1]
    v_pk_fma_f32 v[106:107], v[106:107], v[14:15], v[14:15] op_sel:[0,1,1] op_sel_hi:[1,1,1]
    v_rcp_f32 v104, v104
    v_pk_mul_f32 v[64:65], v[64:65], v[112:113]
    v_rcp_f32 v105, v105
    v_pk_mul_f32 v[66:67], v[66:67], v[114:115]
    v_rcp_f32 v106, v106
    v_cvt_pk_bf16_f32 v77, v66, v67
    v_rcp_f32 v107, v107
    v_cvt_pk_bf16_f32 v76, v64, v65
    v_exp_f32 v108, v108
    v_exp_f32 v109, v109
    v_exp_f32 v110, v110
    v_exp_f32 v111, v111
    v_pk_fma_f32 v[108:109], v[108:109], v[12:13], v[12:13] op_sel:[0,1,1] op_sel_hi:[1,1,1]
    v_pk_fma_f32 v[110:111], v[110:111], v[12:13], v[12:13] op_sel:[0,1,1] op_sel_hi:[1,1,1]
    v_rcp_f32 v108, v108
    v_pk_mul_f32 v[60:61], v[60:61], v[104:105]
    v_rcp_f32 v109, v109
    v_pk_mul_f32 v[62:63], v[62:63], v[106:107]
    v_rcp_f32 v110, v110
    v_cvt_pk_bf16_f32 v75, v62, v63
    v_rcp_f32 v111, v111
    v_cvt_pk_bf16_f32 v74, v60, v61
    v_pk_mul_f32 v[56:57], v[56:57], v[108:109]
    v_pk_mul_f32 v[58:59], v[58:59], v[110:111]
    v_cvt_pk_bf16_f32 v73, v58, v59
    v_cvt_pk_bf16_f32 v72, v56, v57
    s_add_u32 s36, s26, 0xd80000
    s_addc_u32 s37, s27, 0
    s_mov_b32 s38, 0x380000
    s_mov_b32 s39, 0x20000
    s_add_u32 s16, s26, 0x500000
    s_addc_u32 s17, s27, 0
    s_mov_b32 s18, 0xc4000
    s_mov_b32 s19, 0x20000
    s_cmp_ge_u32 s11, 7
    s_cselect_b32 s5, 7, 0
    s_cselect_b32 s6, 1, 0
    s_sub_u32 s7, s11, s5
    s_lshl_b32 s5, s10, 1
    s_add_u32 s6, s6, s5
    s_lshr_b32 s24, s4, 1
    s_and_b32 s25, s4, 1
    s_mul_i32 s28, s4, 7
    s_xor_b32 s5, s24, 0
    s_lshl_b32 s29, s6, 1
    s_add_u32 s5, s5, s29
    s_mov_b32 s48, s5
    s_mul_i32 s5, s5, 56
    s_add_u32 s5, s5, s28
    s_lshl_b32 s40, s5, 10
    s_xor_b32 s5, s25, 0
    s_lshl_b32 s29, s7, 1
    s_add_u32 s5, s5, s29
    s_mov_b32 s51, s5
    s_mul_i32 s5, s5, 56
    s_add_u32 s5, s5, s28
    s_lshl_b32 s42, s5, 10
    s_xor_b32 s5, s24, 1
    s_lshl_b32 s29, s6, 1
    s_add_u32 s5, s5, s29
    s_mul_i32 s5, s5, 56
    s_add_u32 s5, s5, s28
    s_lshl_b32 s41, s5, 10
    s_xor_b32 s5, s25, 1
    s_lshl_b32 s29, s7, 1
    s_add_u32 s5, s5, s29
    s_mul_i32 s5, s5, 56
    s_add_u32 s5, s5, s28
    s_lshl_b32 s43, s5, 10
    s_mul_i32 s52, s48, 28672
    s_lshl_b32 s5, s51, 11
    s_add_u32 s52, s52, s5
    v_and_b32 v6, 31, v1
    v_lshrrev_b32 v7, 5, v1
    v_lshlrev_b32 v8, 6, v6
    v_lshl_add_u32 v8, v7, 4, v8
    s_lshr_b32 s53, s21, 17
    s_mul_i32 s53, s53, 56
    s_lshl_b32 s5, s11, 1
    s_add_u32 s53, s53, s5
    s_lshl_b32 s53, s53, 10
    s_waitcnt vmcnt(8)
    ds_read2st64_b32 v[56:57], v4 offset0:0 offset1:4
    ds_read2st64_b32 v[58:59], v4 offset0:8 offset1:12
    s_waitcnt lgkmcnt(0)
    v_max3_u32 v60, v56, v57, v58
    v_max_u32 v60, v60, v59
    v_cmp_eq_u32 vcc, -1, v60
    s_cbranch_vccnz fz_rz0
fz_bz0:
    s_barrier
    ds_read_b128 v[24:27], v2 offset:0
    ds_read_b128 v[28:31], v2 offset:1024
    ds_read_b128 v[32:35], v2 offset:2048
    ds_read_b128 v[36:39], v2 offset:3072
    v_and_b32 v16, 3, v1
    v_lshlrev_b32 v16, 7, v16
    s_cmp_ge_u32 s11, 7
    s_cselect_b32 s5, 4096, 0
    s_cselect_b32 s7, -7, 7
    s_lshl_b32 s7, s7, 14
    s_add_u32 s5, s5, 396800
    s_lshl_b32 s29, s10, 13
    s_add_u32 s5, s5, s29
    v_add_u32 v16, s5, v16
    s_add_u32 s85, s84, s7
    s_add_u32 s7, s84, 4096
    s_add_u32 s100, s85, 4096
    s_lshl_b32 s5, s10, 13
    s_add_u32 s5, s5, 786432
    v_min_u32 v18, 55, v1
    v_lshlrev_b32 v18, 7, v18
    v_add_u32 v18, s5, v18
    s_waitcnt lgkmcnt(3)
    v_mfma_f32_16x16x32_bf16 v[128:131], v[24:27], a[0:3], 0
    s_add_u32 s30, s30, 0x4000
    s_and_b32 s30, s30, 0x1c000
    s_add_u32 s32, s101, s30
    s_add_u32 m0, s33, 49152
    s_nop 0
    buffer_load_dwordx4 v9, s[44:47], s32 offen offset:0 sc1 lds
    ds_read_b128 v[40:43], v2 offset:4096
    v_mfma_f32_16x16x32_bf16 v[132:135], v[24:27], a[4:7], 0
    ds_read_b128 v[44:47], v2 offset:5120
    s_waitcnt lgkmcnt(4)
    v_mfma_f32_16x16x32_bf16 v[136:139], v[28:31], a[0:3], 0
    ds_read_b128 v[48:51], v2 offset:6144
    v_mfma_f32_16x16x32_bf16 v[140:143], v[28:31], a[4:7], 0
    ds_read_b128 v[52:55], v2 offset:7168
    s_waitcnt lgkmcnt(5)
    v_mfma_f32_16x16x32_bf16 v[144:147], v[32:35], a[0:3], 0
    buffer_load_dwordx4 v9, s[44:47], s32 offen offset:1024 sc1 lds
    v_mov_b32 v88, v20
    v_mfma_f32_16x16x32_bf16 v[148:151], v[32:35], a[4:7], 0
    v_mov_b32 v89, v20
    s_waitcnt lgkmcnt(4)
    v_mfma_f32_16x16x32_bf16 v[152:155], v[36:39], a[0:3], 0
    v_mov_b32 v90, v20
    v_mfma_f32_16x16x32_bf16 v[156:159], v[36:39], a[4:7], 0
    s_waitcnt lgkmcnt(3)
    v_mfma_f32_16x16x32_bf16 v[128:131], v[40:43], a[8:11], v[128:131]
    buffer_load_dwordx4 v9, s[44:47], s32 offen offset:2048 sc1 lds
    ds_read_b128 v[24:27], v2 offset:8192
    v_mfma_f32_16x16x32_bf16 v[132:135], v[40:43], a[12:15], v[132:135]
    ds_read_b128 v[28:31], v2 offset:9216
    s_waitcnt lgkmcnt(4)
    v_mfma_f32_16x16x32_bf16 v[136:139], v[44:47], a[8:11], v[136:139]
    ds_read_b128 v[32:35], v2 offset:10240
    v_mfma_f32_16x16x32_bf16 v[140:143], v[44:47], a[12:15], v[140:143]
    ds_read_b128 v[36:39], v2 offset:11264
    s_waitcnt lgkmcnt(5)
    v_mfma_f32_16x16x32_bf16 v[144:147], v[48:51], a[8:11], v[144:147]
    buffer_load_dwordx4 v9, s[44:47], s32 offen offset:3072 sc1 lds
    s_waitcnt vmcnt(8)
    v_mfma_f32_16x16x32_bf16 v[148:151], v[48:51], a[12:15], v[148:151]
    ds_read2st64_b32 v[56:57], v4 offset0:64 offset1:68
    s_waitcnt lgkmcnt(5)
    v_mfma_f32_16x16x32_bf16 v[152:155], v[52:55], a[8:11], v[152:155]
    ds_read2st64_b32 v[58:59], v4 offset0:72 offset1:76
    v_mfma_f32_16x16x32_bf16 v[156:159], v[52:55], a[12:15], v[156:159]
    s_waitcnt lgkmcnt(5)
    v_mfma_f32_16x16x32_bf16 v[128:131], v[24:27], a[16:19], v[128:131]
    s_add_u32 s30, s30, 0x4000
    s_and_b32 s30, s30, 0x1c000
    s_add_u32 s32, s101, s30
    s_add_u32 m0, s33, 65536
    s_nop 0
    buffer_load_dwordx4 v9, s[44:47], s32 offen offset:0 sc1 lds
    ds_read_b128 v[40:43], v2 offset:12288
    ds_read_b128 v[44:47], v2 offset:13312
    v_mfma_f32_16x16x32_bf16 v[132:135], v[24:27], a[20:23], v[132:135]
    ds_read_b128 v[48:51], v2 offset:14336
    s_waitcnt lgkmcnt(7)
    v_mfma_f32_16x16x32_bf16 v[136:139], v[28:31], a[16:19], v[136:139]
    ds_read_b128 v[52:55], v2 offset:15360
    v_mfma_f32_16x16x32_bf16 v[140:143], v[28:31], a[20:23], v[140:143]
    s_waitcnt lgkmcnt(4)
    v_max3_u32 v60, v56, v57, v58
    v_mfma_f32_16x16x32_bf16 v[144:147], v[32:35], a[16:19], v[144:147]
    buffer_load_dwordx4 v9, s[44:47], s32 offen offset:1024 sc1 lds
    v_max_u32 v60, v60, v59
    v_mfma_f32_16x16x32_bf16 v[148:151], v[32:35], a[20:23], v[148:151]
    v_cmp_eq_u32 vcc, -1, v60
    v_mfma_f32_16x16x32_bf16 v[152:155], v[36:39], a[16:19], v[152:155]
    s_cbranch_vccnz fz_rz1
fz_bz1:
    v_mfma_f32_16x16x32_bf16 v[156:159], v[36:39], a[20:23], v[156:159]
    s_barrier
    s_waitcnt lgkmcnt(3)
    v_mfma_f32_16x16x32_bf16 v[128:131], v[40:43], a[24:27], v[128:131]
    buffer_load_dwordx4 v9, s[44:47], s32 offen offset:2048 sc1 lds
    ds_read_b128 v[24:27], v2 offset:16384
    v_mfma_f32_16x16x32_bf16 v[132:135], v[40:43], a[28:31], v[132:135]
    ds_read_b128 v[28:31], v2 offset:17408
    s_waitcnt lgkmcnt(4)
    v_mfma_f32_16x16x32_bf16 v[136:139], v[44:47], a[24:27], v[136:139]
    ds_read_b128 v[32:35], v2 offset:18432
    v_mfma_f32_16x16x32_bf16 v[140:143], v[44:47], a[28:31], v[140:143]
    ds_read_b128 v[36:39], v2 offset:19456
    s_waitcnt lgkmcnt(5)
    v_mfma_f32_16x16x32_bf16 v[144:147], v[48:51], a[24:27], v[144:147]
    buffer_load_dwordx4 v9, s[44:47], s32 offen offset:3072 sc1 lds
    v_mov_b32 v91, v20
    v_mfma_f32_16x16x32_bf16 v[148:151], v[48:51], a[28:31], v[148:151]
    v_mov_b32 v92, v21
    s_waitcnt lgkmcnt(4)
    v_mfma_f32_16x16x32_bf16 v[152:155], v[52:55], a[24:27], v[152:155]
    v_mov_b32 v93, v21
    v_mfma_f32_16x16x32_bf16 v[156:159], v[52:55], a[28:31], v[156:159]
    s_waitcnt lgkmcnt(3)
    v_mfma_f32_16x16x32_bf16 v[128:131], v[24:27], a[32:35], v[128:131]
    s_add_u32 m0, s86, 4096
    s_add_u32 s22, s23, 0x10080
    buffer_load_dwordx4 v254, s[12:15], s22 offen lds
    ds_read_b128 v[40:43], v2 offset:20480
    v_mfma_f32_16x16x32_bf16 v[132:135], v[24:27], a[36:39], v[132:135]
    ds_read_b128 v[44:47], v2 offset:21504
    s_waitcnt lgkmcnt(4)
    v_mfma_f32_16x16x32_bf16 v[136:139], v[28:31], a[32:35], v[136:139]
    ds_read_b128 v[48:51], v2 offset:22528
    v_mfma_f32_16x16x32_bf16 v[140:143], v[28:31], a[36:39], v[140:143]
    ds_read_b128 v[52:55], v2 offset:23552
    s_waitcnt lgkmcnt(5)
    v_mfma_f32_16x16x32_bf16 v[144:147], v[32:35], a[32:35], v[144:147]
    buffer_load_dwordx4 v255, s[12:15], s22 offen offset:1024 lds
    v_mov_b32 v94, v21
    v_mfma_f32_16x16x32_bf16 v[148:151], v[32:35], a[36:39], v[148:151]
    v_mov_b32 v95, v21
    s_waitcnt lgkmcnt(4)
    v_mfma_f32_16x16x32_bf16 v[152:155], v[36:39], a[32:35], v[152:155]
    v_mov_b32 v96, v20
    v_mfma_f32_16x16x32_bf16 v[156:159], v[36:39], a[36:39], v[156:159]
    s_waitcnt lgkmcnt(3)
    v_mfma_f32_16x16x32_bf16 v[128:131], v[40:43], a[40:43], v[128:131]
    s_add_u32 m0, s86, 6144
    s_add_u32 s20, s20, 0x100
    s_and_b32 s20, s20, 0x700
    s_add_u32 s23, s87, s20
    s_add_u32 s22, s23, 0x0
    buffer_load_dwordx4 v254, s[12:15], s22 offen lds
    ds_read_b128 v[24:27], v2 offset:24576
    v_mfma_f32_16x16x32_bf16 v[132:135], v[40:43], a[44:47], v[132:135]
    ds_read_b128 v[28:31], v2 offset:25600
    s_waitcnt lgkmcnt(4)
    v_mfma_f32_16x16x32_bf16 v[136:139], v[44:47], a[40:43], v[136:139]
    ds_read_b128 v[32:35], v2 offset:26624
    v_mfma_f32_16x16x32_bf16 v[140:143], v[44:47], a[44:47], v[140:143]
    ds_read_b128 v[36:39], v2 offset:27648
    s_waitcnt lgkmcnt(5)
    v_mfma_f32_16x16x32_bf16 v[144:147], v[48:51], a[40:43], v[144:147]
    buffer_load_dwordx4 v255, s[12:15], s22 offen offset:1024 lds
    s_waitcnt vmcnt(12)
    v_mfma_f32_16x16x32_bf16 v[148:151], v[48:51], a[44:47], v[148:151]
    ds_read2st64_b32 v[56:57], v4 offset0:128 offset1:132
    s_waitcnt lgkmcnt(5)
    v_mfma_f32_16x16x32_bf16 v[152:155], v[52:55], a[40:43], v[152:155]
    ds_read2st64_b32 v[58:59], v4 offset0:136 offset1:140
    v_mfma_f32_16x16x32_bf16 v[156:159], v[52:55], a[44:47], v[156:159]
    s_waitcnt lgkmcnt(5)
    v_mfma_f32_16x16x32_bf16 v[128:131], v[24:27], a[48:51], v[128:131]
    s_add_u32 m0, s86, 8192
    s_add_u32 s22, s23, 0x10000
    buffer_load_dwordx4 v254, s[12:15], s22 offen lds
    ds_read_b128 v[40:43], v2 offset:28672
    ds_read_b128 v[44:47], v2 offset:29696
    v_mfma_f32_16x16x32_bf16 v[132:135], v[24:27], a[52:55], v[132:135]
    ds_read_b128 v[48:51], v2 offset:30720
    s_waitcnt lgkmcnt(7)
    v_mfma_f32_16x16x32_bf16 v[136:139], v[28:31], a[48:51], v[136:139]
    ds_read_b128 v[52:55], v2 offset:31744
    v_mfma_f32_16x16x32_bf16 v[140:143], v[28:31], a[52:55], v[140:143]
    s_waitcnt lgkmcnt(4)
    v_max3_u32 v60, v56, v57, v58
    v_mfma_f32_16x16x32_bf16 v[144:147], v[32:35], a[48:51], v[144:147]
    buffer_load_dwordx4 v255, s[12:15], s22 offen offset:1024 lds
    v_max_u32 v60, v60, v59
    v_mfma_f32_16x16x32_bf16 v[148:151], v[32:35], a[52:55], v[148:151]
    v_cmp_eq_u32 vcc, -1, v60
    v_mfma_f32_16x16x32_bf16 v[152:155], v[36:39], a[48:51], v[152:155]
    s_cbranch_vccnz fz_rz2
fz_bz2:
    v_mfma_f32_16x16x32_bf16 v[156:159], v[36:39], a[52:55], v[156:159]
    s_barrier
    s_waitcnt lgkmcnt(3)
    v_mfma_f32_16x16x32_bf16 v[128:131], v[40:43], a[56:59], v[128:131]
    s_add_u32 s30, s30, 0x4000
    s_and_b32 s30, s30, 0x1c000
    s_add_u32 s32, s101, s30
    s_add_u32 m0, s33, 81920
    s_nop 0
    buffer_load_dwordx4 v9, s[44:47], s32 offen offset:0 sc1 lds
    ds_read_b128 v[24:27], v2 offset:32768
    v_mfma_f32_16x16x32_bf16 v[132:135], v[40:43], a[60:63], v[132:135]
    ds_read_b128 v[28:31], v2 offset:33792
    s_waitcnt lgkmcnt(4)
    v_mfma_f32_16x16x32_bf16 v[136:139], v[44:47], a[56:59], v[136:139]
    ds_read_b128 v[32:35], v2 offset:34816
    v_mfma_f32_16x16x32_bf16 v[140:143], v[44:47], a[60:63], v[140:143]
    ds_read_b128 v[36:39], v2 offset:35840
    s_waitcnt lgkmcnt(5)
    v_mfma_f32_16x16x32_bf16 v[144:147], v[48:51], a[56:59], v[144:147]
    buffer_load_dwordx4 v9, s[44:47], s32 offen offset:1024 sc1 lds
    v_mov_b32 v97, v20
    v_mfma_f32_16x16x32_bf16 v[148:151], v[48:51], a[60:63], v[148:151]
    v_mov_b32 v98, v20
    s_waitcnt lgkmcnt(4)
    v_mfma_f32_16x16x32_bf16 v[152:155], v[52:55], a[56:59], v[152:155]
    v_mov_b32 v99, v20
    v_mfma_f32_16x16x32_bf16 v[156:159], v[52:55], a[60:63], v[156:159]
    s_waitcnt lgkmcnt(3)
    v_mfma_f32_16x16x32_bf16 v[128:131], v[24:27], a[64:67], v[128:131]
    buffer_load_dwordx4 v9, s[44:47], s32 offen offset:2048 sc1 lds
    ds_read_b128 v[40:43], v2 offset:36864
    ds_read_b128 v[44:47], v2 offset:37888
    v_mfma_f32_16x16x32_bf16 v[132:135], v[24:27], a[68:71], v[132:135]
    ds_read_b128 v[48:51], v2 offset:38912
    ds_read_b128 v[52:55], v2 offset:39936
    s_waitcnt lgkmcnt(6)
    v_mfma_f32_16x16x32_bf16 v[136:139], v[28:31], a[64:67], v[136:139]
    s_waitcnt vmcnt(7)
    v_mfma_f32_16x16x32_bf16 v[140:143], v[28:31], a[68:71], v[140:143]
    ds_read_b128 a[148:151], v23 offset:4096
    s_waitcnt lgkmcnt(6)
    v_mfma_f32_16x16x32_bf16 v[144:147], v[32:35], a[64:67], v[144:147]
    buffer_load_dwordx4 v9, s[44:47], s32 offen offset:3072 sc1 lds
    ds_read_b128 a[156:159], v124 offset:4096
    v_mfma_f32_16x16x32_bf16 v[148:151], v[32:35], a[68:71], v[148:151]
    v_mov_b32 v100, v21
    s_waitcnt lgkmcnt(6)
    v_mfma_f32_16x16x32_bf16 v[152:155], v[36:39], a[64:67], v[152:155]
    v_mov_b32 v101, v21
    v_mfma_f32_16x16x32_bf16 v[156:159], v[36:39], a[68:71], v[156:159]
    v_mov_b32 v102, v21
    s_waitcnt lgkmcnt(5)
    v_mfma_f32_16x16x32_bf16 v[128:131], v[40:43], a[72:75], v[128:131]
    s_add_u32 m0, s86, 10240
    s_add_u32 s22, s23, 0x80
    buffer_load_dwordx4 v254, s[12:15], s22 offen lds
    ds_read_b128 v[24:27], v2 offset:40960
    ds_read_b128 v[28:31], v2 offset:41984
    v_mfma_f32_16x16x32_bf16 v[132:135], v[40:43], a[76:79], v[132:135]
    ds_read_b128 v[32:35], v2 offset:43008
    ds_read_b128 v[36:39], v2 offset:44032
    s_waitcnt lgkmcnt(8)
    v_mfma_f32_16x16x32_bf16 v[136:139], v[44:47], a[72:75], v[136:139]
    s_waitcnt vmcnt(7)
    v_mfma_f32_16x16x32_bf16 v[140:143], v[44:47], a[76:79], v[140:143]
    ds_read_b128 a[160:163], v23 offset:6144
    s_waitcnt lgkmcnt(8)
    v_mfma_f32_16x16x32_bf16 v[144:147], v[48:51], a[72:75], v[144:147]
    buffer_load_dwordx4 v255, s[12:15], s22 offen offset:1024 lds
    ds_read_b128 a[168:171], v124 offset:6144
    v_mfma_f32_16x16x32_bf16 v[148:151], v[48:51], a[76:79], v[148:151]
    s_waitcnt lgkmcnt(8)
    v_mfma_f32_16x16x32_bf16 v[152:155], v[52:55], a[72:75], v[152:155]
    ds_read2st64_b32 v[56:57], v4 offset0:192 offset1:196
    v_mfma_f32_16x16x32_bf16 v[156:159], v[52:55], a[76:79], v[156:159]
    ds_read2st64_b32 v[58:59], v4 offset0:200 offset1:204
    s_waitcnt lgkmcnt(7)
    v_mfma_f32_16x16x32_bf16 v[128:131], v[24:27], a[80:83], v[128:131]
    s_add_u32 m0, s86, 0
    s_add_u32 s22, s23, 0x10080
    buffer_load_dwordx4 v254, s[12:15], s22 offen lds
    ds_read_b128 v[40:43], v2 offset:45056
    ds_read_b128 v[44:47], v2 offset:46080
    v_mfma_f32_16x16x32_bf16 v[132:135], v[24:27], a[84:87], v[132:135]
    ds_read_b128 v[48:51], v2 offset:47104
    ds_read_b128 v[52:55], v2 offset:48128
    s_waitcnt lgkmcnt(10)
    v_mfma_f32_16x16x32_bf16 v[136:139], v[28:31], a[80:83], v[136:139]
    s_waitcnt vmcnt(7)
    ds_read_b128 a[164:167], v23 offset:8192
    v_mfma_f32_16x16x32_bf16 v[140:143], v[28:31], a[84:87], v[140:143]
    ds_read_b128 a[172:175], v124 offset:8192
    s_waitcnt lgkmcnt(6)
    v_max3_u32 v60, v56, v57, v58
    v_mfma_f32_16x16x32_bf16 v[144:147], v[32:35], a[80:83], v[144:147]
    buffer_load_dwordx4 v255, s[12:15], s22 offen offset:1024 lds
    v_max_u32 v60, v60, v59
    v_mfma_f32_16x16x32_bf16 v[148:151], v[32:35], a[84:87], v[148:151]
    v_cmp_eq_u32 vcc, -1, v60
    v_mfma_f32_16x16x32_bf16 v[152:155], v[36:39], a[80:83], v[152:155]
    s_cbranch_vccnz fz_rz3
fz_bz3:
    v_mfma_f32_16x16x32_bf16 v[156:159], v[36:39], a[84:87], v[156:159]
    s_barrier
    s_waitcnt lgkmcnt(5)
    v_mfma_f32_16x16x32_bf16 v[128:131], v[40:43], a[88:91], v[128:131]
    s_add_u32 m0, s86, 2048
    s_add_u32 s20, s20, 0x100
    s_and_b32 s20, s20, 0x700
    s_add_u32 s23, s87, s20
    s_add_u32 s22, s23, 0x0
    buffer_load_dwordx4 v254, s[12:15], s22 offen lds
    ds_read_b128 v[24:27], v2 offset:49152
    v_mfma_f32_16x16x32_bf16 v[132:135], v[40:43], a[92:95], v[132:135]
    ds_read_b128 v[28:31], v2 offset:50176
    s_waitcnt lgkmcnt(6)
    v_mfma_f32_16x16x32_bf16 v[136:139], v[44:47], a[88:91], v[136:139]
    ds_read_b128 v[32:35], v2 offset:51200
    v_mfma_f32_16x16x32_bf16 v[140:143], v[44:47], a[92:95], v[140:143]
    ds_read_b128 v[36:39], v2 offset:52224
    s_waitcnt lgkmcnt(7)
    v_mfma_f32_16x16x32_bf16 v[144:147], v[48:51], a[88:91], v[144:147]
    buffer_load_dwordx4 v255, s[12:15], s22 offen offset:1024 lds
    v_mov_b32 v103, v21
    v_mfma_f32_16x16x32_bf16 v[148:151], v[48:51], a[92:95], v[148:151]
    v_mov_b32 v104, v20
    s_waitcnt lgkmcnt(6)
    v_mfma_f32_16x16x32_bf16 v[152:155], v[52:55], a[88:91], v[152:155]
    v_mov_b32 v105, v20
    v_mfma_f32_16x16x32_bf16 v[156:159], v[52:55], a[92:95], v[156:159]
    s_waitcnt lgkmcnt(3)
    v_mfma_f32_16x16x32_bf16 v[128:131], v[24:27], a[96:99], v[128:131]
    s_add_u32 m0, s86, 4096
    s_add_u32 s22, s23, 0x10000
    buffer_load_dwordx4 v254, s[12:15], s22 offen lds
    ds_read_b128 v[40:43], v2 offset:53248
    v_mfma_f32_16x16x32_bf16 v[132:135], v[24:27], a[100:103], v[132:135]
    ds_read_b128 v[44:47], v2 offset:54272
    s_waitcnt lgkmcnt(4)
    v_mfma_f32_16x16x32_bf16 v[136:139], v[28:31], a[96:99], v[136:139]
    ds_read_b128 v[48:51], v2 offset:55296
    v_mfma_f32_16x16x32_bf16 v[140:143], v[28:31], a[100:103], v[140:143]
    ds_read_b128 v[52:55], v2 offset:56320
    s_waitcnt lgkmcnt(5)
    v_mfma_f32_16x16x32_bf16 v[144:147], v[32:35], a[96:99], v[144:147]
    buffer_load_dwordx4 v255, s[12:15], s22 offen offset:1024 lds
    v_mov_b32 v106, v20
    v_mfma_f32_16x16x32_bf16 v[148:151], v[32:35], a[100:103], v[148:151]
    v_mov_b32 v107, v20
    s_waitcnt lgkmcnt(4)
    v_mfma_f32_16x16x32_bf16 v[152:155], v[36:39], a[96:99], v[152:155]
    v_mov_b32 v108, v21
    v_mfma_f32_16x16x32_bf16 v[156:159], v[36:39], a[100:103], v[156:159]
    s_waitcnt lgkmcnt(3)
    v_mfma_f32_16x16x32_bf16 v[128:131], v[40:43], a[104:107], v[128:131]
    s_add_u32 s30, s30, 0x4000
    s_and_b32 s30, s30, 0x1c000
    s_add_u32 s32, s101, s30
    s_add_u32 m0, s33, 98304
    s_nop 0
    buffer_load_dwordx4 v9, s[44:47], s32 offen offset:0 sc1 lds
    ds_read_b128 v[24:27], v2 offset:57344
    ds_read_b128 v[28:31], v2 offset:58368
    v_mfma_f32_16x16x32_bf16 v[132:135], v[40:43], a[108:111], v[132:135]
    ds_read_b128 v[32:35], v2 offset:59392
    ds_read_b128 v[36:39], v2 offset:60416
    s_waitcnt lgkmcnt(6)
    v_mfma_f32_16x16x32_bf16 v[136:139], v[44:47], a[104:107], v[136:139]
    s_waitcnt vmcnt(7)
    v_mfma_f32_16x16x32_bf16 v[140:143], v[44:47], a[108:111], v[140:143]
    ds_read_b128 a[176:179], v23 offset:10240
    s_waitcnt lgkmcnt(6)
    v_mfma_f32_16x16x32_bf16 v[144:147], v[48:51], a[104:107], v[144:147]
    buffer_load_dwordx4 v9, s[44:47], s32 offen offset:1024 sc1 lds
    ds_read_b128 a[184:187], v124 offset:10240
    v_mfma_f32_16x16x32_bf16 v[148:151], v[48:51], a[108:111], v[148:151]
    s_waitcnt lgkmcnt(6)
    v_mfma_f32_16x16x32_bf16 v[152:155], v[52:55], a[104:107], v[152:155]
    ds_read2st64_b32 v[56:57], v5 offset0:0 offset1:4
    v_mfma_f32_16x16x32_bf16 v[156:159], v[52:55], a[108:111], v[156:159]
    ds_read2st64_b32 v[58:59], v5 offset0:8 offset1:12
    s_waitcnt lgkmcnt(7)
    v_mfma_f32_16x16x32_bf16 v[128:131], v[24:27], a[112:115], v[128:131]
    buffer_load_dwordx4 v9, s[44:47], s32 offen offset:2048 sc1 lds
    ds_read_b128 v[40:43], v2 offset:61440
    ds_read_b128 v[44:47], v2 offset:62464
    v_mfma_f32_16x16x32_bf16 v[132:135], v[24:27], a[116:119], v[132:135]
    ds_read_b128 v[48:51], v2 offset:63488
    ds_read_b128 v[52:55], v2 offset:64512
    s_waitcnt lgkmcnt(10)
    v_mfma_f32_16x16x32_bf16 v[136:139], v[28:31], a[112:115], v[136:139]
    s_waitcnt vmcnt(7)
    ds_read_b128 a[180:183], v23 offset:0
    v_mfma_f32_16x16x32_bf16 v[140:143], v[28:31], a[116:119], v[140:143]
    ds_read_b128 a[188:191], v124 offset:0
    s_waitcnt lgkmcnt(6)
    v_max3_u32 v60, v56, v57, v58
    v_mfma_f32_16x16x32_bf16 v[144:147], v[32:35], a[112:115], v[144:147]
    buffer_load_dwordx4 v9, s[44:47], s32 offen offset:3072 sc1 lds
    v_max_u32 v60, v60, v59
    v_mfma_f32_16x16x32_bf16 v[148:151], v[32:35], a[116:119], v[148:151]
    v_cmp_eq_u32 vcc, -1, v60
    v_mfma_f32_16x16x32_bf16 v[152:155], v[36:39], a[112:115], v[152:155]
    s_cbranch_vccnz fz_rz4
fz_bz4:
    v_mfma_f32_16x16x32_bf16 v[156:159], v[36:39], a[116:119], v[156:159]
    s_barrier
    s_waitcnt lgkmcnt(5)
    v_mfma_f32_16x16x32_bf16 v[128:131], v[40:43], a[120:123], v[128:131]
    s_add_u32 m0, s86, 6144
    s_add_u32 s22, s23, 0x80
    buffer_load_dwordx4 v254, s[12:15], s22 offen lds
    ds_read_b128 v[24:27], v3 offset:0
    ds_read_b128 v[28:31], v3 offset:1024
    v_mfma_f32_16x16x32_bf16 v[132:135], v[40:43], a[124:127], v[132:135]
    ds_read_b128 v[32:35], v3 offset:2048
    ds_read_b128 v[36:39], v3 offset:3072
    s_waitcnt lgkmcnt(8)
    v_mfma_f32_16x16x32_bf16 v[136:139], v[44:47], a[120:123], v[136:139]
    s_waitcnt vmcnt(7)
    v_mfma_f32_16x16x32_bf16 v[140:143], v[44:47], a[124:127], v[140:143]
    ds_read_b128 a[192:195], v23 offset:2048
    s_waitcnt lgkmcnt(8)
    v_mfma_f32_16x16x32_bf16 v[144:147], v[48:51], a[120:123], v[144:147]
    buffer_load_dwordx4 v255, s[12:15], s22 offen offset:1024 lds
    ds_read_b128 a[200:203], v124 offset:2048
    v_mfma_f32_16x16x32_bf16 v[148:151], v[48:51], a[124:127], v[148:151]
    v_mov_b32 v109, v21
    s_waitcnt lgkmcnt(8)
    v_mfma_f32_16x16x32_bf16 v[152:155], v[52:55], a[120:123], v[152:155]
    v_mov_b32 v110, v21
    v_mfma_f32_16x16x32_bf16 v[156:159], v[52:55], a[124:127], v[156:159]
    v_mov_b32 v111, v21
    s_waitcnt lgkmcnt(5)
    v_mfma_f32_16x16x32_bf16 v[128:131], v[24:27], a[128:131], v[128:131]
    s_add_u32 m0, s86, 8192
    s_add_u32 s22, s23, 0x10080
    buffer_load_dwordx4 v254, s[12:15], s22 offen lds
    ds_read_b128 v[40:43], v3 offset:4096
    ds_read_b128 v[44:47], v3 offset:5120
    v_mfma_f32_16x16x32_bf16 v[132:135], v[24:27], a[132:135], v[132:135]
    ds_read_b128 v[48:51], v3 offset:6144
    ds_read_b128 v[52:55], v3 offset:7168
    s_waitcnt lgkmcnt(8)
    v_mfma_f32_16x16x32_bf16 v[136:139], v[28:31], a[128:131], v[136:139]
    s_waitcnt vmcnt(7)
    v_mfma_f32_16x16x32_bf16 v[140:143], v[28:31], a[132:135], v[140:143]
    ds_read_b128 a[196:199], v23 offset:4096
    s_waitcnt lgkmcnt(8)
    v_mfma_f32_16x16x32_bf16 v[144:147], v[32:35], a[128:131], v[144:147]
    buffer_load_dwordx4 v255, s[12:15], s22 offen offset:1024 lds
    ds_read_b128 a[204:207], v124 offset:4096
    v_mfma_f32_16x16x32_bf16 v[148:151], v[32:35], a[132:135], v[148:151]
    v_mov_b32 v112, v20
    s_waitcnt lgkmcnt(8)
    v_mfma_f32_16x16x32_bf16 v[152:155], v[36:39], a[128:131], v[152:155]
    v_mov_b32 v113, v20
    v_mfma_f32_16x16x32_bf16 v[156:159], v[36:39], a[132:135], v[156:159]
    v_mov_b32 v114, v20
    s_waitcnt lgkmcnt(5)
    v_mfma_f32_16x16x32_bf16 v[128:131], v[40:43], a[136:139], v[128:131]
    s_add_u32 m0, s86, 10240
    s_add_u32 s20, s20, 0x100
    s_and_b32 s20, s20, 0x700
    s_add_u32 s23, s87, s20
    s_add_u32 s22, s23, 0x0
    buffer_load_dwordx4 v254, s[12:15], s22 offen lds
    ds_read_b128 v[24:27], v3 offset:8192
    v_mfma_f32_16x16x32_bf16 v[132:135], v[40:43], a[140:143], v[132:135]
    ds_read_b128 v[28:31], v3 offset:9216
    s_waitcnt lgkmcnt(6)
    v_mfma_f32_16x16x32_bf16 v[136:139], v[44:47], a[136:139], v[136:139]
    ds_read_b128 v[32:35], v3 offset:10240
    v_mfma_f32_16x16x32_bf16 v[140:143], v[44:47], a[140:143], v[140:143]
    ds_read_b128 v[36:39], v3 offset:11264
    s_waitcnt lgkmcnt(7)
    v_mfma_f32_16x16x32_bf16 v[144:147], v[48:51], a[136:139], v[144:147]
    buffer_load_dwordx4 v255, s[12:15], s22 offen offset:1024 lds
    v_mfma_f32_16x16x32_bf16 v[148:151], v[48:51], a[140:143], v[148:151]
    ds_read2st64_b32 v[56:57], v5 offset0:64 offset1:68
    s_waitcnt lgkmcnt(7)
    v_mfma_f32_16x16x32_bf16 v[152:155], v[52:55], a[136:139], v[152:155]
    ds_read2st64_b32 v[58:59], v5 offset0:72 offset1:76
    v_mfma_f32_16x16x32_bf16 v[156:159], v[52:55], a[140:143], v[156:159]
    s_waitcnt lgkmcnt(5)
    v_mfma_f32_16x16x32_bf16 v[128:131], v[24:27], a[144:147], v[128:131]
    s_add_u32 m0, s86, 0
    s_add_u32 s22, s23, 0x10000
    buffer_load_dwordx4 v254, s[12:15], s22 offen lds
    ds_read_b128 v[40:43], v3 offset:12288
    ds_read_b128 v[44:47], v3 offset:13312
    v_mfma_f32_16x16x32_bf16 v[132:135], v[24:27], a[148:151], v[132:135]
    ds_read_b128 v[48:51], v3 offset:14336
    s_waitcnt lgkmcnt(7)
    v_mfma_f32_16x16x32_bf16 v[136:139], v[28:31], a[144:147], v[136:139]
    ds_read_b128 v[52:55], v3 offset:15360
    v_mfma_f32_16x16x32_bf16 v[140:143], v[28:31], a[148:151], v[140:143]
    s_waitcnt lgkmcnt(4)
    v_max3_u32 v60, v56, v57, v58
    v_mfma_f32_16x16x32_bf16 v[144:147], v[32:35], a[144:147], v[144:147]
    buffer_load_dwordx4 v255, s[12:15], s22 offen offset:1024 lds
    v_max_u32 v60, v60, v59
    v_mfma_f32_16x16x32_bf16 v[148:151], v[32:35], a[148:151], v[148:151]
    v_cmp_eq_u32 vcc, -1, v60
    v_mfma_f32_16x16x32_bf16 v[152:155], v[36:39], a[144:147], v[152:155]
    s_cbranch_vccnz fz_rz5
fz_bz5:
    v_mfma_f32_16x16x32_bf16 v[156:159], v[36:39], a[148:151], v[156:159]
    s_barrier
    s_waitcnt lgkmcnt(3)
    v_mfma_f32_16x16x32_bf16 v[128:131], v[40:43], a[152:155], v[128:131]
    s_add_u32 s30, s30, 0x4000
    s_and_b32 s30, s30, 0x1c000
    s_add_u32 s32, s101, s30
    s_add_u32 m0, s33, 0
    s_nop 0
    buffer_load_dwordx4 v9, s[44:47], s32 offen offset:0 sc1 lds
    ds_read_b128 v[24:27], v3 offset:16384
    ds_read_b128 v[28:31], v3 offset:17408
    v_mfma_f32_16x16x32_bf16 v[132:135], v[40:43], a[156:159], v[132:135]
    ds_read_b128 v[32:35], v3 offset:18432
    ds_read_b128 v[36:39], v3 offset:19456
    s_waitcnt lgkmcnt(6)
    v_mfma_f32_16x16x32_bf16 v[136:139], v[44:47], a[152:155], v[136:139]
    s_waitcnt vmcnt(7)
    v_mfma_f32_16x16x32_bf16 v[140:143], v[44:47], a[156:159], v[140:143]
    ds_read_b128 a[208:211], v23 offset:6144
    s_waitcnt lgkmcnt(6)
    v_mfma_f32_16x16x32_bf16 v[144:147], v[48:51], a[152:155], v[144:147]
    buffer_load_dwordx4 v9, s[44:47], s32 offen offset:1024 sc1 lds
    ds_read_b128 a[216:219], v124 offset:6144
    v_mfma_f32_16x16x32_bf16 v[148:151], v[48:51], a[156:159], v[148:151]
    v_mov_b32 v115, v20
    s_waitcnt lgkmcnt(6)
    v_mfma_f32_16x16x32_bf16 v[152:155], v[52:55], a[152:155], v[152:155]
    v_mov_b32 v116, v21
    v_mfma_f32_16x16x32_bf16 v[156:159], v[52:55], a[156:159], v[156:159]
    v_mov_b32 v117, v21
    s_waitcnt lgkmcnt(5)
    v_mfma_f32_16x16x32_bf16 v[128:131], v[24:27], a[160:163], v[128:131]
    buffer_load_dwordx4 v9, s[44:47], s32 offen offset:2048 sc1 lds
    ds_read_b128 v[40:43], v3 offset:20480
    ds_read_b128 v[44:47], v3 offset:21504
    v_mfma_f32_16x16x32_bf16 v[132:135], v[24:27], a[164:167], v[132:135]
    ds_read_b128 v[48:51], v3 offset:22528
    ds_read_b128 v[52:55], v3 offset:23552
    s_waitcnt lgkmcnt(8)
    v_mfma_f32_16x16x32_bf16 v[136:139], v[28:31], a[160:163], v[136:139]
    s_waitcnt vmcnt(7)
    v_mfma_f32_16x16x32_bf16 v[140:143], v[28:31], a[164:167], v[140:143]
    ds_read_b128 a[212:215], v23 offset:8192
    s_waitcnt lgkmcnt(8)
    v_mfma_f32_16x16x32_bf16 v[144:147], v[32:35], a[160:163], v[144:147]
    buffer_load_dwordx4 v9, s[44:47], s32 offen offset:3072 sc1 lds
    ds_read_b128 a[220:223], v124 offset:8192
    v_mfma_f32_16x16x32_bf16 v[148:151], v[32:35], a[164:167], v[148:151]
    v_mov_b32 v118, v21
    s_waitcnt lgkmcnt(8)
    v_mfma_f32_16x16x32_bf16 v[152:155], v[36:39], a[160:163], v[152:155]
    v_mov_b32 v119, v21
    v_mfma_f32_16x16x32_bf16 v[156:159], v[36:39], a[164:167], v[156:159]
    v_lshlrev_b32 v208, 16, v72
    s_waitcnt lgkmcnt(5)
    v_mfma_f32_16x16x32_bf16 v[128:131], v[40:43], a[168:171], v[128:131]
    s_add_u32 m0, s86, 2048
    s_add_u32 s22, s23, 0x80
    buffer_load_dwordx4 v254, s[12:15], s22 offen lds
    ds_read_b128 v[24:27], v3 offset:24576
    ds_read_b128 v[28:31], v3 offset:25600
    v_mfma_f32_16x16x32_bf16 v[132:135], v[40:43], a[172:175], v[132:135]
    ds_read_b128 v[32:35], v3 offset:26624
    ds_read_b128 v[36:39], v3 offset:27648
    s_waitcnt lgkmcnt(8)
    v_mfma_f32_16x16x32_bf16 v[136:139], v[44:47], a[168:171], v[136:139]
    s_waitcnt vmcnt(7)
    v_mfma_f32_16x16x32_bf16 v[140:143], v[44:47], a[172:175], v[140:143]
    ds_read_b128 a[224:227], v23 offset:10240
    s_waitcnt lgkmcnt(8)
    v_mfma_f32_16x16x32_bf16 v[144:147], v[48:51], a[168:171], v[144:147]
    buffer_load_dwordx4 v255, s[12:15], s22 offen offset:1024 lds
    ds_read_b128 a[232:235], v124 offset:10240
    v_mfma_f32_16x16x32_bf16 v[148:151], v[48:51], a[172:175], v[148:151]
    s_waitcnt lgkmcnt(8)
    v_mfma_f32_16x16x32_bf16 v[152:155], v[52:55], a[168:171], v[152:155]
    ds_read2st64_b32 v[56:57], v5 offset0:128 offset1:132
    v_mfma_f32_16x16x32_bf16 v[156:159], v[52:55], a[172:175], v[156:159]
    ds_read2st64_b32 v[58:59], v5 offset0:136 offset1:140
    s_waitcnt lgkmcnt(7)
    v_mfma_f32_16x16x32_bf16 v[128:131], v[24:27], a[176:179], v[128:131]
    s_add_u32 m0, s86, 4096
    s_add_u32 s22, s23, 0x10080
    buffer_load_dwordx4 v254, s[12:15], s22 offen lds
    ds_read_b128 v[40:43], v3 offset:28672
    ds_read_b128 v[44:47], v3 offset:29696
    v_mfma_f32_16x16x32_bf16 v[132:135], v[24:27], a[180:183], v[132:135]
    ds_read_b128 v[48:51], v3 offset:30720
    ds_read_b128 v[52:55], v3 offset:31744
    s_waitcnt lgkmcnt(10)
    v_mfma_f32_16x16x32_bf16 v[136:139], v[28:31], a[176:179], v[136:139]
    s_waitcnt vmcnt(7)
    ds_read_b128 a[228:231], v23 offset:0
    v_mfma_f32_16x16x32_bf16 v[140:143], v[28:31], a[180:183], v[140:143]
    ds_read_b128 a[236:239], v124 offset:0
    s_waitcnt lgkmcnt(6)
    v_max3_u32 v60, v56, v57, v58
    v_mfma_f32_16x16x32_bf16 v[144:147], v[32:35], a[176:179], v[144:147]
    buffer_load_dwordx4 v255, s[12:15], s22 offen offset:1024 lds
    v_max_u32 v60, v60, v59
    v_mfma_f32_16x16x32_bf16 v[148:151], v[32:35], a[180:183], v[148:151]
    v_cmp_eq_u32 vcc, -1, v60
    v_mfma_f32_16x16x32_bf16 v[152:155], v[36:39], a[176:179], v[152:155]
    s_cbranch_vccnz fz_rz6
fz_bz6:
    v_mfma_f32_16x16x32_bf16 v[156:159], v[36:39], a[180:183], v[156:159]
    s_barrier
    s_waitcnt lgkmcnt(5)
    v_mfma_f32_16x16x32_bf16 v[128:131], v[40:43], a[184:187], v[128:131]
    s_lshl_b32 s32, s24, 14
    s_add_u32 s30, s30, s32
    s_add_u32 s30, s30, 0x14000
    s_and_b32 s30, s30, 0x1c000
    s_add_u32 s32, s49, s30
    s_add_u32 m0, s33, 16384
    s_nop 0
    buffer_load_dwordx4 v9, s[44:47], s32 offen offset:0 sc1 lds
    ds_read_b128 v[24:27], v3 offset:32768
    v_mfma_f32_16x16x32_bf16 v[132:135], v[40:43], a[188:191], v[132:135]
    ds_read_b128 v[28:31], v3 offset:33792
    s_waitcnt lgkmcnt(6)
    v_mfma_f32_16x16x32_bf16 v[136:139], v[44:47], a[184:187], v[136:139]
    ds_read_b128 v[32:35], v3 offset:34816
    v_mfma_f32_16x16x32_bf16 v[140:143], v[44:47], a[188:191], v[140:143]
    ds_read_b128 v[36:39], v3 offset:35840
    s_waitcnt lgkmcnt(7)
    v_mfma_f32_16x16x32_bf16 v[144:147], v[48:51], a[184:187], v[144:147]
    buffer_load_dwordx4 v9, s[44:47], s32 offen offset:1024 sc1 lds
    v_and_b32 v209, 0xffff0000, v72
    v_mfma_f32_16x16x32_bf16 v[148:151], v[48:51], a[188:191], v[148:151]
    v_lshlrev_b32 v210, 16, v73
    s_waitcnt lgkmcnt(6)
    v_mfma_f32_16x16x32_bf16 v[152:155], v[52:55], a[184:187], v[152:155]
    v_and_b32 v211, 0xffff0000, v73
    v_mfma_f32_16x16x32_bf16 v[156:159], v[52:55], a[188:191], v[156:159]
    s_waitcnt lgkmcnt(3)
    v_mfma_f32_16x16x32_bf16 v[128:131], v[24:27], a[192:195], v[128:131]
    global_load_dword v252, v253, s[26:27] sc0 sc1
    ds_read_b128 v[40:43], v3 offset:36864
    v_mfma_f32_16x16x32_bf16 v[132:135], v[24:27], a[196:199], v[132:135]
    ds_read_b128 v[44:47], v3 offset:37888
    s_waitcnt lgkmcnt(4)
    v_mfma_f32_16x16x32_bf16 v[136:139], v[28:31], a[192:195], v[136:139]
    ds_read_b128 v[48:51], v3 offset:38912
    v_mfma_f32_16x16x32_bf16 v[140:143], v[28:31], a[196:199], v[140:143]
    ds_read_b128 v[52:55], v3 offset:39936
    s_waitcnt lgkmcnt(5)
    v_mfma_f32_16x16x32_bf16 v[144:147], v[32:35], a[192:195], v[144:147]
    s_add_u32 s32, s32, 2048
    buffer_load_dwordx4 v9, s[44:47], s32 offen offset:2048 sc1 lds
    v_lshlrev_b32 v212, 16, v74
    v_mfma_f32_16x16x32_bf16 v[148:151], v[32:35], a[196:199], v[148:151]
    v_and_b32 v213, 0xffff0000, v74
    s_waitcnt lgkmcnt(4)
    v_mfma_f32_16x16x32_bf16 v[152:155], v[36:39], a[192:195], v[152:155]
    v_lshlrev_b32 v214, 16, v75
    v_mfma_f32_16x16x32_bf16 v[156:159], v[36:39], a[196:199], v[156:159]
    s_waitcnt lgkmcnt(3)
    v_mfma_f32_16x16x32_bf16 v[128:131], v[40:43], a[200:203], v[128:131]
    buffer_load_dwordx4 v9, s[44:47], s32 offen offset:3072 sc1 lds
    ds_read_b128 v[24:27], v3 offset:40960
    ds_read_b128 v[28:31], v3 offset:41984
    v_mfma_f32_16x16x32_bf16 v[132:135], v[40:43], a[204:207], v[132:135]
    ds_read_b128 v[32:35], v3 offset:43008
    ds_read_b128 v[36:39], v3 offset:44032
    s_waitcnt lgkmcnt(6)
    v_mfma_f32_16x16x32_bf16 v[136:139], v[44:47], a[200:203], v[136:139]
    s_waitcnt vmcnt(7)
    v_mfma_f32_16x16x32_bf16 v[140:143], v[44:47], a[204:207], v[140:143]
    ds_read_b128 a[240:243], v23 offset:2048
    s_waitcnt lgkmcnt(6)
    v_mfma_f32_16x16x32_bf16 v[144:147], v[48:51], a[200:203], v[144:147]
    s_add_u32 s30, s30, 0x8000
    s_and_b32 s30, s30, 0x1c000
    s_add_u32 s32, s49, s30
    s_add_u32 m0, s33, 32768
    s_nop 0
    buffer_load_dwordx4 v9, s[44:47], s32 offen offset:0 sc1 lds
    ds_read_b128 a[248:251], v124 offset:2048
    v_mfma_f32_16x16x32_bf16 v[148:151], v[48:51], a[204:207], v[148:151]
    s_waitcnt lgkmcnt(6)
    v_mfma_f32_16x16x32_bf16 v[152:155], v[52:55], a[200:203], v[152:155]
    ds_read2st64_b32 v[56:57], v4 offset0:0 offset1:4
    v_mfma_f32_16x16x32_bf16 v[156:159], v[52:55], a[204:207], v[156:159]
    ds_read2st64_b32 v[58:59], v4 offset0:8 offset1:12
    s_waitcnt lgkmcnt(7)
    v_mfma_f32_16x16x32_bf16 v[128:131], v[24:27], a[208:211], v[128:131]
    buffer_load_dwordx4 v9, s[44:47], s32 offen offset:1024 sc1 lds
    ds_read_b128 v[40:43], v3 offset:45056
    ds_read_b128 v[44:47], v3 offset:46080
    v_mfma_f32_16x16x32_bf16 v[132:135], v[24:27], a[212:215], v[132:135]
    ds_read_b128 v[48:51], v3 offset:47104
    ds_read_b128 v[52:55], v3 offset:48128
    s_waitcnt lgkmcnt(10)
    v_mfma_f32_16x16x32_bf16 v[136:139], v[28:31], a[208:211], v[136:139]
    s_waitcnt vmcnt(7)
    ds_read_b128 a[244:247], v23 offset:4096
    v_mfma_f32_16x16x32_bf16 v[140:143], v[28:31], a[212:215], v[140:143]
    ds_read_b128 a[252:255], v124 offset:4096
    s_waitcnt lgkmcnt(6)
    v_max3_u32 v60, v56, v57, v58
    v_mfma_f32_16x16x32_bf16 v[144:147], v[32:35], a[208:211], v[144:147]
    s_add_u32 s32, s32, 2048
    buffer_load_dwordx4 v9, s[44:47], s32 offen offset:2048 sc1 lds
    v_max_u32 v60, v60, v59
    v_mfma_f32_16x16x32_bf16 v[148:151], v[32:35], a[212:215], v[148:151]
    v_cmp_eq_u32 vcc, -1, v60
    v_mfma_f32_16x16x32_bf16 v[152:155], v[36:39], a[208:211], v[152:155]
    s_cbranch_vccnz fz_rz7
fz_bz7:
    v_mfma_f32_16x16x32_bf16 v[156:159], v[36:39], a[212:215], v[156:159]
    s_barrier
    s_waitcnt lgkmcnt(5)
    v_mfma_f32_16x16x32_bf16 v[128:131], v[40:43], a[216:219], v[128:131]
    buffer_load_dwordx4 v9, s[44:47], s32 offen offset:3072 sc1 lds
    ds_read_b128 v[24:27], v2 offset:0
    v_mfma_f32_16x16x32_bf16 v[132:135], v[40:43], a[220:223], v[132:135]
    ds_read_b128 v[28:31], v2 offset:1024
    s_waitcnt lgkmcnt(6)
    v_mfma_f32_16x16x32_bf16 v[136:139], v[44:47], a[216:219], v[136:139]
    ds_read_b128 v[32:35], v2 offset:2048
    v_mfma_f32_16x16x32_bf16 v[140:143], v[44:47], a[220:223], v[140:143]
    ds_read_b128 v[36:39], v2 offset:3072
    s_waitcnt lgkmcnt(7)
    v_mfma_f32_16x16x32_bf16 v[144:147], v[48:51], a[216:219], v[144:147]
    s_add_u32 s30, s30, 0x8000
    s_and_b32 s30, s30, 0x1c000
    s_add_u32 s32, s49, s30
    s_add_u32 m0, s33, 49152
    s_nop 0
    buffer_load_dwordx4 v9, s[44:47], s32 offen offset:0 sc1 lds
    v_and_b32 v215, 0xffff0000, v75
    v_mfma_f32_16x16x32_bf16 v[148:151], v[48:51], a[220:223], v[148:151]
    v_lshlrev_b32 v216, 16, v76
    s_waitcnt lgkmcnt(6)
    v_mfma_f32_16x16x32_bf16 v[152:155], v[52:55], a[216:219], v[152:155]
    v_and_b32 v217, 0xffff0000, v76
    v_mfma_f32_16x16x32_bf16 v[156:159], v[52:55], a[220:223], v[156:159]
    s_waitcnt lgkmcnt(3)
    v_mfma_f32_16x16x32_bf16 v[128:131], v[24:27], a[224:227], v[128:131]
    buffer_load_dwordx4 v9, s[44:47], s32 offen offset:1024 sc1 lds
    ds_read_b128 v[40:43], v2 offset:4096
    v_mfma_f32_16x16x32_bf16 v[132:135], v[24:27], a[228:231], v[132:135]
    ds_read_b128 v[44:47], v2 offset:5120
    s_waitcnt lgkmcnt(4)
    v_mfma_f32_16x16x32_bf16 v[136:139], v[28:31], a[224:227], v[136:139]
    ds_read_b128 v[48:51], v2 offset:6144
    v_mfma_f32_16x16x32_bf16 v[140:143], v[28:31], a[228:231], v[140:143]
    ds_read_b128 v[52:55], v2 offset:7168
    s_waitcnt lgkmcnt(5)
    v_mfma_f32_16x16x32_bf16 v[144:147], v[32:35], a[224:227], v[144:147]
    s_add_u32 s32, s32, 2048
    buffer_load_dwordx4 v9, s[44:47], s32 offen offset:2048 sc1 lds
    v_lshlrev_b32 v218, 16, v77
    v_mfma_f32_16x16x32_bf16 v[148:151], v[32:35], a[228:231], v[148:151]
    v_and_b32 v219, 0xffff0000, v77
    s_waitcnt lgkmcnt(4)
    v_mfma_f32_16x16x32_bf16 v[152:155], v[36:39], a[224:227], v[152:155]
    v_lshlrev_b32 v220, 16, v78
    v_mfma_f32_16x16x32_bf16 v[156:159], v[36:39], a[228:231], v[156:159]
    s_waitcnt lgkmcnt(3)
    v_mfma_f32_16x16x32_bf16 v[128:131], v[40:43], a[232:235], v[128:131]
    buffer_load_dwordx4 v9, s[44:47], s32 offen offset:3072 sc1 lds
    ds_read_b128 v[24:27], v2 offset:8192
    v_mfma_f32_16x16x32_bf16 v[132:135], v[40:43], a[236:239], v[132:135]
    ds_read_b128 v[28:31], v2 offset:9216
    s_waitcnt lgkmcnt(4)
    v_mfma_f32_16x16x32_bf16 v[136:139], v[44:47], a[232:235], v[136:139]
    ds_read_b128 v[32:35], v2 offset:10240
    v_mfma_f32_16x16x32_bf16 v[140:143], v[44:47], a[236:239], v[140:143]
    ds_read_b128 v[36:39], v2 offset:11264
    s_waitcnt lgkmcnt(5)
    v_mfma_f32_16x16x32_bf16 v[144:147], v[48:51], a[232:235], v[144:147]
    s_add_u32 s30, s30, 0x8000
    s_and_b32 s30, s30, 0x1c000
    s_add_u32 s32, s49, s30
    s_add_u32 m0, s33, 65536
    s_nop 0
    buffer_load_dwordx4 v9, s[44:47], s32 offen offset:0 sc1 lds
    s_waitcnt vmcnt(9)
    v_mfma_f32_16x16x32_bf16 v[148:151], v[48:51], a[236:239], v[148:151]
    ds_read2st64_b32 v[56:57], v4 offset0:64 offset1:68
    s_waitcnt lgkmcnt(5)
    v_mfma_f32_16x16x32_bf16 v[152:155], v[52:55], a[232:235], v[152:155]
    ds_read2st64_b32 v[58:59], v4 offset0:72 offset1:76
    v_mfma_f32_16x16x32_bf16 v[156:159], v[52:55], a[236:239], v[156:159]
    s_waitcnt lgkmcnt(5)
    v_mfma_f32_16x16x32_bf16 v[128:131], v[24:27], a[240:243], v[128:131]
    buffer_load_dwordx4 v9, s[44:47], s32 offen offset:1024 sc1 lds
    ds_read_b128 v[40:43], v2 offset:12288
    ds_read_b128 v[44:47], v2 offset:13312
    v_mfma_f32_16x16x32_bf16 v[132:135], v[24:27], a[244:247], v[132:135]
    ds_read_b128 v[48:51], v2 offset:14336
    s_waitcnt lgkmcnt(7)
    v_mfma_f32_16x16x32_bf16 v[136:139], v[28:31], a[240:243], v[136:139]
    ds_read_b128 v[52:55], v2 offset:15360
    v_mfma_f32_16x16x32_bf16 v[140:143], v[28:31], a[244:247], v[140:143]
    s_waitcnt lgkmcnt(4)
    v_max3_u32 v60, v56, v57, v58
    v_mfma_f32_16x16x32_bf16 v[144:147], v[32:35], a[240:243], v[144:147]
    s_add_u32 s32, s32, 2048
    buffer_load_dwordx4 v9, s[44:47], s32 offen offset:2048 sc1 lds
    v_max_u32 v60, v60, v59
    v_mfma_f32_16x16x32_bf16 v[148:151], v[32:35], a[244:247], v[148:151]
    v_cmp_eq_u32 vcc, -1, v60
    v_mfma_f32_16x16x32_bf16 v[152:155], v[36:39], a[240:243], v[152:155]
    s_cbranch_vccnz fz_rz8
fz_bz8:
    v_mfma_f32_16x16x32_bf16 v[156:159], v[36:39], a[244:247], v[156:159]
    s_barrier
    s_waitcnt lgkmcnt(3)
    v_mfma_f32_16x16x32_bf16 v[128:131], v[40:43], a[248:251], v[128:131]
    buffer_load_dwordx4 v9, s[44:47], s32 offen offset:3072 sc1 lds
    ds_read_b128 v[24:27], v2 offset:16384
    ds_read_b128 v[28:31], v2 offset:17408
    v_mfma_f32_16x16x32_bf16 v[132:135], v[40:43], a[252:255], v[132:135]
    ds_read_b128 v[32:35], v2 offset:18432
    s_waitcnt lgkmcnt(5)
    v_mfma_f32_16x16x32_bf16 v[136:139], v[44:47], a[248:251], v[136:139]
    ds_read_b128 v[36:39], v2 offset:19456
    v_mfma_f32_16x16x32_bf16 v[140:143], v[44:47], a[252:255], v[140:143]
    v_cmp_ne_u32 vcc, s50, v252
    s_waitcnt lgkmcnt(5)
    v_mfma_f32_16x16x32_bf16 v[144:147], v[48:51], a[248:251], v[144:147]
    s_add_u32 s30, s30, 0x8000
    s_and_b32 s30, s30, 0x1c000
    s_add_u32 s32, s49, s30
    s_add_u32 s32, s32, 2048
    s_add_u32 m0, s33, 81920
    s_nop 0
    buffer_load_dwordx4 v9, s[44:47], s32 offen offset:0 sc1 lds
    s_cbranch_vccnz fz_rf2
fz_bf2:
    v_mfma_f32_16x16x32_bf16 v[148:151], v[48:51], a[252:255], v[148:151]
    v_and_b32 v221, 0xffff0000, v78
    s_waitcnt lgkmcnt(4)
    v_mfma_f32_16x16x32_bf16 v[152:155], v[52:55], a[248:251], v[152:155]
    v_lshlrev_b32 v222, 16, v79
    v_mfma_f32_16x16x32_bf16 v[156:159], v[52:55], a[252:255], v[156:159]
    v_and_b32 v223, 0xffff0000, v79
    s_waitcnt lgkmcnt(3)
    v_mfma_f32_16x16x32_bf16 v[88:91], v[24:27], a[128:131], v[88:91]
    buffer_load_dwordx4 v9, s[44:47], s32 offen offset:1024 sc1 lds
    ds_read_b128 v[40:43], v2 offset:20480
    ds_read_b128 v[44:47], v2 offset:21504
    v_mfma_f32_16x16x32_bf16 v[92:95], v[24:27], a[132:135], v[92:95]
    ds_read_b128 v[48:51], v2 offset:22528
    ds_read_b128 v[52:55], v2 offset:23552
    s_waitcnt lgkmcnt(6)
    v_mfma_f32_16x16x32_bf16 v[96:99], v[28:31], a[128:131], v[96:99]
    v_lshlrev_b32 v224, 16, v80
    v_and_b32 v225, 0xffff0000, v80
    v_mfma_f32_16x16x32_bf16 v[100:103], v[28:31], a[132:135], v[100:103]
    v_lshlrev_b32 v226, 16, v81
    v_cvt_pk_bf16_f32 v160, v128, v129
    s_waitcnt lgkmcnt(5)
    v_mfma_f32_16x16x32_bf16 v[88:91], v[32:35], a[136:139], v[88:91]
    s_add_u32 s32, s32, 2048
    buffer_load_dwordx4 v9, s[44:47], s32 offen offset:2048 sc1 lds
    v_cvt_pk_bf16_f32 v161, v130, v131
    v_cvt_pk_bf16_f32 v162, v132, v133
    v_mfma_f32_16x16x32_bf16 v[92:95], v[32:35], a[140:143], v[92:95]
    v_cvt_pk_bf16_f32 v163, v134, v135
    v_cvt_pk_bf16_f32 v164, v136, v137
    s_waitcnt lgkmcnt(4)
    v_mfma_f32_16x16x32_bf16 v[96:99], v[36:39], a[136:139], v[96:99]
    v_cvt_pk_bf16_f32 v165, v138, v139
    v_cvt_pk_bf16_f32 v166, v140, v141
    v_mfma_f32_16x16x32_bf16 v[100:103], v[36:39], a[140:143], v[100:103]
    v_cvt_pk_bf16_f32 v167, v142, v143
    s_waitcnt lgkmcnt(3)
    v_mfma_f32_16x16x32_bf16 v[88:91], v[40:43], a[144:147], v[88:91]
    buffer_store_dwordx4 v[160:163], v9, s[96:99], s84 offen offset:0 sc1
    ds_read_b128 v[24:27], v2 offset:24576
    ds_read_b128 v[28:31], v2 offset:25600
    v_mfma_f32_16x16x32_bf16 v[92:95], v[40:43], a[148:151], v[92:95]
    ds_read_b128 v[32:35], v2 offset:26624
    ds_read_b128 v[36:39], v2 offset:27648
    s_waitcnt lgkmcnt(6)
    v_mfma_f32_16x16x32_bf16 v[96:99], v[44:47], a[144:147], v[96:99]
    s_waitcnt vmcnt(12)
    ds_read2st64_b32 v[56:57], v4 offset0:128 offset1:132
    v_mfma_f32_16x16x32_bf16 v[100:103], v[44:47], a[148:151], v[100:103]
    ds_read2st64_b32 v[58:59], v4 offset0:136 offset1:140
    v_cvt_pk_bf16_f32 v168, v144, v145
    s_waitcnt lgkmcnt(7)
    v_mfma_f32_16x16x32_bf16 v[88:91], v[48:51], a[152:155], v[88:91]
    buffer_store_dwordx4 v[164:167], v9, s[96:99], s84 offen offset:1024 sc1
    v_cvt_pk_bf16_f32 v169, v146, v147
    v_cvt_pk_bf16_f32 v170, v148, v149
    v_mfma_f32_16x16x32_bf16 v[92:95], v[48:51], a[156:159], v[92:95]
    v_cvt_pk_bf16_f32 v171, v150, v151
    v_cvt_pk_bf16_f32 v172, v152, v153
    s_waitcnt lgkmcnt(6)
    v_mfma_f32_16x16x32_bf16 v[96:99], v[52:55], a[152:155], v[96:99]
    v_cvt_pk_bf16_f32 v173, v154, v155
    v_cvt_pk_bf16_f32 v174, v156, v157
    v_mfma_f32_16x16x32_bf16 v[100:103], v[52:55], a[156:159], v[100:103]
    v_cvt_pk_bf16_f32 v175, v158, v159
    s_waitcnt lgkmcnt(5)
    v_mfma_f32_16x16x32_bf16 v[88:91], v[24:27], a[160:163], v[88:91]
    buffer_store_dwordx4 v[168:171], v9, s[96:99], s84 offen offset:2048 sc1
    ds_read_b128 v[40:43], v2 offset:28672
    ds_read_b128 v[44:47], v2 offset:29696
    v_mfma_f32_16x16x32_bf16 v[92:95], v[24:27], a[164:167], v[92:95]
    ds_read_b128 v[48:51], v2 offset:30720
    s_waitcnt lgkmcnt(7)
    v_mfma_f32_16x16x32_bf16 v[96:99], v[28:31], a[160:163], v[96:99]
    ds_read_b128 v[52:55], v2 offset:31744
    v_mfma_f32_16x16x32_bf16 v[100:103], v[28:31], a[164:167], v[100:103]
    s_waitcnt lgkmcnt(4)
    v_max3_u32 v60, v56, v57, v58
    v_mfma_f32_16x16x32_bf16 v[88:91], v[32:35], a[168:171], v[88:91]
    buffer_store_dwordx4 v[172:175], v9, s[96:99], s84 offen offset:3072 sc1
    v_max_u32 v60, v60, v59
    v_mfma_f32_16x16x32_bf16 v[92:95], v[32:35], a[172:175], v[92:95]
    v_cmp_eq_u32 vcc, -1, v60
    v_mfma_f32_16x16x32_bf16 v[96:99], v[36:39], a[168:171], v[96:99]
    s_cbranch_vccnz fz_rz9
fz_bz9:
    v_mfma_f32_16x16x32_bf16 v[100:103], v[36:39], a[172:175], v[100:103]
    s_barrier
    s_waitcnt lgkmcnt(3)
    v_mfma_f32_16x16x32_bf16 v[88:91], v[40:43], a[176:179], v[88:91]
    buffer_load_dwordx4 v9, s[44:47], s32 offen offset:3072 sc1 lds
    ds_read_b128 v[24:27], v2 offset:32768
    v_mfma_f32_16x16x32_bf16 v[92:95], v[40:43], a[180:183], v[92:95]
    ds_read_b128 v[28:31], v2 offset:33792
    s_waitcnt lgkmcnt(4)
    v_mfma_f32_16x16x32_bf16 v[96:99], v[44:47], a[176:179], v[96:99]
    ds_read_b128 v[32:35], v2 offset:34816
    v_mfma_f32_16x16x32_bf16 v[100:103], v[44:47], a[180:183], v[100:103]
    ds_read_b128 v[36:39], v2 offset:35840
    s_waitcnt lgkmcnt(5)
    v_mfma_f32_16x16x32_bf16 v[88:91], v[48:51], a[184:187], v[88:91]
    s_add_u32 s30, s30, 0x8000
    s_and_b32 s30, s30, 0x1c000
    s_add_u32 s32, s49, s30
    s_add_u32 s32, s32, 2048
    s_add_u32 m0, s33, 98304
    s_nop 0
    buffer_load_dwordx4 v9, s[44:47], s32 offen offset:0 sc1 lds
    v_and_b32 v227, 0xffff0000, v81
    v_mfma_f32_16x16x32_bf16 v[92:95], v[48:51], a[188:191], v[92:95]
    v_lshlrev_b32 v228, 16, v82
    s_waitcnt lgkmcnt(4)
    v_mfma_f32_16x16x32_bf16 v[96:99], v[52:55], a[184:187], v[96:99]
    v_and_b32 v229, 0xffff0000, v82
    v_mfma_f32_16x16x32_bf16 v[100:103], v[52:55], a[188:191], v[100:103]
    s_waitcnt lgkmcnt(3)
    v_mfma_f32_16x16x32_bf16 v[88:91], v[24:27], a[192:195], v[88:91]
    buffer_load_dwordx4 v9, s[44:47], s32 offen offset:1024 sc1 lds
    ds_read_b128 v[40:43], v2 offset:36864
    v_mfma_f32_16x16x32_bf16 v[92:95], v[24:27], a[196:199], v[92:95]
    ds_read_b128 v[44:47], v2 offset:37888
    s_waitcnt lgkmcnt(4)
    v_mfma_f32_16x16x32_bf16 v[96:99], v[28:31], a[192:195], v[96:99]
    ds_read_b128 v[48:51], v2 offset:38912
    v_mfma_f32_16x16x32_bf16 v[100:103], v[28:31], a[196:199], v[100:103]
    ds_read_b128 v[52:55], v2 offset:39936
    s_waitcnt lgkmcnt(5)
    v_mfma_f32_16x16x32_bf16 v[88:91], v[32:35], a[200:203], v[88:91]
    s_add_u32 s32, s32, 2048
    buffer_load_dwordx4 v9, s[44:47], s32 offen offset:2048 sc1 lds
    v_lshlrev_b32 v230, 16, v83
    v_mfma_f32_16x16x32_bf16 v[92:95], v[32:35], a[204:207], v[92:95]
    v_and_b32 v231, 0xffff0000, v83
    s_waitcnt lgkmcnt(4)
    v_mfma_f32_16x16x32_bf16 v[96:99], v[36:39], a[200:203], v[96:99]
    v_lshlrev_b32 v232, 16, v84
    v_mfma_f32_16x16x32_bf16 v[100:103], v[36:39], a[204:207], v[100:103]
    s_waitcnt lgkmcnt(3)
    v_mfma_f32_16x16x32_bf16 v[88:91], v[40:43], a[208:211], v[88:91]
    buffer_load_dwordx4 v9, s[44:47], s32 offen offset:3072 sc1 lds
    ds_read_b128 v[24:27], v2 offset:40960
    ds_read_b128 v[28:31], v2 offset:41984
    v_mfma_f32_16x16x32_bf16 v[92:95], v[40:43], a[212:215], v[92:95]
    ds_read_b128 v[32:35], v2 offset:43008
    ds_read_b128 v[36:39], v2 offset:44032
    s_waitcnt lgkmcnt(6)
    v_mfma_f32_16x16x32_bf16 v[96:99], v[44:47], a[208:211], v[96:99]
    s_waitcnt vmcnt(16)
    ds_read2st64_b32 v[56:57], v4 offset0:192 offset1:196
    v_mfma_f32_16x16x32_bf16 v[100:103], v[44:47], a[212:215], v[100:103]
    ds_read2st64_b32 v[58:59], v4 offset0:200 offset1:204
    s_waitcnt lgkmcnt(7)
    v_mfma_f32_16x16x32_bf16 v[88:91], v[48:51], a[216:219], v[88:91]
    s_add_u32 s30, s30, 0x8000
    s_and_b32 s30, s30, 0x1c000
    s_add_u32 s32, s49, s30
    s_add_u32 s32, s32, 2048
    s_add_u32 m0, s33, 0
    s_nop 0
    buffer_load_dwordx4 v9, s[44:47], s32 offen offset:0 sc1 lds
    s_mul_i32 s5, s4, 12288
    v_mfma_f32_16x16x32_bf16 v[92:95], v[48:51], a[220:223], v[92:95]
    s_add_u32 s5, s5, 114688
    s_waitcnt lgkmcnt(6)
    v_mfma_f32_16x16x32_bf16 v[96:99], v[52:55], a[216:219], v[96:99]
    v_add_u32 v16, s5, v9
    v_mfma_f32_16x16x32_bf16 v[100:103], v[52:55], a[220:223], v[100:103]
    s_xor_b32 s5, s4, 1
    s_waitcnt lgkmcnt(5)
    v_mfma_f32_16x16x32_bf16 v[88:91], v[24:27], a[224:227], v[88:91]
    buffer_load_dwordx4 v9, s[44:47], s32 offen offset:1024 sc1 lds
    ds_read_b128 v[40:43], v2 offset:45056
    ds_read_b128 v[44:47], v2 offset:46080
    v_mfma_f32_16x16x32_bf16 v[92:95], v[24:27], a[228:231], v[92:95]
    ds_read_b128 v[48:51], v2 offset:47104
    ds_read_b128 v[52:55], v2 offset:48128
    s_waitcnt lgkmcnt(8)
    v_mfma_f32_16x16x32_bf16 v[96:99], v[28:31], a[224:227], v[96:99]
    s_waitcnt lgkmcnt(4)
    v_max3_u32 v60, v56, v57, v58
    v_max_u32 v60, v60, v59
    v_mfma_f32_16x16x32_bf16 v[100:103], v[28:31], a[228:231], v[100:103]
    v_cmp_eq_u32 vcc, -1, v60
    s_cbranch_vccnz fz_rz10
fz_bz10:
    v_mfma_f32_16x16x32_bf16 v[88:91], v[32:35], a[232:235], v[88:91]
    s_add_u32 s32, s32, 2048
    buffer_load_dwordx4 v9, s[44:47], s32 offen offset:2048 sc1 lds
    s_barrier
    s_mul_i32 s5, s5, 12288
    v_mfma_f32_16x16x32_bf16 v[92:95], v[32:35], a[236:239], v[92:95]
    s_add_u32 s5, s5, 114688
    v_mfma_f32_16x16x32_bf16 v[96:99], v[36:39], a[232:235], v[96:99]
    v_add_u32 v17, s5, v9
    v_mfma_f32_16x16x32_bf16 v[100:103], v[36:39], a[236:239], v[100:103]
    s_xor_b32 s5, s4, 2
    s_waitcnt lgkmcnt(3)
    v_mfma_f32_16x16x32_bf16 v[88:91], v[40:43], a[240:243], v[88:91]
    buffer_load_dwordx4 v9, s[44:47], s32 offen offset:3072 sc1 lds
    ds_read_b128 v[24:27], v2 offset:49152
    v_mfma_f32_16x16x32_bf16 v[92:95], v[40:43], a[244:247], v[92:95]
    ds_read_b128 v[28:31], v2 offset:50176
    s_waitcnt lgkmcnt(4)
    v_mfma_f32_16x16x32_bf16 v[96:99], v[44:47], a[240:243], v[96:99]
    ds_read_b128 v[32:35], v2 offset:51200
    v_mfma_f32_16x16x32_bf16 v[100:103], v[44:47], a[244:247], v[100:103]
    ds_read_b128 v[36:39], v2 offset:52224
    s_waitcnt lgkmcnt(5)
    v_mfma_f32_16x16x32_bf16 v[88:91], v[48:51], a[248:251], v[88:91]
    s_add_u32 s30, s30, 0x8000
    s_and_b32 s30, s30, 0x1c000
    s_add_u32 s32, s49, s30
    s_add_u32 s32, s32, 2048
    s_add_u32 m0, s33, 16384
    s_nop 0
    buffer_load_dwordx4 v9, s[44:47], s32 offen offset:0 sc1 lds
    v_and_b32 v233, 0xffff0000, v84
    v_mfma_f32_16x16x32_bf16 v[92:95], v[48:51], a[252:255], v[92:95]
    v_lshlrev_b32 v234, 16, v85
    s_waitcnt lgkmcnt(4)
    v_mfma_f32_16x16x32_bf16 v[96:99], v[52:55], a[248:251], v[96:99]
    v_and_b32 v235, 0xffff0000, v85
    v_mfma_f32_16x16x32_bf16 v[100:103], v[52:55], a[252:255], v[100:103]
    s_waitcnt lgkmcnt(3)
    v_mfma_f32_16x16x32_bf16 v[88:91], v[24:27], a[0:3], v[88:91]
    buffer_load_dwordx4 v9, s[44:47], s32 offen offset:1024 sc1 lds
    ds_read_b128 v[40:43], v2 offset:53248
    v_mfma_f32_16x16x32_bf16 v[92:95], v[24:27], a[4:7], v[92:95]
    ds_read_b128 v[44:47], v2 offset:54272
    s_waitcnt lgkmcnt(4)
    v_mfma_f32_16x16x32_bf16 v[96:99], v[28:31], a[0:3], v[96:99]
    ds_read_b128 v[48:51], v2 offset:55296
    v_mfma_f32_16x16x32_bf16 v[100:103], v[28:31], a[4:7], v[100:103]
    ds_read_b128 v[52:55], v2 offset:56320
    s_waitcnt lgkmcnt(5)
    v_mfma_f32_16x16x32_bf16 v[88:91], v[32:35], a[8:11], v[88:91]
    s_add_u32 s32, s32, 2048
    buffer_load_dwordx4 v9, s[44:47], s32 offen offset:2048 sc1 lds
    v_lshlrev_b32 v236, 16, v86
    v_mfma_f32_16x16x32_bf16 v[92:95], v[32:35], a[12:15], v[92:95]
    v_and_b32 v237, 0xffff0000, v86
    s_waitcnt lgkmcnt(4)
    v_mfma_f32_16x16x32_bf16 v[96:99], v[36:39], a[8:11], v[96:99]
    v_lshlrev_b32 v238, 16, v87
    v_mfma_f32_16x16x32_bf16 v[100:103], v[36:39], a[12:15], v[100:103]
    s_waitcnt lgkmcnt(3)
    v_mfma_f32_16x16x32_bf16 v[88:91], v[40:43], a[16:19], v[88:91]
    buffer_load_dwordx4 v9, s[44:47], s32 offen offset:3072 sc1 lds
    ds_read_b128 v[24:27], v2 offset:57344
    ds_read_b128 v[28:31], v2 offset:58368
    v_mfma_f32_16x16x32_bf16 v[92:95], v[40:43], a[20:23], v[92:95]
    ds_read_b128 v[32:35], v2 offset:59392
    ds_read_b128 v[36:39], v2 offset:60416
    s_waitcnt lgkmcnt(6)
    v_mfma_f32_16x16x32_bf16 v[96:99], v[44:47], a[16:19], v[96:99]
    s_waitcnt vmcnt(20)
    ds_read2st64_b32 v[56:57], v5 offset0:0 offset1:4
    v_mfma_f32_16x16x32_bf16 v[100:103], v[44:47], a[20:23], v[100:103]
    ds_read2st64_b32 v[58:59], v5 offset0:8 offset1:12
    s_waitcnt lgkmcnt(7)
    v_mfma_f32_16x16x32_bf16 v[88:91], v[48:51], a[24:27], v[88:91]
    buffer_load_dwordx4 v[160:163], v9, s[96:99], s85 offen offset:0 sc1
    s_mul_i32 s5, s5, 12288
    v_mfma_f32_16x16x32_bf16 v[92:95], v[48:51], a[28:31], v[92:95]
    s_add_u32 s5, s5, 114688
    s_waitcnt lgkmcnt(6)
    v_mfma_f32_16x16x32_bf16 v[96:99], v[52:55], a[24:27], v[96:99]
    v_add_u32 v18, s5, v9
    v_mfma_f32_16x16x32_bf16 v[100:103], v[52:55], a[28:31], v[100:103]
    s_xor_b32 s5, s4, 3
    s_waitcnt lgkmcnt(5)
    v_mfma_f32_16x16x32_bf16 v[88:91], v[24:27], a[32:35], v[88:91]
    buffer_load_dwordx4 v[164:167], v9, s[96:99], s85 offen offset:1024 sc1
    ds_read_b128 v[40:43], v2 offset:61440
    ds_read_b128 v[44:47], v2 offset:62464
    v_mfma_f32_16x16x32_bf16 v[92:95], v[24:27], a[36:39], v[92:95]
    ds_read_b128 v[48:51], v2 offset:63488
    ds_read_b128 v[52:55], v2 offset:64512
    s_waitcnt lgkmcnt(8)
    v_mfma_f32_16x16x32_bf16 v[96:99], v[28:31], a[32:35], v[96:99]
    s_waitcnt lgkmcnt(4)
    v_max3_u32 v60, v56, v57, v58
    v_max_u32 v60, v60, v59
    v_mfma_f32_16x16x32_bf16 v[100:103], v[28:31], a[36:39], v[100:103]
    v_cmp_eq_u32 vcc, -1, v60
    s_cbranch_vccnz fz_rz11
fz_bz11:
    v_mfma_f32_16x16x32_bf16 v[88:91], v[32:35], a[40:43], v[88:91]
    buffer_load_dwordx4 v[120:123], v9, s[16:19], s42 offen offset:0 sc1
    s_barrier
    s_mul_i32 s5, s5, 12288
    v_mfma_f32_16x16x32_bf16 v[92:95], v[32:35], a[44:47], v[92:95]
    s_add_u32 s5, s5, 114688
    v_mfma_f32_16x16x32_bf16 v[96:99], v[36:39], a[40:43], v[96:99]
    v_add_u32 v19, s5, v9
    v_mfma_f32_16x16x32_bf16 v[100:103], v[36:39], a[44:47], v[100:103]
    v_and_b32 v13, 15, v1
    s_waitcnt lgkmcnt(3)
    v_mfma_f32_16x16x32_bf16 v[88:91], v[40:43], a[48:51], v[88:91]
    buffer_load_dwordx4 v[124:127], v9, s[16:19], s43 offen offset:0 sc1
    ds_read_b128 v[24:27], v3 offset:0
    v_mfma_f32_16x16x32_bf16 v[92:95], v[40:43], a[52:55], v[92:95]
    ds_read_b128 v[28:31], v3 offset:1024
    s_waitcnt lgkmcnt(4)
    v_mfma_f32_16x16x32_bf16 v[96:99], v[44:47], a[48:51], v[96:99]
    ds_read_b128 v[32:35], v3 offset:2048
    v_mfma_f32_16x16x32_bf16 v[100:103], v[44:47], a[52:55], v[100:103]
    ds_read_b128 v[36:39], v3 offset:3072
    s_waitcnt lgkmcnt(5)
    v_mfma_f32_16x16x32_bf16 v[88:91], v[48:51], a[56:59], v[88:91]
    buffer_load_dwordx4 v[176:179], v9, s[16:19], s42 offen offset:1024 sc1
    v_and_b32 v239, 0xffff0000, v87
    v_mfma_f32_16x16x32_bf16 v[92:95], v[48:51], a[60:63], v[92:95]
    s_waitcnt lgkmcnt(4)
    v_mfma_f32_16x16x32_bf16 v[96:99], v[52:55], a[56:59], v[96:99]
    v_mfma_f32_16x16x32_bf16 v[100:103], v[52:55], a[60:63], v[100:103]
    s_waitcnt lgkmcnt(3)
    v_mfma_f32_16x16x32_bf16 v[88:91], v[24:27], a[64:67], v[88:91]
    buffer_load_dwordx4 v[180:183], v9, s[16:19], s43 offen offset:1024 sc1
    ds_read_b128 v[40:43], v3 offset:4096
    v_mfma_f32_16x16x32_bf16 v[92:95], v[24:27], a[68:71], v[92:95]
    ds_read_b128 v[44:47], v3 offset:5120
    s_waitcnt lgkmcnt(4)
    v_mfma_f32_16x16x32_bf16 v[96:99], v[28:31], a[64:67], v[96:99]
    ds_read_b128 v[48:51], v3 offset:6144
    v_mfma_f32_16x16x32_bf16 v[100:103], v[28:31], a[68:71], v[100:103]
    ds_read_b128 v[52:55], v3 offset:7168
    s_waitcnt lgkmcnt(5)
    v_mfma_f32_16x16x32_bf16 v[88:91], v[32:35], a[72:75], v[88:91]
    buffer_load_dwordx4 v[184:187], v9, s[16:19], s42 offen offset:2048 sc1
    v_mfma_f32_16x16x32_bf16 v[92:95], v[32:35], a[76:79], v[92:95]
    s_waitcnt lgkmcnt(4)
    v_mfma_f32_16x16x32_bf16 v[96:99], v[36:39], a[72:75], v[96:99]
    v_mfma_f32_16x16x32_bf16 v[100:103], v[36:39], a[76:79], v[100:103]
    s_waitcnt lgkmcnt(3)
    v_mfma_f32_16x16x32_bf16 v[88:91], v[40:43], a[80:83], v[88:91]
    buffer_load_dwordx4 v[188:191], v9, s[16:19], s43 offen offset:2048 sc1
    ds_read_b128 v[24:27], v3 offset:8192
    ds_read_b128 v[28:31], v3 offset:9216
    v_mfma_f32_16x16x32_bf16 v[92:95], v[40:43], a[84:87], v[92:95]
    ds_read_b128 v[32:35], v3 offset:10240
    ds_read_b128 v[36:39], v3 offset:11264
    s_waitcnt lgkmcnt(6)
    v_mfma_f32_16x16x32_bf16 v[96:99], v[44:47], a[80:83], v[96:99]
    s_waitcnt vmcnt(20)
    ds_read2st64_b32 v[56:57], v5 offset0:64 offset1:68
    v_mfma_f32_16x16x32_bf16 v[100:103], v[44:47], a[84:87], v[100:103]
    ds_read2st64_b32 v[58:59], v5 offset0:72 offset1:76
    s_waitcnt lgkmcnt(7)
    v_mfma_f32_16x16x32_bf16 v[88:91], v[48:51], a[88:91], v[88:91]
    buffer_load_dwordx4 v[192:195], v8, s[60:63], s52 offen offset:0 sc1
    v_mul_u32_u24 v13, 896, v13
    v_mfma_f32_16x16x32_bf16 v[92:95], v[48:51], a[92:95], v[92:95]
    v_bfe_u32 v14, v1, 4, 1
    s_waitcnt lgkmcnt(6)
    v_mfma_f32_16x16x32_bf16 v[96:99], v[52:55], a[88:91], v[96:99]
    v_lshl_add_u32 v13, v14, 5, v13
    v_mfma_f32_16x16x32_bf16 v[100:103], v[52:55], a[92:95], v[100:103]
    v_lshl_add_u32 v13, v7, 4, v13
    s_waitcnt lgkmcnt(5)
    v_mfma_f32_16x16x32_bf16 v[88:91], v[24:27], a[96:99], v[88:91]
    buffer_load_dwordx4 v[196:199], v8, s[60:63], s52 offen offset:32 sc1
    ds_read_b128 v[40:43], v3 offset:12288
    ds_read_b128 v[44:47], v3 offset:13312
    v_mfma_f32_16x16x32_bf16 v[92:95], v[24:27], a[100:103], v[92:95]
    ds_read_b128 v[48:51], v3 offset:14336
    ds_read_b128 v[52:55], v3 offset:15360
    s_waitcnt lgkmcnt(8)
    v_mfma_f32_16x16x32_bf16 v[96:99], v[28:31], a[96:99], v[96:99]
    s_waitcnt lgkmcnt(4)
    v_max3_u32 v60, v56, v57, v58
    v_max_u32 v60, v60, v59
    v_mfma_f32_16x16x32_bf16 v[100:103], v[28:31], a[100:103], v[100:103]
    v_cmp_eq_u32 vcc, -1, v60
    s_cbranch_vccnz fz_rz12
fz_bz12:
    v_mfma_f32_16x16x32_bf16 v[88:91], v[32:35], a[104:107], v[88:91]
    buffer_load_dwordx4 v[200:203], v9, s[16:19], s42 offen offset:3072 sc1
    s_barrier
    v_lshlrev_b32 v10, 3, v7
    v_mfma_f32_16x16x32_bf16 v[92:95], v[32:35], a[108:111], v[92:95]
    v_sub_u32 v10, v6, v10
    v_mfma_f32_16x16x32_bf16 v[96:99], v[36:39], a[104:107], v[96:99]
    v_mov_b32 v11, 0x3f80
    v_mfma_f32_16x16x32_bf16 v[100:103], v[36:39], a[108:111], v[100:103]
    v_mov_b32 v12, 0x3f800000
    s_waitcnt lgkmcnt(3)
    v_mfma_f32_16x16x32_bf16 v[88:91], v[40:43], a[112:115], v[88:91]
    buffer_load_dwordx4 v[204:207], v9, s[16:19], s43 offen offset:3072 sc1
    ds_read_b128 v[24:27], v3 offset:16384
    v_mfma_f32_16x16x32_bf16 v[92:95], v[40:43], a[116:119], v[92:95]
    ds_read_b128 v[28:31], v3 offset:17408
    s_waitcnt lgkmcnt(4)
    v_mfma_f32_16x16x32_bf16 v[96:99], v[44:47], a[112:115], v[96:99]
    ds_read_b128 v[32:35], v3 offset:18432
    v_mfma_f32_16x16x32_bf16 v[100:103], v[44:47], a[116:119], v[100:103]
    ds_read_b128 v[36:39], v3 offset:19456
    s_waitcnt lgkmcnt(5)
    v_mfma_f32_16x16x32_bf16 v[88:91], v[48:51], a[120:123], v[88:91]
    s_add_u32 s42, s42, 4096
    s_add_u32 s43, s43, 4096
    buffer_load_dwordx4 v[240:243], v9, s[16:19], s42 offen offset:0 sc1
    s_waitcnt vmcnt(11)
    v_max_u32 v61, v160, v164
    v_mfma_f32_16x16x32_bf16 v[92:95], v[48:51], a[124:127], v[92:95]
    v_cmp_eq_u32 vcc, -1, v61
    s_waitcnt lgkmcnt(4)
    v_mfma_f32_16x16x32_bf16 v[96:99], v[52:55], a[120:123], v[96:99]
    s_cbranch_vccnz fz_rp0
fz_bp0:
    v_mfma_f32_16x16x32_bf16 v[100:103], v[52:55], a[124:127], v[100:103]
    s_waitcnt lgkmcnt(3)
    v_mfma_f32_16x16x32_bf16 v[104:107], v[24:27], a[128:131], v[104:107]
    buffer_load_dwordx4 v[244:247], v9, s[16:19], s43 offen offset:0 sc1
    ds_read_b128 v[40:43], v3 offset:20480
    ds_read_b128 v[44:47], v3 offset:21504
    v_mfma_f32_16x16x32_bf16 v[108:111], v[24:27], a[132:135], v[108:111]
    ds_read_b128 v[48:51], v3 offset:22528
    ds_read_b128 v[52:55], v3 offset:23552
    s_waitcnt lgkmcnt(6)
    v_mfma_f32_16x16x32_bf16 v[112:115], v[28:31], a[128:131], v[112:115]
    v_lshlrev_b32 v128, 16, v160
    v_and_b32 v129, 0xffff0000, v160
    v_mfma_f32_16x16x32_bf16 v[116:119], v[28:31], a[132:135], v[116:119]
    v_lshlrev_b32 v130, 16, v161
    v_and_b32 v131, 0xffff0000, v161
    s_waitcnt lgkmcnt(5)
    v_mfma_f32_16x16x32_bf16 v[104:107], v[32:35], a[136:139], v[104:107]
    buffer_load_dwordx4 v[168:171], v9, s[96:99], s85 offen offset:2048 sc1
    v_lshlrev_b32 v132, 16, v162
    v_mfma_f32_16x16x32_bf16 v[108:111], v[32:35], a[140:143], v[108:111]
    v_and_b32 v133, 0xffff0000, v162
    s_waitcnt lgkmcnt(4)
    v_mfma_f32_16x16x32_bf16 v[112:115], v[36:39], a[136:139], v[112:115]
    v_lshlrev_b32 v134, 16, v163
    v_mfma_f32_16x16x32_bf16 v[116:119], v[36:39], a[140:143], v[116:119]
    v_and_b32 v135, 0xffff0000, v163
    s_waitcnt lgkmcnt(3)
    v_mfma_f32_16x16x32_bf16 v[104:107], v[40:43], a[144:147], v[104:107]
    buffer_load_dwordx4 v[172:175], v9, s[96:99], s85 offen offset:3072 sc1
    ds_read_b128 v[24:27], v3 offset:24576
    ds_read_b128 v[28:31], v3 offset:25600
    v_mfma_f32_16x16x32_bf16 v[108:111], v[40:43], a[148:151], v[108:111]
    ds_read_b128 v[32:35], v3 offset:26624
    ds_read_b128 v[36:39], v3 offset:27648
    s_waitcnt lgkmcnt(6)
    v_mfma_f32_16x16x32_bf16 v[112:115], v[44:47], a[144:147], v[112:115]
    ds_read2st64_b32 v[56:57], v5 offset0:128 offset1:132
    v_mfma_f32_16x16x32_bf16 v[116:119], v[44:47], a[148:151], v[116:119]
    ds_read2st64_b32 v[58:59], v5 offset0:136 offset1:140
    v_lshlrev_b32 v136, 16, v164
    s_waitcnt lgkmcnt(7)
    v_mfma_f32_16x16x32_bf16 v[104:107], v[48:51], a[152:155], v[104:107]
    buffer_load_dwordx4 v[248:251], v9, s[16:19], s42 offen offset:1024 sc1
    v_and_b32 v137, 0xffff0000, v164
    v_lshlrev_b32 v138, 16, v165
    v_mfma_f32_16x16x32_bf16 v[108:111], v[48:51], a[156:159], v[108:111]
    v_and_b32 v139, 0xffff0000, v165
    v_lshlrev_b32 v140, 16, v166
    s_waitcnt lgkmcnt(6)
    v_mfma_f32_16x16x32_bf16 v[112:115], v[52:55], a[152:155], v[112:115]
    v_and_b32 v141, 0xffff0000, v166
    v_lshlrev_b32 v142, 16, v167
    v_mfma_f32_16x16x32_bf16 v[116:119], v[52:55], a[156:159], v[116:119]
    v_and_b32 v143, 0xffff0000, v167
    s_waitcnt lgkmcnt(5)
    v_mfma_f32_16x16x32_bf16 v[104:107], v[24:27], a[160:163], v[104:107]
    buffer_load_dwordx4 v[252:255], v9, s[16:19], s43 offen offset:1024 sc1
    ds_read_b128 v[40:43], v3 offset:28672
    ds_read_b128 v[44:47], v3 offset:29696
    v_mfma_f32_16x16x32_bf16 v[108:111], v[24:27], a[164:167], v[108:111]
    ds_read_b128 v[48:51], v3 offset:30720
    ds_read_b128 v[52:55], v3 offset:31744
    s_waitcnt lgkmcnt(8)
    v_mfma_f32_16x16x32_bf16 v[112:115], v[28:31], a[160:163], v[112:115]
    s_waitcnt lgkmcnt(4)
    v_max3_u32 v60, v56, v57, v58
    v_max_u32 v60, v60, v59
    v_mfma_f32_16x16x32_bf16 v[116:119], v[28:31], a[164:167], v[116:119]
    v_cmp_eq_u32 vcc, -1, v60
    s_cbranch_vccnz fz_rz13
fz_bz13:
    v_mfma_f32_16x16x32_bf16 v[104:107], v[32:35], a[168:171], v[104:107]
    buffer_load_dwordx4 a[128:131], v9, s[16:19], s42 offen offset:2048 sc1
    s_barrier
    v_pk_add_f32 v[88:89], v[88:89], v[128:129]
    v_mfma_f32_16x16x32_bf16 v[108:111], v[32:35], a[172:175], v[108:111]
    v_pk_add_f32 v[90:91], v[90:91], v[130:131]
    v_pk_add_f32 v[92:93], v[92:93], v[132:133]
    v_mfma_f32_16x16x32_bf16 v[112:115], v[36:39], a[168:171], v[112:115]
    v_pk_add_f32 v[94:95], v[94:95], v[134:135]
    v_pk_mul_f32 v[88:89], v[88:89], v[208:209]
    v_mfma_f32_16x16x32_bf16 v[116:119], v[36:39], a[172:175], v[116:119]
    v_pk_mul_f32 v[90:91], v[90:91], v[210:211]
    v_pk_mul_f32 v[92:93], v[92:93], v[212:213]
    v_pk_mul_f32 v[94:95], v[94:95], v[214:215]
    s_waitcnt lgkmcnt(3)
    v_mfma_f32_16x16x32_bf16 v[104:107], v[40:43], a[176:179], v[104:107]
    buffer_load_dwordx4 a[132:135], v9, s[16:19], s43 offen offset:2048 sc1
    ds_read_b128 v[24:27], v3 offset:32768
    ds_read_b128 v[28:31], v3 offset:33792
    v_mfma_f32_16x16x32_bf16 v[108:111], v[40:43], a[180:183], v[108:111]
    ds_read_b128 v[32:35], v3 offset:34816
    ds_read_b128 v[36:39], v3 offset:35840
    s_waitcnt lgkmcnt(6)
    v_mfma_f32_16x16x32_bf16 v[112:115], v[44:47], a[176:179], v[112:115]
    v_cvt_pk_bf16_f32 v64, v88, v89
    v_cvt_pk_bf16_f32 v65, v90, v91
    v_mfma_f32_16x16x32_bf16 v[116:119], v[44:47], a[180:183], v[116:119]
    v_cvt_pk_bf16_f32 v66, v92, v93
    v_cvt_pk_bf16_f32 v67, v94, v95
    s_waitcnt lgkmcnt(5)
    v_mfma_f32_16x16x32_bf16 v[104:107], v[48:51], a[184:187], v[104:107]
    s_add_u32 s42, s42, 24576
    s_add_u32 s43, s43, 24576
    buffer_load_dwordx4 a[136:139], v9, s[16:19], s42 offen offset:0 sc1
    v_permlane16_swap_b32 v64, v66
    v_mfma_f32_16x16x32_bf16 v[108:111], v[48:51], a[188:191], v[108:111]
    v_permlane16_swap_b32 v65, v67
    s_waitcnt lgkmcnt(4)
    v_mfma_f32_16x16x32_bf16 v[112:115], v[52:55], a[184:187], v[112:115]
    buffer_store_dwordx4 v[64:67], v9, s[36:39], s53 offen offset:0 sc1
    v_mfma_f32_16x16x32_bf16 v[116:119], v[52:55], a[188:191], v[116:119]
    v_pk_add_f32 v[96:97], v[96:97], v[136:137]
    s_waitcnt lgkmcnt(3)
    v_mfma_f32_16x16x32_bf16 v[104:107], v[24:27], a[192:195], v[104:107]
    buffer_load_dwordx4 a[140:143], v9, s[16:19], s43 offen offset:0 sc1
    ds_read_b128 v[40:43], v3 offset:36864
    ds_read_b128 v[44:47], v3 offset:37888
    v_mfma_f32_16x16x32_bf16 v[108:111], v[24:27], a[196:199], v[108:111]
    ds_read_b128 v[48:51], v3 offset:38912
    ds_read_b128 v[52:55], v3 offset:39936
    s_waitcnt lgkmcnt(6)
    v_mfma_f32_16x16x32_bf16 v[112:115], v[28:31], a[192:195], v[112:115]
    v_pk_add_f32 v[98:99], v[98:99], v[138:139]
    v_pk_add_f32 v[100:101], v[100:101], v[140:141]
    v_mfma_f32_16x16x32_bf16 v[116:119], v[28:31], a[196:199], v[116:119]
    v_pk_add_f32 v[102:103], v[102:103], v[142:143]
    v_pk_mul_f32 v[96:97], v[96:97], v[216:217]
    s_waitcnt lgkmcnt(5)
    v_mfma_f32_16x16x32_bf16 v[104:107], v[32:35], a[200:203], v[104:107]
    buffer_load_dwordx4 a[144:147], v9, s[16:19], s42 offen offset:1024 sc1
    v_pk_mul_f32 v[98:99], v[98:99], v[218:219]
    v_mfma_f32_16x16x32_bf16 v[108:111], v[32:35], a[204:207], v[108:111]
    v_pk_mul_f32 v[100:101], v[100:101], v[220:221]
    s_waitcnt lgkmcnt(4)
    v_mfma_f32_16x16x32_bf16 v[112:115], v[36:39], a[200:203], v[112:115]
    v_pk_mul_f32 v[102:103], v[102:103], v[222:223]
    v_mfma_f32_16x16x32_bf16 v[116:119], v[36:39], a[204:207], v[116:119]
    v_cvt_pk_bf16_f32 v68, v96, v97
    s_waitcnt lgkmcnt(3)
    v_mfma_f32_16x16x32_bf16 v[104:107], v[40:43], a[208:211], v[104:107]
    buffer_load_dwordx4 a[148:151], v9, s[16:19], s43 offen offset:1024 sc1
    ds_read_b128 v[24:27], v3 offset:40960
    ds_read_b128 v[28:31], v3 offset:41984
    v_mfma_f32_16x16x32_bf16 v[108:111], v[40:43], a[212:215], v[108:111]
    ds_read_b128 v[32:35], v3 offset:43008
    ds_read_b128 v[36:39], v3 offset:44032
    s_waitcnt lgkmcnt(6)
    v_mfma_f32_16x16x32_bf16 v[112:115], v[44:47], a[208:211], v[112:115]
    ds_read2st64_b32 v[56:57], v4 offset0:0 offset1:4
    v_mfma_f32_16x16x32_bf16 v[116:119], v[44:47], a[212:215], v[116:119]
    ds_read2st64_b32 v[58:59], v4 offset0:8 offset1:12
    v_cvt_pk_bf16_f32 v69, v98, v99
    s_waitcnt lgkmcnt(7)
    v_mfma_f32_16x16x32_bf16 v[104:107], v[48:51], a[216:219], v[104:107]
    buffer_load_dwordx4 a[152:155], v9, s[16:19], s42 offen offset:2048 sc1
    v_cvt_pk_bf16_f32 v70, v100, v101
    v_cvt_pk_bf16_f32 v71, v102, v103
    v_mfma_f32_16x16x32_bf16 v[108:111], v[48:51], a[220:223], v[108:111]
    v_permlane16_swap_b32 v68, v70
    s_waitcnt lgkmcnt(6)
    v_mfma_f32_16x16x32_bf16 v[112:115], v[52:55], a[216:219], v[112:115]
    v_permlane16_swap_b32 v69, v71
    v_mfma_f32_16x16x32_bf16 v[116:119], v[52:55], a[220:223], v[116:119]
    buffer_store_dwordx4 v[68:71], v9, s[36:39], s53 offen offset:1024 sc1
    s_waitcnt lgkmcnt(5)
    v_mfma_f32_16x16x32_bf16 v[104:107], v[24:27], a[224:227], v[104:107]
    buffer_load_dwordx4 a[156:159], v9, s[16:19], s43 offen offset:2048 sc1
    ds_read_b128 v[40:43], v3 offset:45056
    ds_read_b128 v[44:47], v3 offset:46080
    v_mfma_f32_16x16x32_bf16 v[108:111], v[24:27], a[228:231], v[108:111]
    ds_read_b128 v[48:51], v3 offset:47104
    s_waitcnt lgkmcnt(7)
    v_mfma_f32_16x16x32_bf16 v[112:115], v[28:31], a[224:227], v[112:115]
    ds_read_b128 v[52:55], v3 offset:48128
    v_mfma_f32_16x16x32_bf16 v[116:119], v[28:31], a[228:231], v[116:119]
    s_waitcnt lgkmcnt(4)
    v_max3_u32 v60, v56, v57, v58
    v_mfma_f32_16x16x32_bf16 v[104:107], v[32:35], a[232:235], v[104:107]
    buffer_load_dwordx4 a[160:163], v9, s[16:19], s42 offen offset:3072 sc1
    v_max_u32 v60, v60, v59
    v_mfma_f32_16x16x32_bf16 v[108:111], v[32:35], a[236:239], v[108:111]
    v_cmp_eq_u32 vcc, -1, v60
    v_mfma_f32_16x16x32_bf16 v[112:115], v[36:39], a[232:235], v[112:115]
    s_cbranch_vccnz fz_rz14
fz_bz14:
    v_mfma_f32_16x16x32_bf16 v[116:119], v[36:39], a[236:239], v[116:119]
    s_barrier
    s_waitcnt lgkmcnt(3)
    v_mfma_f32_16x16x32_bf16 v[104:107], v[40:43], a[240:243], v[104:107]
    buffer_load_dwordx4 a[164:167], v9, s[16:19], s43 offen offset:3072 sc1
    ds_read_b128 v[24:27], v2 offset:0
    v_mfma_f32_16x16x32_bf16 v[108:111], v[40:43], a[244:247], v[108:111]
    ds_read_b128 v[28:31], v2 offset:1024
    s_waitcnt lgkmcnt(4)
    v_mfma_f32_16x16x32_bf16 v[112:115], v[44:47], a[240:243], v[112:115]
    ds_read_b128 v[32:35], v2 offset:2048
    v_mfma_f32_16x16x32_bf16 v[116:119], v[44:47], a[244:247], v[116:119]
    ds_read_b128 v[36:39], v2 offset:3072
    s_waitcnt lgkmcnt(5)
    v_mfma_f32_16x16x32_bf16 v[104:107], v[48:51], a[248:251], v[104:107]
    s_add_u32 s42, s42, 4096
    s_add_u32 s43, s43, 4096
    buffer_load_dwordx4 a[168:171], v9, s[16:19], s42 offen offset:0 sc1
    v_cmp_eq_u32 vcc, 0, v10
    v_mfma_f32_16x16x32_bf16 v[108:111], v[48:51], a[252:255], v[108:111]
    s_nop 0
    v_cndmask_b32 v64, 0, v11, vcc
    s_waitcnt lgkmcnt(4)
    v_mfma_f32_16x16x32_bf16 v[112:115], v[52:55], a[248:251], v[112:115]
    v_cmp_eq_u32 vcc, 1, v10
    v_mfma_f32_16x16x32_bf16 v[116:119], v[52:55], a[252:255], v[116:119]
    s_nop 0
    v_cndmask_b32 v64, v64, v12, vcc
    s_waitcnt lgkmcnt(3)
    v_mfma_f32_16x16x32_bf16 v[104:107], v[24:27], a[0:3], v[104:107]
    buffer_load_dwordx4 a[172:175], v9, s[16:19], s43 offen offset:0 sc1
    ds_read_b128 v[40:43], v2 offset:4096
    v_mfma_f32_16x16x32_bf16 v[108:111], v[24:27], a[4:7], v[108:111]
    ds_read_b128 v[44:47], v2 offset:5120
    s_waitcnt lgkmcnt(4)
    v_mfma_f32_16x16x32_bf16 v[112:115], v[28:31], a[0:3], v[112:115]
    ds_read_b128 v[48:51], v2 offset:6144
    v_mfma_f32_16x16x32_bf16 v[116:119], v[28:31], a[4:7], v[116:119]
    ds_read_b128 v[52:55], v2 offset:7168
    s_waitcnt lgkmcnt(5)
    v_mfma_f32_16x16x32_bf16 v[104:107], v[32:35], a[8:11], v[104:107]
    buffer_load_dwordx4 a[176:179], v9, s[16:19], s42 offen offset:1024 sc1
    v_cmp_eq_u32 vcc, 2, v10
    v_mfma_f32_16x16x32_bf16 v[108:111], v[32:35], a[12:15], v[108:111]
    s_nop 0
    v_cndmask_b32 v65, 0, v11, vcc
    s_waitcnt lgkmcnt(4)
    v_mfma_f32_16x16x32_bf16 v[112:115], v[36:39], a[8:11], v[112:115]
    v_cmp_eq_u32 vcc, 3, v10
    v_mfma_f32_16x16x32_bf16 v[116:119], v[36:39], a[12:15], v[116:119]
    s_nop 0
    v_cndmask_b32 v65, v65, v12, vcc
    s_waitcnt lgkmcnt(3)
    v_mfma_f32_16x16x32_bf16 v[104:107], v[40:43], a[16:19], v[104:107]
    buffer_load_dwordx4 a[180:183], v9, s[16:19], s43 offen offset:1024 sc1
    ds_read_b128 v[24:27], v2 offset:8192
    ds_read_b128 v[28:31], v2 offset:9216
    v_mfma_f32_16x16x32_bf16 v[108:111], v[40:43], a[20:23], v[108:111]
    ds_read_b128 v[32:35], v2 offset:10240
    ds_read_b128 v[36:39], v2 offset:11264
    s_waitcnt lgkmcnt(6)
    v_mfma_f32_16x16x32_bf16 v[112:115], v[44:47], a[16:19], v[112:115]
    ds_read2st64_b32 v[56:57], v4 offset0:64 offset1:68
    v_mfma_f32_16x16x32_bf16 v[116:119], v[44:47], a[20:23], v[116:119]
    ds_read2st64_b32 v[58:59], v4 offset0:72 offset1:76
    s_waitcnt lgkmcnt(7)
    v_mfma_f32_16x16x32_bf16 v[104:107], v[48:51], a[24:27], v[104:107]
    buffer_load_dwordx4 a[184:187], v9, s[16:19], s42 offen offset:2048 sc1
    v_cmp_eq_u32 vcc, 4, v10
    v_mfma_f32_16x16x32_bf16 v[108:111], v[48:51], a[28:31], v[108:111]
    s_nop 0
    v_cndmask_b32 v66, 0, v11, vcc
    s_waitcnt lgkmcnt(6)
    v_mfma_f32_16x16x32_bf16 v[112:115], v[52:55], a[24:27], v[112:115]
    v_cmp_eq_u32 vcc, 5, v10
    v_mfma_f32_16x16x32_bf16 v[116:119], v[52:55], a[28:31], v[116:119]
    s_nop 0
    v_cndmask_b32 v66, v66, v12, vcc
    s_waitcnt lgkmcnt(5)
    v_mfma_f32_16x16x32_bf16 v[104:107], v[24:27], a[32:35], v[104:107]
    buffer_load_dwordx4 a[188:191], v9, s[16:19], s43 offen offset:2048 sc1
    ds_read_b128 v[40:43], v2 offset:12288
    ds_read_b128 v[44:47], v2 offset:13312
    v_mfma_f32_16x16x32_bf16 v[108:111], v[24:27], a[36:39], v[108:111]
    ds_read_b128 v[48:51], v2 offset:14336
    ds_read_b128 v[52:55], v2 offset:15360
    s_waitcnt lgkmcnt(8)
    v_mfma_f32_16x16x32_bf16 v[112:115], v[28:31], a[32:35], v[112:115]
    s_waitcnt lgkmcnt(4)
    v_max3_u32 v60, v56, v57, v58
    v_max_u32 v60, v60, v59
    v_mfma_f32_16x16x32_bf16 v[116:119], v[28:31], a[36:39], v[116:119]
    v_cmp_eq_u32 vcc, -1, v60
    s_cbranch_vccnz fz_rz15
fz_bz15:
    v_mfma_f32_16x16x32_bf16 v[104:107], v[32:35], a[40:43], v[104:107]
    s_barrier
    v_cmp_eq_u32 vcc, 6, v10
    v_mfma_f32_16x16x32_bf16 v[108:111], v[32:35], a[44:47], v[108:111]
    s_nop 0
    v_cndmask_b32 v67, 0, v11, vcc
    v_mfma_f32_16x16x32_bf16 v[112:115], v[36:39], a[40:43], v[112:115]
    v_cmp_eq_u32 vcc, 7, v10
    v_mfma_f32_16x16x32_bf16 v[116:119], v[36:39], a[44:47], v[116:119]
    s_nop 0
    v_cndmask_b32 v67, v67, v12, vcc
    s_waitcnt lgkmcnt(3)
    v_mfma_f32_16x16x32_bf16 v[104:107], v[40:43], a[48:51], v[104:107]
    s_add_u32 s22, s40, 4096
    s_add_u32 s23, s41, 4096
    buffer_load_dwordx4 v[72:75], v9, s[36:39], s40 offen offset:0 sc1
    ds_read_b128 v[24:27], v2 offset:16384
    v_mfma_f32_16x16x32_bf16 v[108:111], v[40:43], a[52:55], v[108:111]
    ds_read_b128 v[28:31], v2 offset:17408
    s_waitcnt lgkmcnt(4)
    v_mfma_f32_16x16x32_bf16 v[112:115], v[44:47], a[48:51], v[112:115]
    ds_read_b128 v[32:35], v2 offset:18432
    v_mfma_f32_16x16x32_bf16 v[116:119], v[44:47], a[52:55], v[116:119]
    ds_read_b128 v[36:39], v2 offset:19456
    s_waitcnt lgkmcnt(5)
    v_mfma_f32_16x16x32_bf16 v[104:107], v[48:51], a[56:59], v[104:107]
    buffer_load_dwordx4 v[76:79], v9, s[36:39], s41 offen offset:0 sc1
    v_cmp_eq_u32 vcc, 16, v10
    v_mfma_f32_16x16x32_bf16 v[108:111], v[48:51], a[60:63], v[108:111]
    s_nop 0
    v_cndmask_b32 v68, 0, v11, vcc
    s_waitcnt lgkmcnt(4)
    v_mfma_f32_16x16x32_bf16 v[112:115], v[52:55], a[56:59], v[112:115]
    v_cmp_eq_u32 vcc, 17, v10
    v_mfma_f32_16x16x32_bf16 v[116:119], v[52:55], a[60:63], v[116:119]
    s_nop 0
    v_cndmask_b32 v68, v68, v12, vcc
    s_waitcnt lgkmcnt(3)
    v_mfma_f32_16x16x32_bf16 v[104:107], v[24:27], a[64:67], v[104:107]
    buffer_load_dwordx4 v[80:83], v9, s[36:39], s40 offen offset:1024 sc1
    ds_read_b128 v[40:43], v2 offset:20480
    v_mfma_f32_16x16x32_bf16 v[108:111], v[24:27], a[68:71], v[108:111]
    ds_read_b128 v[44:47], v2 offset:21504
    s_waitcnt lgkmcnt(4)
    v_mfma_f32_16x16x32_bf16 v[112:115], v[28:31], a[64:67], v[112:115]
    ds_read_b128 v[48:51], v2 offset:22528
    v_mfma_f32_16x16x32_bf16 v[116:119], v[28:31], a[68:71], v[116:119]
    ds_read_b128 v[52:55], v2 offset:23552
    s_waitcnt lgkmcnt(5)
    v_mfma_f32_16x16x32_bf16 v[104:107], v[32:35], a[72:75], v[104:107]
    buffer_load_dwordx4 v[84:87], v9, s[36:39], s41 offen offset:1024 sc1
    v_cmp_eq_u32 vcc, 18, v10
    v_mfma_f32_16x16x32_bf16 v[108:111], v[32:35], a[76:79], v[108:111]
    s_nop 0
    v_cndmask_b32 v69, 0, v11, vcc
    s_waitcnt lgkmcnt(4)
    v_mfma_f32_16x16x32_bf16 v[112:115], v[36:39], a[72:75], v[112:115]
    v_cmp_eq_u32 vcc, 19, v10
    v_mfma_f32_16x16x32_bf16 v[116:119], v[36:39], a[76:79], v[116:119]
    s_nop 0
    v_cndmask_b32 v69, v69, v12, vcc
    s_waitcnt lgkmcnt(3)
    v_mfma_f32_16x16x32_bf16 v[104:107], v[40:43], a[80:83], v[104:107]
    buffer_load_dwordx4 v[88:91], v9, s[36:39], s40 offen offset:2048 sc1
    ds_read_b128 v[24:27], v2 offset:24576
    ds_read_b128 v[28:31], v2 offset:25600
    v_mfma_f32_16x16x32_bf16 v[108:111], v[40:43], a[84:87], v[108:111]
    ds_read_b128 v[32:35], v2 offset:26624
    ds_read_b128 v[36:39], v2 offset:27648
    s_waitcnt lgkmcnt(6)
    v_mfma_f32_16x16x32_bf16 v[112:115], v[44:47], a[80:83], v[112:115]
    s_waitcnt vmcnt(25)
    v_max_u32 v61, v168, v172
    v_cmp_eq_u32 vcc, -1, v61
    v_mfma_f32_16x16x32_bf16 v[116:119], v[44:47], a[84:87], v[116:119]
    s_cbranch_vccnz fz_rp1
fz_bp1:
    v_cmp_eq_u32 vcc, 20, v10
    s_waitcnt lgkmcnt(5)
    v_mfma_f32_16x16x32_bf16 v[104:107], v[48:51], a[88:91], v[104:107]
    buffer_load_dwordx4 v[92:95], v9, s[36:39], s41 offen offset:2048 sc1
    v_cndmask_b32 v70, 0, v11, vcc
    v_cmp_eq_u32 vcc, 21, v10
    v_mfma_f32_16x16x32_bf16 v[108:111], v[48:51], a[92:95], v[108:111]
    s_nop 0
    v_cndmask_b32 v70, v70, v12, vcc
    s_mul_i32 s5, s48, 28672
    s_waitcnt lgkmcnt(4)
    v_mfma_f32_16x16x32_bf16 v[112:115], v[52:55], a[88:91], v[112:115]
    s_lshl_b32 s55, s51, 6
    s_add_u32 s55, s5, s55
    v_mfma_f32_16x16x32_bf16 v[116:119], v[52:55], a[92:95], v[116:119]
    s_add_u32 s56, s55, 14336
    s_mov_b32 s44, s8
    s_mov_b32 s45, s9
    s_mov_b32 s46, 0x1c0000
    s_mov_b32 s47, 0x20000
    s_waitcnt lgkmcnt(3)
    v_mfma_f32_16x16x32_bf16 v[104:107], v[24:27], a[96:99], v[104:107]
    buffer_load_dwordx4 v[96:99], v9, s[36:39], s40 offen offset:3072 sc1
    ds_read_b128 v[40:43], v2 offset:28672
    ds_read_b128 v[44:47], v2 offset:29696
    v_mfma_f32_16x16x32_bf16 v[108:111], v[24:27], a[100:103], v[108:111]
    ds_read_b128 v[48:51], v2 offset:30720
    ds_read_b128 v[52:55], v2 offset:31744
    s_waitcnt lgkmcnt(6)
    v_mfma_f32_16x16x32_bf16 v[112:115], v[28:31], a[96:99], v[112:115]
    v_lshlrev_b32 v144, 16, v168
    v_and_b32 v145, 0xffff0000, v168
    v_mfma_f32_16x16x32_bf16 v[116:119], v[28:31], a[100:103], v[116:119]
    v_lshlrev_b32 v146, 16, v169
    v_and_b32 v147, 0xffff0000, v169
    s_waitcnt lgkmcnt(5)
    v_mfma_f32_16x16x32_bf16 v[104:107], v[32:35], a[104:107], v[104:107]
    buffer_load_dwordx4 v[100:103], v9, s[36:39], s41 offen offset:3072 sc1
    v_lshlrev_b32 v148, 16, v170
    v_and_b32 v149, 0xffff0000, v170
    v_mfma_f32_16x16x32_bf16 v[108:111], v[32:35], a[108:111], v[108:111]
    v_lshlrev_b32 v150, 16, v171
    v_and_b32 v151, 0xffff0000, v171
    s_waitcnt lgkmcnt(4)
    v_mfma_f32_16x16x32_bf16 v[112:115], v[36:39], a[104:107], v[112:115]
    v_cmp_eq_u32 vcc, 22, v10
    s_nop 1
    v_cndmask_b32 v71, 0, v11, vcc
    v_mfma_f32_16x16x32_bf16 v[116:119], v[36:39], a[108:111], v[116:119]
    v_cmp_eq_u32 vcc, 23, v10
    s_nop 1
    v_cndmask_b32 v71, v71, v12, vcc
    s_add_u32 s30, s40, 28672
    s_add_u32 s32, s40, 32768
    s_add_u32 s31, s41, 28672
    s_add_u32 s33, s41, 32768
    s_waitcnt lgkmcnt(3)
    v_mfma_f32_16x16x32_bf16 v[104:107], v[40:43], a[112:115], v[104:107]
    buffer_load_dwordx4 v[128:131], v9, s[36:39], s22 offen offset:0 sc1
    v_lshlrev_b32 v152, 16, v172
    v_mfma_f32_16x16x32_bf16 v[108:111], v[40:43], a[116:119], v[108:111]
    v_and_b32 v153, 0xffff0000, v172
    s_waitcnt lgkmcnt(2)
    v_mfma_f32_16x16x32_bf16 v[112:115], v[44:47], a[112:115], v[112:115]
    v_lshlrev_b32 v154, 16, v173
    v_mfma_f32_16x16x32_bf16 v[116:119], v[44:47], a[116:119], v[116:119]
    v_and_b32 v155, 0xffff0000, v173
    s_waitcnt lgkmcnt(1)
    v_mfma_f32_16x16x32_bf16 v[104:107], v[48:51], a[120:123], v[104:107]
    buffer_load_dwordx4 v[132:135], v9, s[36:39], s23 offen offset:0 sc1
    v_lshlrev_b32 v156, 16, v174
    v_mfma_f32_16x16x32_bf16 v[108:111], v[48:51], a[124:127], v[108:111]
    v_and_b32 v157, 0xffff0000, v174
    s_waitcnt lgkmcnt(0)
    v_mfma_f32_16x16x32_bf16 v[112:115], v[52:55], a[120:123], v[112:115]
    v_lshlrev_b32 v158, 16, v175
    v_mfma_f32_16x16x32_bf16 v[116:119], v[52:55], a[124:127], v[116:119]
    v_and_b32 v159, 0xffff0000, v175
    buffer_load_dwordx4 v[136:139], v9, s[36:39], s22 offen offset:1024 sc1
    v_pk_add_f32 v[104:105], v[104:105], v[144:145]
    v_pk_add_f32 v[106:107], v[106:107], v[146:147]
    v_pk_add_f32 v[108:109], v[108:109], v[148:149]
    v_pk_add_f32 v[110:111], v[110:111], v[150:151]
    v_pk_mul_f32 v[104:105], v[104:105], v[224:225]
    v_pk_mul_f32 v[106:107], v[106:107], v[226:227]
    v_pk_mul_f32 v[108:109], v[108:109], v[228:229]
    v_pk_mul_f32 v[110:111], v[110:111], v[230:231]
    v_cvt_pk_bf16_f32 v48, v104, v105
    v_cvt_pk_bf16_f32 v49, v106, v107
    v_cvt_pk_bf16_f32 v50, v108, v109
    v_cvt_pk_bf16_f32 v51, v110, v111
    s_nop 0
    v_permlane16_swap_b32 v48, v50
    v_permlane16_swap_b32 v49, v51
    s_add_u32 s53, s53, 26624
    buffer_store_dwordx4 v[48:51], v9, s[36:39], s53 offen offset:2048 sc1
    v_pk_add_f32 v[112:113], v[112:113], v[152:153]
    v_pk_add_f32 v[114:115], v[114:115], v[154:155]
    v_pk_add_f32 v[116:117], v[116:117], v[156:157]
    v_pk_add_f32 v[118:119], v[118:119], v[158:159]
    v_pk_mul_f32 v[112:113], v[112:113], v[232:233]
    v_pk_mul_f32 v[114:115], v[114:115], v[234:235]
    v_pk_mul_f32 v[116:117], v[116:117], v[236:237]
    v_pk_mul_f32 v[118:119], v[118:119], v[238:239]
    v_cvt_pk_bf16_f32 v52, v112, v113
    v_cvt_pk_bf16_f32 v53, v114, v115
    v_cvt_pk_bf16_f32 v54, v116, v117
    v_cvt_pk_bf16_f32 v55, v118, v119
    s_nop 0
    v_permlane16_swap_b32 v52, v54
    v_permlane16_swap_b32 v53, v55
    buffer_store_dwordx4 v[52:55], v9, s[36:39], s53 offen offset:3072 sc1
    buffer_load_dwordx4 v[140:143], v9, s[36:39], s23 offen offset:1024 sc1
    buffer_load_dwordx4 v[208:211], v9, s[36:39], s22 offen offset:2048 sc1
    buffer_load_dwordx4 v[212:215], v9, s[36:39], s23 offen offset:2048 sc1
    v_mfma_f32_32x32x16_bf16 v[104:119], v[192:195], v[64:67], 0
    v_mfma_f32_32x32x16_bf16 v[104:119], v[196:199], v[68:71], v[104:119]
    s_waitcnt vmcnt(13)
    v_max3_u32 v10, v72, v76, v80
    s_waitcnt vmcnt(11)
    v_max3_u32 v10, v10, v84, v88
    s_waitcnt vmcnt(9)
    v_max3_u32 v10, v10, v92, v96
    s_waitcnt vmcnt(8)
    v_max_u32 v10, v10, v100
    v_cmp_eq_u32 vcc, -1, v10
    s_cbranch_vccnz fz_ra0
fz_ba0:
    v_mfma_f32_32x32x16_bf16 a[32:47], v[124:127], v[76:79], 0
    v_mfma_f32_32x32x16_bf16 a[16:31], v[120:123], v[76:79], 0
    v_mfma_f32_32x32x16_bf16 a[0:15], v[124:127], v[72:75], 0
    v_mfma_f32_32x32x16_bf16 v[104:119], v[120:123], v[72:75], v[104:119]
    v_mfma_f32_32x32x16_bf16 a[32:47], v[180:183], v[84:87], a[32:47]
    v_mfma_f32_32x32x16_bf16 a[16:31], v[176:179], v[84:87], a[16:31]
    v_mfma_f32_32x32x16_bf16 a[0:15], v[180:183], v[80:83], a[0:15]
    v_mfma_f32_32x32x16_bf16 v[104:119], v[176:179], v[80:83], v[104:119]
    v_mfma_f32_32x32x16_bf16 a[32:47], v[188:191], v[92:95], a[32:47]
    v_mfma_f32_32x32x16_bf16 a[16:31], v[184:187], v[92:95], a[16:31]
    v_mfma_f32_32x32x16_bf16 a[0:15], v[188:191], v[88:91], a[0:15]
    v_mfma_f32_32x32x16_bf16 v[104:119], v[184:187], v[88:91], v[104:119]
    v_mfma_f32_32x32x16_bf16 a[32:47], v[204:207], v[100:103], a[32:47]
    s_waitcnt vmcnt(3)
    v_mfma_f32_32x32x16_bf16 a[16:31], v[200:203], v[100:103], a[16:31]
    v_max3_u32 v10, v128, v132, v136
    s_waitcnt vmcnt(1)
    v_max3_u32 v10, v10, v140, v208
    buffer_load_dwordx4 v[144:147], v9, s[36:39], s30 offen offset:0 sc1
    buffer_load_dwordx4 v[148:151], v9, s[36:39], s31 offen offset:0 sc1
    v_mfma_f32_32x32x16_bf16 a[0:15], v[204:207], v[96:99], a[0:15]
    s_waitcnt vmcnt(2)
    v_max_u32 v10, v10, v212
    v_cmp_eq_u32 vcc, -1, v10
    buffer_load_dwordx4 v[152:155], v9, s[36:39], s30 offen offset:1024 sc1
    buffer_load_dwordx4 v[156:159], v9, s[36:39], s31 offen offset:1024 sc1
    v_mfma_f32_32x32x16_bf16 v[104:119], v[200:203], v[96:99], v[104:119]
    s_cbranch_vccnz fz_ra1
fz_ba1:
    buffer_load_dwordx4 v[160:163], v9, s[36:39], s30 offen offset:2048 sc1
    buffer_load_dwordx4 v[164:167], v9, s[36:39], s31 offen offset:2048 sc1
    v_mfma_f32_32x32x16_bf16 a[32:47], v[244:247], v[132:135], a[32:47]
    buffer_load_dwordx4 v[168:171], v9, s[36:39], s30 offen offset:3072 sc1
    buffer_load_dwordx4 v[172:175], v9, s[36:39], s31 offen offset:3072 sc1
    v_mfma_f32_32x32x16_bf16 a[16:31], v[240:243], v[132:135], a[16:31]
    buffer_load_dwordx4 v[216:219], v9, s[36:39], s32 offen offset:0 sc1
    buffer_load_dwordx4 v[220:223], v9, s[36:39], s33 offen offset:0 sc1
    v_mfma_f32_32x32x16_bf16 a[0:15], v[244:247], v[128:131], a[0:15]
    buffer_load_dwordx4 v[224:227], v9, s[36:39], s32 offen offset:1024 sc1
    buffer_load_dwordx4 v[228:231], v9, s[36:39], s33 offen offset:1024 sc1
    v_mfma_f32_32x32x16_bf16 v[104:119], v[240:243], v[128:131], v[104:119]
    buffer_load_dwordx4 v[232:235], v9, s[36:39], s32 offen offset:2048 sc1
    buffer_load_dwordx4 v[236:239], v9, s[36:39], s33 offen offset:2048 sc1
    v_mfma_f32_32x32x16_bf16 a[32:47], v[252:255], v[140:143], a[32:47]
    v_mfma_f32_32x32x16_bf16 a[16:31], v[248:251], v[140:143], a[16:31]
    v_mfma_f32_32x32x16_bf16 a[0:15], v[252:255], v[136:139], a[0:15]
    v_mfma_f32_32x32x16_bf16 v[104:119], v[248:251], v[136:139], v[104:119]
    v_mfma_f32_32x32x16_bf16 a[32:47], a[132:135], v[212:215], a[32:47]
    v_mfma_f32_32x32x16_bf16 a[16:31], a[128:131], v[212:215], a[16:31]
    v_mfma_f32_32x32x16_bf16 a[0:15], a[132:135], v[208:211], a[0:15]
    v_mfma_f32_32x32x16_bf16 v[104:119], a[128:131], v[208:211], v[104:119]
    s_waitcnt vmcnt(11)
    v_max3_u32 v10, v144, v148, v152
    s_waitcnt vmcnt(9)
    v_max3_u32 v10, v10, v156, v160
    s_waitcnt vmcnt(7)
    v_max3_u32 v10, v10, v164, v168
    s_waitcnt vmcnt(6)
    v_max_u32 v10, v10, v172
    v_cmp_eq_u32 vcc, -1, v10
    s_cbranch_vccnz fz_ra2
fz_ba2:
    v_mfma_f32_32x32x16_bf16 a[32:47], a[140:143], v[148:151], a[32:47]
    v_mfma_f32_32x32x16_bf16 a[16:31], a[136:139], v[148:151], a[16:31]
    v_mfma_f32_32x32x16_bf16 a[0:15], a[140:143], v[144:147], a[0:15]
    v_mfma_f32_32x32x16_bf16 v[104:119], a[136:139], v[144:147], v[104:119]
    v_mfma_f32_32x32x16_bf16 a[32:47], a[148:151], v[156:159], a[32:47]
    v_mfma_f32_32x32x16_bf16 a[16:31], a[144:147], v[156:159], a[16:31]
    s_waitcnt vmcnt(3)
    v_max3_u32 v10, v216, v220, v224
    s_waitcnt vmcnt(1)
    v_max3_u32 v10, v10, v228, v232
    v_mfma_f32_32x32x16_bf16 a[0:15], a[148:151], v[152:155], a[0:15]
    s_waitcnt vmcnt(0)
    v_max_u32 v10, v10, v236
    v_cmp_eq_u32 vcc, -1, v10
    v_mfma_f32_32x32x16_bf16 v[104:119], a[144:147], v[152:155], v[104:119]
    s_cbranch_vccnz fz_ra3
fz_ba3:
    v_mfma_f32_32x32x16_bf16 a[32:47], a[156:159], v[164:167], a[32:47]
    v_mfma_f32_32x32x16_bf16 a[32:47], a[164:167], v[172:175], a[32:47]
    v_mfma_f32_32x32x16_bf16 a[32:47], a[172:175], v[220:223], a[32:47]
    v_mfma_f32_32x32x16_bf16 a[32:47], a[180:183], v[228:231], a[32:47]
    v_mfma_f32_32x32x16_bf16 a[32:47], a[188:191], v[236:239], a[32:47]
    v_mfma_f32_32x32x16_bf16 a[16:31], a[152:155], v[164:167], a[16:31]
    v_mfma_f32_32x32x16_bf16 a[16:31], a[160:163], v[172:175], a[16:31]
    s_nop 9
    ds_write_b128 v16, a[32:35] offset:8192
    v_mfma_f32_32x32x16_bf16 a[16:31], a[168:171], v[220:223], a[16:31]
    ds_write_b128 v16, a[36:39] offset:9216
    v_mfma_f32_32x32x16_bf16 a[16:31], a[176:179], v[228:231], a[16:31]
    ds_write_b128 v16, a[40:43] offset:10240
    v_mfma_f32_32x32x16_bf16 a[16:31], a[184:187], v[236:239], a[16:31]
    ds_write_b128 v16, a[44:47] offset:11264
    v_mfma_f32_32x32x16_bf16 a[0:15], a[156:159], v[160:163], a[0:15]
    v_mfma_f32_32x32x16_bf16 a[0:15], a[164:167], v[168:171], a[0:15]
    s_nop 8
    ds_write_b128 v16, a[16:19] offset:4096
    v_mfma_f32_32x32x16_bf16 a[0:15], a[172:175], v[216:219], a[0:15]
    ds_write_b128 v16, a[20:23] offset:5120
    v_mfma_f32_32x32x16_bf16 a[0:15], a[180:183], v[224:227], a[0:15]
    ds_write_b128 v16, a[24:27] offset:6144
    v_mfma_f32_32x32x16_bf16 a[0:15], a[188:191], v[232:235], a[0:15]
    ds_write_b128 v16, a[28:31] offset:7168
    v_mfma_f32_32x32x16_bf16 v[104:119], a[152:155], v[160:163], v[104:119]
    v_mfma_f32_32x32x16_bf16 v[104:119], a[160:163], v[168:171], v[104:119]
    s_nop 8
    ds_write_b128 v16, a[0:3] offset:0
    v_mfma_f32_32x32x16_bf16 v[104:119], a[168:171], v[216:219], v[104:119]
    ds_write_b128 v16, a[4:7] offset:1024
    v_mfma_f32_32x32x16_bf16 v[104:119], a[176:179], v[224:227], v[104:119]
    ds_write_b128 v16, a[8:11] offset:2048
    v_mfma_f32_32x32x16_bf16 v[104:119], a[184:187], v[232:235], v[104:119]
    ds_write_b128 v16, a[12:15] offset:3072
    s_waitcnt lgkmcnt(0)
    s_barrier
    ds_read_b128 v[24:27], v17 offset:0
    ds_read_b128 v[28:31], v18 offset:4096
    ds_read_b128 v[32:35], v19 offset:8192
    ds_read_b128 v[36:39], v17 offset:1024
    ds_read_b128 v[40:43], v18 offset:5120
    ds_read_b128 v[44:47], v19 offset:9216
    ds_read_b128 v[48:51], v17 offset:2048
    ds_read_b128 v[52:55], v18 offset:6144
    ds_read_b128 v[56:59], v19 offset:10240
    ds_read_b128 v[60:63], v17 offset:3072
    ds_read_b128 v[64:67], v18 offset:7168
    ds_read_b128 v[68:71], v19 offset:11264
    s_waitcnt lgkmcnt(10)
    v_pk_add_f32 v[24:25], v[24:25], v[28:29]
    s_waitcnt lgkmcnt(9)
    v_pk_add_f32 v[104:105], v[104:105], v[32:33]
    v_pk_add_f32 v[26:27], v[26:27], v[30:31]
    v_pk_add_f32 v[106:107], v[106:107], v[34:35]
    v_pk_add_f32 v[104:105], v[104:105], v[24:25]
    v_pk_add_f32 v[106:107], v[106:107], v[26:27]
    v_cvt_pk_bf16_f32 v80, v104, v105
    v_cvt_pk_bf16_f32 v81, v106, v107
    s_waitcnt lgkmcnt(7)
    v_pk_add_f32 v[36:37], v[36:37], v[40:41]
    s_waitcnt lgkmcnt(6)
    v_pk_add_f32 v[108:109], v[108:109], v[44:45]
    v_pk_add_f32 v[38:39], v[38:39], v[42:43]
    v_pk_add_f32 v[110:111], v[110:111], v[46:47]
    v_pk_add_f32 v[108:109], v[108:109], v[36:37]
    v_pk_add_f32 v[110:111], v[110:111], v[38:39]
    v_cvt_pk_bf16_f32 v82, v108, v109
    v_cvt_pk_bf16_f32 v83, v110, v111
    s_nop 0
    v_permlane32_swap_b32 v80, v82
    v_permlane32_swap_b32 v81, v83
    s_waitcnt lgkmcnt(4)
    v_pk_add_f32 v[48:49], v[48:49], v[52:53]
    s_waitcnt lgkmcnt(3)
    v_pk_add_f32 v[112:113], v[112:113], v[56:57]
    v_pk_add_f32 v[50:51], v[50:51], v[54:55]
    v_pk_add_f32 v[114:115], v[114:115], v[58:59]
    v_pk_add_f32 v[112:113], v[112:113], v[48:49]
    v_pk_add_f32 v[114:115], v[114:115], v[50:51]
    v_cvt_pk_bf16_f32 v84, v112, v113
    v_cvt_pk_bf16_f32 v85, v114, v115
    s_waitcnt lgkmcnt(1)
    v_pk_add_f32 v[60:61], v[60:61], v[64:65]
    s_waitcnt lgkmcnt(0)
    v_pk_add_f32 v[116:117], v[116:117], v[68:69]
    v_pk_add_f32 v[62:63], v[62:63], v[66:67]
    v_pk_add_f32 v[118:119], v[118:119], v[70:71]
    v_pk_add_f32 v[116:117], v[116:117], v[60:61]
    v_pk_add_f32 v[118:119], v[118:119], v[62:63]
    v_cvt_pk_bf16_f32 v86, v116, v117
    v_cvt_pk_bf16_f32 v87, v118, v119
    s_nop 0
    v_permlane32_swap_b32 v84, v86
    v_permlane32_swap_b32 v85, v87
    s_nop 0
    v_permlane16_swap_b32 v80, v84
    v_permlane16_swap_b32 v81, v85
    v_permlane16_swap_b32 v82, v86
    v_permlane16_swap_b32 v83, v87
    buffer_store_dwordx4 v[80:83], v13, s[44:47], s55 offen
    buffer_store_dwordx4 v[84:87], v13, s[44:47], s56 offen
    s_endpgm
fz_poll:
    s_mov_b32 s54, 0
fz_poll2:
    buffer_load_dwordx4 v[16:19], v6, s[44:47], 0 offen sc0 sc1
    buffer_load_dwordx4 v[20:23], v6, s[44:47], s51 offen sc0 sc1
    buffer_load_dwordx4 v[24:27], v6, s[44:47], s52 offen sc0 sc1
    buffer_load_dwordx4 v[28:31], v6, s[44:47], s53 offen sc0 sc1
    s_add_u32 s54, s54, 1
    s_cmp_ge_u32 s54, 20000
    s_waitcnt vmcnt(0)
    s_cbranch_scc1 fz_go
    s_mov_b64 s[56:57], 0
    v_cmp_ne_u32 vcc, s50, v17
    s_or_b64 s[56:57], s[56:57], vcc
    v_cmp_ne_u32 vcc, s50, v19
    s_or_b64 s[56:57], s[56:57], vcc
    v_cmp_ne_u32 vcc, s50, v21
    s_or_b64 s[56:57], s[56:57], vcc
    v_cmp_ne_u32 vcc, s50, v23
    s_or_b64 s[56:57], s[56:57], vcc
    v_cmp_ne_u32 vcc, s50, v25
    s_or_b64 s[56:57], s[56:57], vcc
    v_cmp_ne_u32 vcc, s50, v27
    s_or_b64 s[56:57], s[56:57], vcc
    v_cmp_ne_u32 vcc, s50, v29
    s_or_b64 s[56:57], s[56:57], vcc
    v_cmp_ne_u32 vcc, s50, v31
    s_or_b64 s[56:57], s[56:57], vcc
    s_cbranch_scc1 fz_poll2
    s_branch fz_go
fz_hrec:
    s_mov_b32 s54, 0
    s_mov_b32 s57, m0
    s_cmp_eq_u32 s59, 99
    s_cbranch_scc1 fz_hr1
fz_hr0:
    s_waitcnt vmcnt(0)
fz_hr1:
    ds_read2st64_b32 a[224:225], v4 offset0:0 offset1:4
    ds_read2st64_b32 a[226:227], v4 offset0:8 offset1:12
    ds_read2st64_b32 a[228:229], v4 offset0:16 offset1:20
    ds_read2st64_b32 a[230:231], v4 offset0:24 offset1:28
    ds_read2st64_b32 a[232:233], v4 offset0:32 offset1:36
    ds_read2st64_b32 a[234:235], v4 offset0:40 offset1:44
    ds_read2st64_b32 a[236:237], v4 offset0:48 offset1:52
    ds_read2st64_b32 a[238:239], v23 offset0:0 offset1:4
    ds_read2st64_b32 a[240:241], v23 offset0:8 offset1:12
    ds_read2st64_b32 a[242:243], v23 offset0:16 offset1:20
    ds_read2st64_b32 a[244:245], v23 offset0:24 offset1:28
    ds_read2st64_b32 a[246:247], v23 offset0:32 offset1:36
    s_mov_b32 s59, 99
    s_waitcnt lgkmcnt(0)
    s_cmp_eq_u32 s58, 1
    s_cbranch_scc1 fz_hc1
    s_cmp_eq_u32 s58, 2
    s_cbranch_scc1 fz_hc2
    s_cmp_eq_u32 s58, 3
    s_cbranch_scc1 fz_hc3
    s_cmp_eq_u32 s58, 4
    s_cbranch_scc1 fz_hc4
    s_cmp_eq_u32 s58, 5
    s_cbranch_scc1 fz_hc5
    s_cmp_eq_u32 s58, 6
    s_cbranch_scc1 fz_hc6
    s_cmp_eq_u32 s58, 7
    s_cbranch_scc1 fz_hc7
    s_cmp_eq_u32 s58, 8
    s_cbranch_scc1 fz_hc8
    s_cmp_eq_u32 s58, 9
    s_cbranch_scc1 fz_hc9
    s_cmp_eq_u32 s58, 10
    s_cbranch_scc1 fz_hc10
    s_cmp_eq_u32 s58, 11
    s_cbranch_scc1 fz_hc11
    s_cmp_eq_u32 s58, 12
    s_cbranch_scc1 fz_hc12
    s_cmp_eq_u32 s58, 13
    s_cbranch_scc1 fz_hc13
fz_hc0:
    v_max_u32 v10, v128, v132
    v_cmp_eq_u32 vcc, -1, v10
    s_cbranch_vccz fz_hc1
    s_add_u32 s56, s53, 0
    s_min_u32 s59, s59, 0
    s_mov_b64 exec, vcc
    buffer_load_dwordx4 v[128:131], v9, s[60:63], s56 offen offset:0 sc1
    buffer_load_dwordx4 v[132:135], v9, s[60:63], s56 offen offset:1024 sc1
    s_mov_b64 exec, -1
fz_hc1:
    v_max_u32 v10, v136, v140
    v_cmp_eq_u32 vcc, -1, v10
    s_cbranch_vccz fz_hc2
    s_add_u32 s56, s53, 0
    s_min_u32 s59, s59, 1
    s_mov_b64 exec, vcc
    buffer_load_dwordx4 v[136:139], v9, s[60:63], s56 offen offset:2048 sc1
    buffer_load_dwordx4 v[140:143], v9, s[60:63], s56 offen offset:3072 sc1
    s_mov_b64 exec, -1
fz_hc2:
    v_accvgpr_read_b32 v18, a224
    v_accvgpr_read_b32 v19, a225
    v_max_u32 v10, v18, v19
    v_cmp_eq_u32 vcc, -1, v10
    s_cbranch_vccz fz_hc3
    s_add_u32 s56, s53, 4096
    s_add_u32 m0, s6, 0
    s_min_u32 s59, s59, 2
    s_mov_b64 exec, vcc
    buffer_load_dwordx4 v0, s[60:63], s56 offen offset:0 sc1 lds
    buffer_load_dwordx4 v0, s[60:63], s56 offen offset:1024 sc1 lds
    s_mov_b64 exec, -1
fz_hc3:
    v_accvgpr_read_b32 v18, a226
    v_accvgpr_read_b32 v19, a227
    v_max_u32 v10, v18, v19
    v_cmp_eq_u32 vcc, -1, v10
    s_cbranch_vccz fz_hc4
    s_add_u32 s56, s53, 4096
    s_add_u32 m0, s6, 0
    s_min_u32 s59, s59, 3
    s_mov_b64 exec, vcc
    buffer_load_dwordx4 v0, s[60:63], s56 offen offset:2048 sc1 lds
    buffer_load_dwordx4 v0, s[60:63], s56 offen offset:3072 sc1 lds
    s_mov_b64 exec, -1
fz_hc4:
    v_accvgpr_read_b32 v18, a228
    v_accvgpr_read_b32 v19, a229
    v_max_u32 v10, v18, v19
    v_cmp_eq_u32 vcc, -1, v10
    s_cbranch_vccz fz_hc5
    s_add_u32 s56, s53, 8192
    s_add_u32 m0, s6, 4096
    s_min_u32 s59, s59, 4
    s_mov_b64 exec, vcc
    buffer_load_dwordx4 v0, s[60:63], s56 offen offset:0 sc1 lds
    buffer_load_dwordx4 v0, s[60:63], s56 offen offset:1024 sc1 lds
    s_mov_b64 exec, -1
fz_hc5:
    v_accvgpr_read_b32 v18, a230
    v_accvgpr_read_b32 v19, a231
    v_max_u32 v10, v18, v19
    v_cmp_eq_u32 vcc, -1, v10
    s_cbranch_vccz fz_hc6
    s_add_u32 s56, s53, 8192
    s_add_u32 m0, s6, 4096
    s_min_u32 s59, s59, 5
    s_mov_b64 exec, vcc
    buffer_load_dwordx4 v0, s[60:63], s56 offen offset:2048 sc1 lds
    buffer_load_dwordx4 v0, s[60:63], s56 offen offset:3072 sc1 lds
    s_mov_b64 exec, -1
fz_hc6:
    v_accvgpr_read_b32 v18, a232
    v_accvgpr_read_b32 v19, a233
    v_max_u32 v10, v18, v19
    v_cmp_eq_u32 vcc, -1, v10
    s_cbranch_vccz fz_hc7
    s_add_u32 s56, s53, 12288
    s_add_u32 m0, s6, 8192
    s_min_u32 s59, s59, 6
    s_mov_b64 exec, vcc
    buffer_load_dwordx4 v0, s[60:63], s56 offen offset:0 sc1 lds
    buffer_load_dwordx4 v0, s[60:63], s56 offen offset:1024 sc1 lds
    s_mov_b64 exec, -1
fz_hc7:
    v_accvgpr_read_b32 v18, a234
    v_accvgpr_read_b32 v19, a235
    v_max_u32 v10, v18, v19
    v_cmp_eq_u32 vcc, -1, v10
    s_cbranch_vccz fz_hc8
    s_add_u32 s56, s53, 12288
    s_add_u32 m0, s6, 8192
    s_min_u32 s59, s59, 7
    s_mov_b64 exec, vcc
    buffer_load_dwordx4 v0, s[60:63], s56 offen offset:2048 sc1 lds
    buffer_load_dwordx4 v0, s[60:63], s56 offen offset:3072 sc1 lds
    s_mov_b64 exec, -1
fz_hc8:
    s_cmp_lt_u32 s85, 8
    s_cbranch_scc1 fz_hc14
    v_accvgpr_read_b32 v18, a236
    v_accvgpr_read_b32 v19, a237
    v_max_u32 v10, v18, v19
    v_cmp_eq_u32 vcc, -1, v10
    s_cbranch_vccz fz_hc9
    s_add_u32 s56, s53, 16384
    s_add_u32 m0, s6, 12288
    s_min_u32 s59, s59, 8
    s_mov_b64 exec, vcc
    buffer_load_dwordx4 v0, s[60:63], s56 offen offset:0 sc1 lds
    buffer_load_dwordx4 v0, s[60:63], s56 offen offset:1024 sc1 lds
    s_mov_b64 exec, -1
fz_hc9:
    s_cmp_lt_u32 s85, 9
    s_cbranch_scc1 fz_hc14
    v_accvgpr_read_b32 v18, a238
    v_accvgpr_read_b32 v19, a239
    v_max_u32 v10, v18, v19
    v_cmp_eq_u32 vcc, -1, v10
    s_cbranch_vccz fz_hc10
    s_add_u32 s56, s53, 16384
    s_sub_u32 m0, s7, 2048
    s_min_u32 s59, s59, 9
    s_mov_b64 exec, vcc
    buffer_load_dwordx4 v0, s[60:63], s56 offen offset:2048 sc1 lds
    buffer_load_dwordx4 v0, s[60:63], s56 offen offset:3072 sc1 lds
    s_mov_b64 exec, -1
fz_hc10:
    s_cmp_lt_u32 s85, 10
    s_cbranch_scc1 fz_hc14
    v_accvgpr_read_b32 v18, a240
    v_accvgpr_read_b32 v19, a241
    v_max_u32 v10, v18, v19
    v_cmp_eq_u32 vcc, -1, v10
    s_cbranch_vccz fz_hc11
    s_add_u32 s56, s53, 20480
    s_add_u32 m0, s7, 2048
    s_min_u32 s59, s59, 10
    s_mov_b64 exec, vcc
    buffer_load_dwordx4 v0, s[60:63], s56 offen offset:0 sc1 lds
    buffer_load_dwordx4 v0, s[60:63], s56 offen offset:1024 sc1 lds
    s_mov_b64 exec, -1
fz_hc11:
    s_cmp_lt_u32 s85, 11
    s_cbranch_scc1 fz_hc14
    v_accvgpr_read_b32 v18, a242
    v_accvgpr_read_b32 v19, a243
    v_max_u32 v10, v18, v19
    v_cmp_eq_u32 vcc, -1, v10
    s_cbranch_vccz fz_hc12
    s_add_u32 s56, s53, 20480
    s_add_u32 m0, s7, 2048
    s_min_u32 s59, s59, 11
    s_mov_b64 exec, vcc
    buffer_load_dwordx4 v0, s[60:63], s56 offen offset:2048 sc1 lds
    buffer_load_dwordx4 v0, s[60:63], s56 offen offset:3072 sc1 lds
    s_mov_b64 exec, -1
fz_hc12:
    s_cmp_lt_u32 s85, 12
    s_cbranch_scc1 fz_hc14
    v_accvgpr_read_b32 v18, a244
    v_accvgpr_read_b32 v19, a245
    v_max_u32 v10, v18, v19
    v_cmp_eq_u32 vcc, -1, v10
    s_cbranch_vccz fz_hc13
    s_add_u32 s56, s53, 24576
    s_add_u32 m0, s7, 6144
    s_min_u32 s59, s59, 12
    s_mov_b64 exec, vcc
    buffer_load_dwordx4 v0, s[60:63], s56 offen offset:0 sc1 lds
    buffer_load_dwordx4 v0, s[60:63], s56 offen offset:1024 sc1 lds
    s_mov_b64 exec, -1
fz_hc13:
    s_cmp_lt_u32 s85, 13
    s_cbranch_scc1 fz_hc14
    v_accvgpr_read_b32 v18, a246
    v_accvgpr_read_b32 v19, a247
    v_max_u32 v10, v18, v19
    v_cmp_eq_u32 vcc, -1, v10
    s_cbranch_vccz fz_hc14
    s_add_u32 s56, s53, 24576
    s_add_u32 m0, s7, 6144
    s_min_u32 s59, s59, 13
    s_mov_b64 exec, vcc
    buffer_load_dwordx4 v0, s[60:63], s56 offen offset:2048 sc1 lds
    buffer_load_dwordx4 v0, s[60:63], s56 offen offset:3072 sc1 lds
    s_mov_b64 exec, -1
fz_hc14:
    s_add_u32 s54, s54, 1
    s_cmp_ge_u32 s54, 20000
    s_cbranch_scc1 fz_hx
    s_cmp_eq_u32 s59, s58
    s_cbranch_scc1 fz_hr0
fz_hx:
    s_cmp_eq_u32 s59, 99
    s_cselect_b32 s101, -1, 0
    s_mov_b32 m0, s57
    s_cmp_eq_u32 s58, 0
    s_cbranch_scc1 fz_bh0
    s_cmp_eq_u32 s58, 1
    s_cbranch_scc1 fz_bh1
    s_cmp_eq_u32 s58, 2
    s_cbranch_scc1 fz_bh2
    s_cmp_eq_u32 s58, 3
    s_cbranch_scc1 fz_bh3
    s_cmp_eq_u32 s58, 4
    s_cbranch_scc1 fz_bh4
    s_cmp_eq_u32 s58, 5
    s_cbranch_scc1 fz_bh5
    s_cmp_eq_u32 s58, 6
    s_cbranch_scc1 fz_bh6
    s_cmp_eq_u32 s58, 7
    s_cbranch_scc1 fz_bh7
    s_cmp_eq_u32 s58, 8
    s_cbranch_scc1 fz_bh8
    s_cmp_eq_u32 s58, 9
    s_cbranch_scc1 fz_bh9
    s_cmp_eq_u32 s58, 10
    s_cbranch_scc1 fz_bh10
    s_cmp_eq_u32 s58, 11
    s_cbranch_scc1 fz_bh11
    s_cmp_eq_u32 s58, 12
    s_cbranch_scc1 fz_bh12
    s_branch fz_bh13
fz_rh0:
    s_waitcnt vmcnt(0)
    s_mov_b32 s58, 0
    s_mov_b32 s85, 7
    s_branch fz_hrec
fz_rh1:
    s_waitcnt vmcnt(0)
    s_mov_b32 s58, 1
    s_mov_b32 s85, 7
    s_branch fz_hrec
fz_rh2:
    s_waitcnt vmcnt(1)
    s_mov_b32 s58, 2
    s_mov_b32 s85, 7
    s_branch fz_hrec
fz_rh3:
    s_waitcnt vmcnt(0)
    s_mov_b32 s58, 3
    s_mov_b32 s85, 8
    s_branch fz_hrec
fz_rh4:
    s_waitcnt vmcnt(1)
    s_mov_b32 s58, 4
    s_mov_b32 s85, 9
    s_branch fz_hrec
fz_rh5:
    s_waitcnt vmcnt(1)
    s_mov_b32 s58, 5
    s_mov_b32 s85, 10
    s_branch fz_hrec
fz_rh6:
    s_waitcnt vmcnt(1)
    s_mov_b32 s58, 6
    s_mov_b32 s85, 11
    s_branch fz_hrec
fz_rh7:
    s_waitcnt vmcnt(0)
    s_mov_b32 s58, 7
    s_mov_b32 s85, 13
    s_branch fz_hrec
fz_rh8:
    s_waitcnt vmcnt(2)
    s_mov_b32 s58, 8
    s_mov_b32 s85, 13
    s_branch fz_hrec
fz_rh9:
    s_waitcnt vmcnt(4)
    s_mov_b32 s58, 9
    s_mov_b32 s85, 13
    s_branch fz_hrec
fz_rh10:
    s_waitcnt vmcnt(6)
    s_mov_b32 s58, 10
    s_mov_b32 s85, 13
    s_branch fz_hrec
fz_rh11:
    s_waitcnt vmcnt(8)
    s_mov_b32 s58, 11
    s_mov_b32 s85, 13
    s_branch fz_hrec
fz_rh12:
    s_waitcnt vmcnt(10)
    s_mov_b32 s58, 12
    s_mov_b32 s85, 13
    s_branch fz_hrec
fz_rh13:
    s_waitcnt vmcnt(63)
    s_mov_b32 s58, 13
    s_mov_b32 s85, 13
    s_branch fz_hrec
fz_rx:
    s_mov_b32 s54, 0
fz_lx:
    buffer_load_dwordx2 v[128:129], v125, s[36:39], s40 offen offset:0 sc0 sc1
    buffer_load_dwordx2 v[130:131], v125, s[36:39], s40 offen offset:256 sc0 sc1
    buffer_load_dwordx2 v[132:133], v125, s[36:39], s40 offen offset:512 sc0 sc1
    buffer_load_dwordx2 v[134:135], v125, s[36:39], s40 offen offset:768 sc0 sc1
    buffer_load_dwordx2 v[136:137], v125, s[36:39], s40 offen offset:1024 sc0 sc1
    buffer_load_dwordx2 v[138:139], v125, s[36:39], s40 offen offset:1280 sc0 sc1
    buffer_load_dwordx2 v[140:141], v125, s[36:39], s40 offen offset:1536 sc0 sc1
    s_add_u32 s54, s54, 1
    s_cmp_ge_u32 s54, 20000
    s_waitcnt vmcnt(0)
    s_cbranch_scc1 fz_bx
    v_or3_b32 v10, v129, v131, v133
    v_or3_b32 v10, v10, v135, v137
    v_or3_b32 v10, v10, v139, v141
    v_cmp_gt_i32 vcc, 0, v10
    s_cbranch_vccnz fz_lx
    s_branch fz_bx
fz_rz0:
    s_mov_b32 s54, 0
    s_add_u32 s56, s31, 0
    s_and_b32 s56, s56, 7
    s_lshl_b32 s56, s56, 14
    s_add_u32 s56, s56, s101
    s_add_u32 s55, s56, 0
    s_mov_b32 s57, m0
    s_add_u32 m0, s33, 0
fz_lz0:
    s_nop 0
    buffer_load_dwordx4 v9, s[44:47], s56 offen offset:0 sc1 lds
    buffer_load_dwordx4 v9, s[44:47], s56 offen offset:1024 sc1 lds
    buffer_load_dwordx4 v9, s[44:47], s55 offen offset:2048 sc1 lds
    buffer_load_dwordx4 v9, s[44:47], s55 offen offset:3072 sc1 lds
    s_add_u32 s54, s54, 1
    s_cmp_ge_u32 s54, 20000
    s_waitcnt vmcnt(0)
    s_cbranch_scc1 fz_xz0
    ds_read2st64_b32 v[56:57], v4 offset0:0 offset1:4
    ds_read2st64_b32 v[58:59], v4 offset0:8 offset1:12
    s_waitcnt lgkmcnt(0)
    v_max3_u32 v60, v56, v57, v58
    v_max_u32 v60, v60, v59
    v_cmp_eq_u32 vcc, -1, v60
    s_cbranch_vccnz fz_lz0
fz_xz0:
    s_mov_b32 m0, s57
    s_branch fz_bz0
fz_rp0:
    s_mov_b32 s54, 0
fz_lp0:
    buffer_load_dwordx4 v[160:163], v9, s[96:99], s85 offen offset:0 sc1
    buffer_load_dwordx4 v[164:167], v9, s[96:99], s85 offen offset:1024 sc1
    s_add_u32 s54, s54, 1
    s_cmp_ge_u32 s54, 20000
    s_waitcnt vmcnt(0)
    s_cbranch_scc1 fz_bp0
    v_max_u32 v61, v160, v164
    v_cmp_eq_u32 vcc, -1, v61
    s_cbranch_vccnz fz_lp0
    s_branch fz_bp0
fz_rp1:
    s_mov_b32 s54, 0
fz_lp1:
    buffer_load_dwordx4 v[168:171], v9, s[96:99], s85 offen offset:2048 sc1
    buffer_load_dwordx4 v[172:175], v9, s[96:99], s85 offen offset:3072 sc1
    s_add_u32 s54, s54, 1
    s_cmp_ge_u32 s54, 20000
    s_waitcnt vmcnt(0)
    s_cbranch_scc1 fz_bp1
    v_max_u32 v61, v168, v172
    v_cmp_eq_u32 vcc, -1, v61
    s_cbranch_vccnz fz_lp1
    s_branch fz_bp1
fz_rz1:
    s_mov_b32 s54, 0
    s_add_u32 s56, s31, 1
    s_and_b32 s56, s56, 7
    s_lshl_b32 s56, s56, 14
    s_add_u32 s56, s56, s101
    s_add_u32 s55, s56, 0
    s_mov_b32 s57, m0
    s_add_u32 m0, s33, 16384
fz_lz1:
    s_nop 0
    buffer_load_dwordx4 v9, s[44:47], s56 offen offset:0 sc1 lds
    buffer_load_dwordx4 v9, s[44:47], s56 offen offset:1024 sc1 lds
    buffer_load_dwordx4 v9, s[44:47], s55 offen offset:2048 sc1 lds
    buffer_load_dwordx4 v9, s[44:47], s55 offen offset:3072 sc1 lds
    s_add_u32 s54, s54, 1
    s_cmp_ge_u32 s54, 20000
    s_waitcnt vmcnt(0)
    s_cbranch_scc1 fz_xz1
    ds_read2st64_b32 v[56:57], v4 offset0:64 offset1:68
    ds_read2st64_b32 v[58:59], v4 offset0:72 offset1:76
    s_waitcnt lgkmcnt(0)
    v_max3_u32 v60, v56, v57, v58
    v_max_u32 v60, v60, v59
    v_cmp_eq_u32 vcc, -1, v60
    s_cbranch_vccnz fz_lz1
fz_xz1:
    s_mov_b32 m0, s57
    s_branch fz_bz1
fz_rz2:
    s_mov_b32 s54, 0
    s_add_u32 s56, s31, 2
    s_and_b32 s56, s56, 7
    s_lshl_b32 s56, s56, 14
    s_add_u32 s56, s56, s101
    s_add_u32 s55, s56, 0
    s_mov_b32 s57, m0
    s_add_u32 m0, s33, 32768
fz_lz2:
    s_nop 0
    buffer_load_dwordx4 v9, s[44:47], s56 offen offset:0 sc1 lds
    buffer_load_dwordx4 v9, s[44:47], s56 offen offset:1024 sc1 lds
    buffer_load_dwordx4 v9, s[44:47], s55 offen offset:2048 sc1 lds
    buffer_load_dwordx4 v9, s[44:47], s55 offen offset:3072 sc1 lds
    s_add_u32 s54, s54, 1
    s_cmp_ge_u32 s54, 20000
    s_waitcnt vmcnt(0)
    s_cbranch_scc1 fz_xz2
    ds_read2st64_b32 v[56:57], v4 offset0:128 offset1:132
    ds_read2st64_b32 v[58:59], v4 offset0:136 offset1:140
    s_waitcnt lgkmcnt(0)
    v_max3_u32 v60, v56, v57, v58
    v_max_u32 v60, v60, v59
    v_cmp_eq_u32 vcc, -1, v60
    s_cbranch_vccnz fz_lz2
fz_xz2:
    s_mov_b32 m0, s57
    s_branch fz_bz2
fz_rz3:
    s_mov_b32 s54, 0
    s_add_u32 s56, s31, 3
    s_and_b32 s56, s56, 7
    s_lshl_b32 s56, s56, 14
    s_add_u32 s56, s56, s101
    s_add_u32 s55, s56, 0
    s_mov_b32 s57, m0
    s_add_u32 m0, s33, 49152
fz_lz3:
    s_nop 0
    buffer_load_dwordx4 v9, s[44:47], s56 offen offset:0 sc1 lds
    buffer_load_dwordx4 v9, s[44:47], s56 offen offset:1024 sc1 lds
    buffer_load_dwordx4 v9, s[44:47], s55 offen offset:2048 sc1 lds
    buffer_load_dwordx4 v9, s[44:47], s55 offen offset:3072 sc1 lds
    s_add_u32 s54, s54, 1
    s_cmp_ge_u32 s54, 20000
    s_waitcnt vmcnt(0)
    s_cbranch_scc1 fz_xz3
    ds_read2st64_b32 v[56:57], v4 offset0:192 offset1:196
    ds_read2st64_b32 v[58:59], v4 offset0:200 offset1:204
    s_waitcnt lgkmcnt(0)
    v_max3_u32 v60, v56, v57, v58
    v_max_u32 v60, v60, v59
    v_cmp_eq_u32 vcc, -1, v60
    s_cbranch_vccnz fz_lz3
fz_xz3:
    s_mov_b32 m0, s57
    s_branch fz_bz3
fz_rz4:
    s_mov_b32 s54, 0
    s_add_u32 s56, s31, 4
    s_and_b32 s56, s56, 7
    s_lshl_b32 s56, s56, 14
    s_add_u32 s56, s56, s101
    s_add_u32 s55, s56, 0
    s_mov_b32 s57, m0
    s_add_u32 m0, s33, 65536
fz_lz4:
    s_nop 0
    buffer_load_dwordx4 v9, s[44:47], s56 offen offset:0 sc1 lds
    buffer_load_dwordx4 v9, s[44:47], s56 offen offset:1024 sc1 lds
    buffer_load_dwordx4 v9, s[44:47], s55 offen offset:2048 sc1 lds
    buffer_load_dwordx4 v9, s[44:47], s55 offen offset:3072 sc1 lds
    s_add_u32 s54, s54, 1
    s_cmp_ge_u32 s54, 20000
    s_waitcnt vmcnt(0)
    s_cbranch_scc1 fz_xz4
    ds_read2st64_b32 v[56:57], v5 offset0:0 offset1:4
    ds_read2st64_b32 v[58:59], v5 offset0:8 offset1:12
    s_waitcnt lgkmcnt(0)
    v_max3_u32 v60, v56, v57, v58
    v_max_u32 v60, v60, v59
    v_cmp_eq_u32 vcc, -1, v60
    s_cbranch_vccnz fz_lz4
fz_xz4:
    s_mov_b32 m0, s57
    s_branch fz_bz4
fz_rz5:
    s_mov_b32 s54, 0
    s_add_u32 s56, s31, 5
    s_and_b32 s56, s56, 7
    s_lshl_b32 s56, s56, 14
    s_add_u32 s56, s56, s101
    s_add_u32 s55, s56, 0
    s_mov_b32 s57, m0
    s_add_u32 m0, s33, 81920
fz_lz5:
    s_nop 0
    buffer_load_dwordx4 v9, s[44:47], s56 offen offset:0 sc1 lds
    buffer_load_dwordx4 v9, s[44:47], s56 offen offset:1024 sc1 lds
    buffer_load_dwordx4 v9, s[44:47], s55 offen offset:2048 sc1 lds
    buffer_load_dwordx4 v9, s[44:47], s55 offen offset:3072 sc1 lds
    s_add_u32 s54, s54, 1
    s_cmp_ge_u32 s54, 20000
    s_waitcnt vmcnt(0)
    s_cbranch_scc1 fz_xz5
    ds_read2st64_b32 v[56:57], v5 offset0:64 offset1:68
    ds_read2st64_b32 v[58:59], v5 offset0:72 offset1:76
    s_waitcnt lgkmcnt(0)
    v_max3_u32 v60, v56, v57, v58
    v_max_u32 v60, v60, v59
    v_cmp_eq_u32 vcc, -1, v60
    s_cbranch_vccnz fz_lz5
fz_xz5:
    s_mov_b32 m0, s57
    s_branch fz_bz5
fz_rz6:
    s_mov_b32 s54, 0
    s_add_u32 s56, s31, 6
    s_and_b32 s56, s56, 7
    s_lshl_b32 s56, s56, 14
    s_add_u32 s56, s56, s101
    s_add_u32 s55, s56, 0
    s_mov_b32 s57, m0
    s_add_u32 m0, s33, 98304
fz_lz6:
    s_nop 0
    buffer_load_dwordx4 v9, s[44:47], s56 offen offset:0 sc1 lds
    buffer_load_dwordx4 v9, s[44:47], s56 offen offset:1024 sc1 lds
    buffer_load_dwordx4 v9, s[44:47], s55 offen offset:2048 sc1 lds
    buffer_load_dwordx4 v9, s[44:47], s55 offen offset:3072 sc1 lds
    s_add_u32 s54, s54, 1
    s_cmp_ge_u32 s54, 20000
    s_waitcnt vmcnt(0)
    s_cbranch_scc1 fz_xz6
    ds_read2st64_b32 v[56:57], v5 offset0:128 offset1:132
    ds_read2st64_b32 v[58:59], v5 offset0:136 offset1:140
    s_waitcnt lgkmcnt(0)
    v_max3_u32 v60, v56, v57, v58
    v_max_u32 v60, v60, v59
    v_cmp_eq_u32 vcc, -1, v60
    s_cbranch_vccnz fz_lz6
fz_xz6:
    s_mov_b32 m0, s57
    s_branch fz_bz6
fz_rz7:
    s_mov_b32 s54, 0
    s_add_u32 s56, s31, 7
    s_and_b32 s56, s56, 7
    s_lshl_b32 s56, s56, 14
    s_add_u32 s56, s56, s101
    s_add_u32 s55, s56, 0
    s_mov_b32 s57, m0
    s_add_u32 m0, s33, 0
fz_lz7:
    s_nop 0
    buffer_load_dwordx4 v9, s[44:47], s56 offen offset:0 sc1 lds
    buffer_load_dwordx4 v9, s[44:47], s56 offen offset:1024 sc1 lds
    buffer_load_dwordx4 v9, s[44:47], s55 offen offset:2048 sc1 lds
    buffer_load_dwordx4 v9, s[44:47], s55 offen offset:3072 sc1 lds
    s_add_u32 s54, s54, 1
    s_cmp_ge_u32 s54, 20000
    s_waitcnt vmcnt(0)
    s_cbranch_scc1 fz_xz7
    ds_read2st64_b32 v[56:57], v4 offset0:0 offset1:4
    ds_read2st64_b32 v[58:59], v4 offset0:8 offset1:12
    s_waitcnt lgkmcnt(0)
    v_max3_u32 v60, v56, v57, v58
    v_max_u32 v60, v60, v59
    v_cmp_eq_u32 vcc, -1, v60
    s_cbranch_vccnz fz_lz7
fz_xz7:
    s_mov_b32 m0, s57
    s_branch fz_bz7
fz_rz8:
    s_mov_b32 s54, 0
    s_add_u32 s56, s31, 4
    s_add_u32 s56, s56, s24
    s_and_b32 s56, s56, 7
    s_lshl_b32 s56, s56, 14
    s_add_u32 s56, s56, s49
    s_add_u32 s55, s56, 2048
    s_mov_b32 s57, m0
    s_add_u32 m0, s33, 16384
fz_lz8:
    s_nop 0
    buffer_load_dwordx4 v9, s[44:47], s56 offen offset:0 sc1 lds
    buffer_load_dwordx4 v9, s[44:47], s56 offen offset:1024 sc1 lds
    buffer_load_dwordx4 v9, s[44:47], s55 offen offset:2048 sc1 lds
    buffer_load_dwordx4 v9, s[44:47], s55 offen offset:3072 sc1 lds
    s_add_u32 s54, s54, 1
    s_cmp_ge_u32 s54, 20000
    s_waitcnt vmcnt(0)
    s_cbranch_scc1 fz_xz8
    ds_read2st64_b32 v[56:57], v4 offset0:64 offset1:68
    ds_read2st64_b32 v[58:59], v4 offset0:72 offset1:76
    s_waitcnt lgkmcnt(0)
    v_max3_u32 v60, v56, v57, v58
    v_max_u32 v60, v60, v59
    v_cmp_eq_u32 vcc, -1, v60
    s_cbranch_vccnz fz_lz8
fz_xz8:
    s_mov_b32 m0, s57
    s_branch fz_bz8
fz_rf2:
    s_mov_b32 s54, 0
fz_lf2:
    global_load_dword v252, v253, s[26:27] offset:0 sc0 sc1
    s_add_u32 s54, s54, 1
    s_cmp_ge_u32 s54, 20000
    s_cbranch_scc1 fz_xf2
    s_waitcnt vmcnt(0)
    v_cmp_ne_u32 vcc, s50, v252
    s_cbranch_vccnz fz_lf2
fz_xf2:
    s_waitcnt vmcnt(0)
    s_branch fz_bf2
fz_rz9:
    s_mov_b32 s54, 0
    s_add_u32 s56, s31, 6
    s_add_u32 s56, s56, s24
    s_and_b32 s56, s56, 7
    s_lshl_b32 s56, s56, 14
    s_add_u32 s56, s56, s49
    s_add_u32 s55, s56, 2048
    s_mov_b32 s57, m0
    s_add_u32 m0, s33, 32768
fz_lz9:
    s_nop 0
    buffer_load_dwordx4 v9, s[44:47], s56 offen offset:0 sc1 lds
    buffer_load_dwordx4 v9, s[44:47], s56 offen offset:1024 sc1 lds
    buffer_load_dwordx4 v9, s[44:47], s55 offen offset:2048 sc1 lds
    buffer_load_dwordx4 v9, s[44:47], s55 offen offset:3072 sc1 lds
    s_add_u32 s54, s54, 1
    s_cmp_ge_u32 s54, 20000
    s_waitcnt vmcnt(0)
    s_cbranch_scc1 fz_xz9
    ds_read2st64_b32 v[56:57], v4 offset0:128 offset1:132
    ds_read2st64_b32 v[58:59], v4 offset0:136 offset1:140
    s_waitcnt lgkmcnt(0)
    v_max3_u32 v60, v56, v57, v58
    v_max_u32 v60, v60, v59
    v_cmp_eq_u32 vcc, -1, v60
    s_cbranch_vccnz fz_lz9
fz_xz9:
    s_mov_b32 m0, s57
    s_branch fz_bz9
fz_rz10:
    s_mov_b32 s54, 0
    s_add_u32 s56, s31, 0
    s_add_u32 s56, s56, s24
    s_and_b32 s56, s56, 7
    s_lshl_b32 s56, s56, 14
    s_add_u32 s56, s56, s49
    s_add_u32 s55, s56, 2048
    s_mov_b32 s57, m0
    s_add_u32 m0, s33, 49152
fz_lz10:
    s_nop 0
    buffer_load_dwordx4 v9, s[44:47], s56 offen offset:0 sc1 lds
    buffer_load_dwordx4 v9, s[44:47], s56 offen offset:1024 sc1 lds
    buffer_load_dwordx4 v9, s[44:47], s55 offen offset:2048 sc1 lds
    buffer_load_dwordx4 v9, s[44:47], s55 offen offset:3072 sc1 lds
    s_add_u32 s54, s54, 1
    s_cmp_ge_u32 s54, 20000
    s_waitcnt vmcnt(0)
    s_cbranch_scc1 fz_xz10
    ds_read2st64_b32 v[56:57], v4 offset0:192 offset1:196
    ds_read2st64_b32 v[58:59], v4 offset0:200 offset1:204
    s_waitcnt lgkmcnt(0)
    v_max3_u32 v60, v56, v57, v58
    v_max_u32 v60, v60, v59
    v_cmp_eq_u32 vcc, -1, v60
    s_cbranch_vccnz fz_lz10
fz_xz10:
    s_mov_b32 m0, s57
    s_branch fz_bz10
fz_rz11:
    s_mov_b32 s54, 0
    s_add_u32 s56, s31, 2
    s_add_u32 s56, s56, s24
    s_and_b32 s56, s56, 7
    s_lshl_b32 s56, s56, 14
    s_add_u32 s56, s56, s49
    s_add_u32 s55, s56, 2048
    s_mov_b32 s57, m0
    s_add_u32 m0, s33, 65536
fz_lz11:
    s_nop 0
    buffer_load_dwordx4 v9, s[44:47], s56 offen offset:0 sc1 lds
    buffer_load_dwordx4 v9, s[44:47], s56 offen offset:1024 sc1 lds
    buffer_load_dwordx4 v9, s[44:47], s55 offen offset:2048 sc1 lds
    buffer_load_dwordx4 v9, s[44:47], s55 offen offset:3072 sc1 lds
    s_add_u32 s54, s54, 1
    s_cmp_ge_u32 s54, 20000
    s_waitcnt vmcnt(0)
    s_cbranch_scc1 fz_xz11
    ds_read2st64_b32 v[56:57], v5 offset0:0 offset1:4
    ds_read2st64_b32 v[58:59], v5 offset0:8 offset1:12
    s_waitcnt lgkmcnt(0)
    v_max3_u32 v60, v56, v57, v58
    v_max_u32 v60, v60, v59
    v_cmp_eq_u32 vcc, -1, v60
    s_cbranch_vccnz fz_lz11
fz_xz11:
    s_mov_b32 m0, s57
    s_branch fz_bz11
fz_rz12:
    s_mov_b32 s54, 0
    s_add_u32 s56, s31, 4
    s_add_u32 s56, s56, s24
    s_and_b32 s56, s56, 7
    s_lshl_b32 s56, s56, 14
    s_add_u32 s56, s56, s49
    s_add_u32 s56, s56, 2048
    s_add_u32 s55, s56, 2048
    s_mov_b32 s57, m0
    s_add_u32 m0, s33, 81920
fz_lz12:
    s_nop 0
    buffer_load_dwordx4 v9, s[44:47], s56 offen offset:0 sc1 lds
    buffer_load_dwordx4 v9, s[44:47], s56 offen offset:1024 sc1 lds
    buffer_load_dwordx4 v9, s[44:47], s55 offen offset:2048 sc1 lds
    buffer_load_dwordx4 v9, s[44:47], s55 offen offset:3072 sc1 lds
    s_add_u32 s54, s54, 1
    s_cmp_ge_u32 s54, 20000
    s_waitcnt vmcnt(0)
    s_cbranch_scc1 fz_xz12
    ds_read2st64_b32 v[56:57], v5 offset0:64 offset1:68
    ds_read2st64_b32 v[58:59], v5 offset0:72 offset1:76
    s_waitcnt lgkmcnt(0)
    v_max3_u32 v60, v56, v57, v58
    v_max_u32 v60, v60, v59
    v_cmp_eq_u32 vcc, -1, v60
    s_cbranch_vccnz fz_lz12
fz_xz12:
    s_mov_b32 m0, s57
    s_branch fz_bz12
fz_rz13:
    s_mov_b32 s54, 0
    s_add_u32 s56, s31, 6
    s_add_u32 s56, s56, s24
    s_and_b32 s56, s56, 7
    s_lshl_b32 s56, s56, 14
    s_add_u32 s56, s56, s49
    s_add_u32 s56, s56, 2048
    s_add_u32 s55, s56, 2048
    s_mov_b32 s57, m0
    s_add_u32 m0, s33, 98304
fz_lz13:
    s_nop 0
    buffer_load_dwordx4 v9, s[44:47], s56 offen offset:0 sc1 lds
    buffer_load_dwordx4 v9, s[44:47], s56 offen offset:1024 sc1 lds
    buffer_load_dwordx4 v9, s[44:47], s55 offen offset:2048 sc1 lds
    buffer_load_dwordx4 v9, s[44:47], s55 offen offset:3072 sc1 lds
    s_add_u32 s54, s54, 1
    s_cmp_ge_u32 s54, 20000
    s_waitcnt vmcnt(0)
    s_cbranch_scc1 fz_xz13
    ds_read2st64_b32 v[56:57], v5 offset0:128 offset1:132
    ds_read2st64_b32 v[58:59], v5 offset0:136 offset1:140
    s_waitcnt lgkmcnt(0)
    v_max3_u32 v60, v56, v57, v58
    v_max_u32 v60, v60, v59
    v_cmp_eq_u32 vcc, -1, v60
    s_cbranch_vccnz fz_lz13
fz_xz13:
    s_mov_b32 m0, s57
    s_branch fz_bz13
fz_rz14:
    s_mov_b32 s54, 0
    s_add_u32 s56, s31, 0
    s_add_u32 s56, s56, s24
    s_and_b32 s56, s56, 7
    s_lshl_b32 s56, s56, 14
    s_add_u32 s56, s56, s49
    s_add_u32 s56, s56, 2048
    s_add_u32 s55, s56, 2048
    s_mov_b32 s57, m0
    s_add_u32 m0, s33, 0
fz_lz14:
    s_nop 0
    buffer_load_dwordx4 v9, s[44:47], s56 offen offset:0 sc1 lds
    buffer_load_dwordx4 v9, s[44:47], s56 offen offset:1024 sc1 lds
    buffer_load_dwordx4 v9, s[44:47], s55 offen offset:2048 sc1 lds
    buffer_load_dwordx4 v9, s[44:47], s55 offen offset:3072 sc1 lds
    s_add_u32 s54, s54, 1
    s_cmp_ge_u32 s54, 20000
    s_waitcnt vmcnt(0)
    s_cbranch_scc1 fz_xz14
    ds_read2st64_b32 v[56:57], v4 offset0:0 offset1:4
    ds_read2st64_b32 v[58:59], v4 offset0:8 offset1:12
    s_waitcnt lgkmcnt(0)
    v_max3_u32 v60, v56, v57, v58
    v_max_u32 v60, v60, v59
    v_cmp_eq_u32 vcc, -1, v60
    s_cbranch_vccnz fz_lz14
fz_xz14:
    s_mov_b32 m0, s57
    s_branch fz_bz14
fz_rz15:
    s_mov_b32 s54, 0
    s_add_u32 s56, s31, 2
    s_add_u32 s56, s56, s24
    s_and_b32 s56, s56, 7
    s_lshl_b32 s56, s56, 14
    s_add_u32 s56, s56, s49
    s_add_u32 s56, s56, 2048
    s_add_u32 s55, s56, 2048
    s_mov_b32 s57, m0
    s_add_u32 m0, s33, 16384
fz_lz15:
    s_nop 0
    buffer_load_dwordx4 v9, s[44:47], s56 offen offset:0 sc1 lds
    buffer_load_dwordx4 v9, s[44:47], s56 offen offset:1024 sc1 lds
    buffer_load_dwordx4 v9, s[44:47], s55 offen offset:2048 sc1 lds
    buffer_load_dwordx4 v9, s[44:47], s55 offen offset:3072 sc1 lds
    s_add_u32 s54, s54, 1
    s_cmp_ge_u32 s54, 20000
    s_waitcnt vmcnt(0)
    s_cbranch_scc1 fz_xz15
    ds_read2st64_b32 v[56:57], v4 offset0:64 offset1:68
    ds_read2st64_b32 v[58:59], v4 offset0:72 offset1:76
    s_waitcnt lgkmcnt(0)
    v_max3_u32 v60, v56, v57, v58
    v_max_u32 v60, v60, v59
    v_cmp_eq_u32 vcc, -1, v60
    s_cbranch_vccnz fz_lz15
fz_xz15:
    s_mov_b32 m0, s57
    s_branch fz_bz15
fz_ra0:
    s_mov_b32 s54, 0
fz_la0:
    buffer_load_dwordx4 v[72:75], v9, s[36:39], s40 offen offset:0 sc1
    buffer_load_dwordx4 v[76:79], v9, s[36:39], s41 offen offset:0 sc1
    buffer_load_dwordx4 v[80:83], v9, s[36:39], s40 offen offset:1024 sc1
    buffer_load_dwordx4 v[84:87], v9, s[36:39], s41 offen offset:1024 sc1
    buffer_load_dwordx4 v[88:91], v9, s[36:39], s40 offen offset:2048 sc1
    buffer_load_dwordx4 v[92:95], v9, s[36:39], s41 offen offset:2048 sc1
    buffer_load_dwordx4 v[96:99], v9, s[36:39], s40 offen offset:3072 sc1
    buffer_load_dwordx4 v[100:103], v9, s[36:39], s41 offen offset:3072 sc1
    s_add_u32 s54, s54, 1
    s_cmp_ge_u32 s54, 20000
    s_waitcnt vmcnt(0)
    s_cbranch_scc1 fz_ba0
    v_max3_u32 v10, v72, v76, v80
    v_max3_u32 v10, v10, v84, v88
    v_max3_u32 v10, v10, v92, v96
    v_max_u32 v10, v10, v100
    v_cmp_eq_u32 vcc, -1, v10
    s_cbranch_vccnz fz_la0
    s_branch fz_ba0
fz_ra1:
    s_mov_b32 s54, 0
fz_la1:
    buffer_load_dwordx4 v[128:131], v9, s[36:39], s22 offen offset:0 sc1
    buffer_load_dwordx4 v[132:135], v9, s[36:39], s23 offen offset:0 sc1
    buffer_load_dwordx4 v[136:139], v9, s[36:39], s22 offen offset:1024 sc1
    buffer_load_dwordx4 v[140:143], v9, s[36:39], s23 offen offset:1024 sc1
    buffer_load_dwordx4 v[208:211], v9, s[36:39], s22 offen offset:2048 sc1
    buffer_load_dwordx4 v[212:215], v9, s[36:39], s23 offen offset:2048 sc1
    s_add_u32 s54, s54, 1
    s_cmp_ge_u32 s54, 20000
    s_waitcnt vmcnt(0)
    s_cbranch_scc1 fz_ba1
    v_max3_u32 v10, v128, v132, v136
    v_max3_u32 v10, v10, v140, v208
    v_max_u32 v10, v10, v212
    v_cmp_eq_u32 vcc, -1, v10
    s_cbranch_vccnz fz_la1
    s_branch fz_ba1
fz_ra2:
    s_mov_b32 s54, 0
fz_la2:
    buffer_load_dwordx4 v[144:147], v9, s[36:39], s30 offen offset:0 sc1
    buffer_load_dwordx4 v[148:151], v9, s[36:39], s31 offen offset:0 sc1
    buffer_load_dwordx4 v[152:155], v9, s[36:39], s30 offen offset:1024 sc1
    buffer_load_dwordx4 v[156:159], v9, s[36:39], s31 offen offset:1024 sc1
    buffer_load_dwordx4 v[160:163], v9, s[36:39], s30 offen offset:2048 sc1
    buffer_load_dwordx4 v[164:167], v9, s[36:39], s31 offen offset:2048 sc1
    buffer_load_dwordx4 v[168:171], v9, s[36:39], s30 offen offset:3072 sc1
    buffer_load_dwordx4 v[172:175], v9, s[36:39], s31 offen offset:3072 sc1
    s_add_u32 s54, s54, 1
    s_cmp_ge_u32 s54, 20000
    s_waitcnt vmcnt(0)
    s_cbranch_scc1 fz_ba2
    v_max3_u32 v10, v144, v148, v152
    v_max3_u32 v10, v10, v156, v160
    v_max3_u32 v10, v10, v164, v168
    v_max_u32 v10, v10, v172
    v_cmp_eq_u32 vcc, -1, v10
    s_cbranch_vccnz fz_la2
    s_branch fz_ba2
fz_ra3:
    s_mov_b32 s54, 0
fz_la3:
    buffer_load_dwordx4 v[216:219], v9, s[36:39], s32 offen offset:0 sc1
    buffer_load_dwordx4 v[220:223], v9, s[36:39], s33 offen offset:0 sc1
    buffer_load_dwordx4 v[224:227], v9, s[36:39], s32 offen offset:1024 sc1
    buffer_load_dwordx4 v[228:231], v9, s[36:39], s33 offen offset:1024 sc1
    buffer_load_dwordx4 v[232:235], v9, s[36:39], s32 offen offset:2048 sc1
    buffer_load_dwordx4 v[236:239], v9, s[36:39], s33 offen offset:2048 sc1
    s_add_u32 s54, s54, 1
    s_cmp_ge_u32 s54, 20000
    s_waitcnt vmcnt(0)
    s_cbranch_scc1 fz_ba3
    v_max3_u32 v10, v216, v220, v224
    v_max3_u32 v10, v10, v228, v232
    v_max_u32 v10, v10, v236
    v_cmp_eq_u32 vcc, -1, v10
    s_cbranch_vccnz fz_la3
    s_branch fz_ba3
fz_helper:
    s_sub_u32 s30, s2, 224
    s_lshr_b32 s30, s30, 3
    s_mul_i32 s30, s30, 16384
    v_lshlrev_b32 v4, 4, v0
    v_add_u32 v4, s30, v4
    s_sub_u32 s30, s28, fz_tab-fz_kernel
    s_subb_u32 s31, s29, 0
    v_min_u32 v5, fz_tab-fz_kernel-16, v4
    global_load_dwordx4 v[232:235], v5, s[30:31]
    v_add_u32 v4, 4096, v4
    v_min_u32 v5, fz_tab-fz_kernel-16, v4
    global_load_dwordx4 v[236:239], v5, s[30:31]
    v_add_u32 v4, 4096, v4
    v_min_u32 v5, fz_tab-fz_kernel-16, v4
    global_load_dwordx4 v[240:243], v5, s[30:31]
    v_add_u32 v4, 4096, v4
    v_min_u32 v5, fz_tab-fz_kernel-16, v4
    global_load_dwordx4 v[244:247], v5, s[30:31]
    s_lshl_b32 s30, s2, 2
    s_add_u32 s30, s30, s4
    s_lshl_b32 s48, s4, 12
    s_lshl_b32 s31, s2, 4
    s_add_u32 s48, s48, s31
    s_mul_i32 s30, s30, 1792
    v_lshlrev_b32 v5, 4, v1
    v_mov_b32 v6, 0x80000000
    v_cmp_gt_u32 vcc, 56, v1
    s_nop 1
    v_cndmask_b32 v5, v6, v5, vcc
    v_mov_b32 v7, 32768
    s_waitcnt lgkmcnt(0)
    s_mov_b32 s40, s8
    s_mov_b32 s41, s9
    s_mov_b32 s42, 0x1c0000
    s_mov_b32 s43, 0x20000
    buffer_load_dwordx4 v[8:11], v5, s[40:43], s30 offen offset:0
    buffer_load_dwordx4 v[12:15], v5, s[40:43], s30 offen offset:896
    global_load_dword v20, v7, s[26:27] sc0 sc1
    s_mov_b32 s44, s26
    s_mov_b32 s45, s27
    s_mov_b32 s46, 0x4000
    s_mov_b32 s47, 0x20000
    s_sub_u32 s3, s2, 224
    s_load_dwordx2 s[14:15], s[0:1], 104
    v_lshrrev_b32 v3, 3, v1
    v_and_b32 v4, 7, v1
    v_lshlrev_b32 v29, 4, v1
    v_mul_u32_u24 v24, 192, v3
    v_lshl_add_u32 v24, v4, 4, v24
    v_lshrrev_b32 v25, 4, v1
    v_and_b32 v26, 15, v1
    v_lshrrev_b32 v27, 2, v26
    v_and_b32 v26, 3, v26
    s_add_u32 s36, s26, 0x1800000
    s_addc_u32 s37, s27, 0
    s_mov_b32 s38, 0x800000
    s_mov_b32 s39, 0x20000
    s_and_b32 s30, s3, 7
    s_lshr_b32 s31, s30, 1
    s_lshl_b32 s31, s31, 2
    s_lshr_b32 s33, s3, 3
    s_add_u32 s31, s31, s33
    s_and_b32 s30, s30, 1
    s_mov_b32 s86, s31
    s_lshl_b32 s84, s31, 1
    s_add_u32 s84, s84, s30
    s_lshl_b32 s84, s84, 3
    s_lshl_b32 s31, s31, 2
    s_add_u32 s31, s31, s4
    s_lshl_b32 s31, s31, 17
    s_lshl_b32 s33, s30, 11
    s_add_u32 s87, s31, s33
    s_lshl_b32 s33, s30, 15
    s_add_u32 s85, s31, s33
    v_lshrrev_b32 v18, 4, v1
    v_and_b32 v19, 15, v1
    v_lshlrev_b32 v19, 4, v19
    v_lshl_add_u32 v30, v18, 12, v19
    s_mov_b32 s60, s56
    s_mov_b32 s61, s57
    s_mov_b32 s62, 0x800000
    s_mov_b32 s63, 0x20000
    s_lshl_b32 s30, s4, 12
    s_add_u32 m0, s30, 65536
    v_mov_b32 v40, -1
    v_mov_b32 v41, -1
    v_mov_b32 v42, -1
    v_mov_b32 v43, -1
    s_lshl_b32 s30, s3, 2
    s_add_u32 s30, s30, s4
    s_mul_i32 s30, s30, 14336
    s_add_u32 s16, s26, 0x100000
    s_addc_u32 s17, s27, 0
    s_mov_b32 s18, 0x1c0000
    s_mov_b32 s19, 0x20000
    s_add_u32 s31, s30, 0
    buffer_store_dwordx4 v[40:43], v29, s[16:19], s31 offen offset:0 sc1
    buffer_store_dwordx4 v[40:43], v29, s[16:19], s31 offen offset:1024 sc1
    buffer_store_dwordx4 v[40:43], v29, s[16:19], s31 offen offset:2048 sc1
    buffer_store_dwordx4 v[40:43], v29, s[16:19], s31 offen offset:3072 sc1
    s_add_u32 s31, s30, 4096
    buffer_store_dwordx4 v[40:43], v29, s[16:19], s31 offen offset:0 sc1
    buffer_store_dwordx4 v[40:43], v29, s[16:19], s31 offen offset:1024 sc1
    buffer_store_dwordx4 v[40:43], v29, s[16:19], s31 offen offset:2048 sc1
    buffer_store_dwordx4 v[40:43], v29, s[16:19], s31 offen offset:3072 sc1
    s_add_u32 s31, s30, 8192
    buffer_store_dwordx4 v[40:43], v29, s[16:19], s31 offen offset:0 sc1
    buffer_store_dwordx4 v[40:43], v29, s[16:19], s31 offen offset:1024 sc1
    buffer_store_dwordx4 v[40:43], v29, s[16:19], s31 offen offset:2048 sc1
    buffer_store_dwordx4 v[40:43], v29, s[16:19], s31 offen offset:3072 sc1
    s_add_u32 s31, s30, 12288
    buffer_store_dwordx4 v[40:43], v29, s[16:19], s31 offen offset:0 sc1
    buffer_store_dwordx4 v[40:43], v29, s[16:19], s31 offen offset:1024 sc1
    s_mov_b32 s49, 0x3f803f80
    s_waitcnt vmcnt(16)
    v_dot2_f32_bf16 v16, v8, s49, 0
    v_dot2_f32_bf16 v16, v9, s49, v16
    v_dot2_f32_bf16 v16, v10, s49, v16
    v_dot2_f32_bf16 v16, v11, s49, v16
    v_dot2_f32_bf16 v18, v8, v8, 0
    v_dot2_f32_bf16 v18, v9, v9, v18
    v_dot2_f32_bf16 v18, v10, v10, v18
    v_dot2_f32_bf16 v18, v11, v11, v18
    s_waitcnt vmcnt(15)
    v_dot2_f32_bf16 v17, v12, s49, 0
    v_dot2_f32_bf16 v17, v13, s49, v17
    v_dot2_f32_bf16 v17, v14, s49, v17
    v_dot2_f32_bf16 v17, v15, s49, v17
    v_dot2_f32_bf16 v19, v12, v12, 0
    v_dot2_f32_bf16 v19, v13, v13, v19
    v_dot2_f32_bf16 v19, v14, v14, v19
    v_dot2_f32_bf16 v19, v15, v15, v19
    v_permlane32_swap_b32 v16, v17
    s_nop 1
    v_permlane32_swap_b32 v18, v19
    v_add_f32 v16, v16, v17
    v_add_f32 v18, v18, v19
    s_nop 1
    v_permlane16_swap_b32 v16, v18
    v_add_f32 v16, v16, v18
    s_nop 1
    v_add_f32_dpp v16, v16, v16 row_ror:8 row_mask:0xf bank_mask:0xf
    s_nop 1
    v_add_f32_dpp v16, v16, v16 row_ror:4 row_mask:0xf bank_mask:0xf
    s_nop 1
    v_add_f32_dpp v16, v16, v16 row_ror:2 row_mask:0xf bank_mask:0xf
    s_nop 1
    v_add_f32_dpp v16, v16, v16 row_ror:1 row_mask:0xf bank_mask:0xf
    v_mov_b32 v18, v16
    s_nop 1
    v_permlane16_swap_b32 v16, v18
    v_mul_f32 v16, 0x3b124925, v16
    v_mul_f32 v18, 0x3b124925, v18
    v_fma_f32 v18, -v16, v16, v18
    v_max_f32 v18, 0, v18
    v_cvt_pk_bf16_f32 v17, v16, v18
    v_lshlrev_b32 v16, 16, v17
    v_and_b32 v18, 0xffff0000, v17
    v_add_f32 v18, 0x3727c5ac, v18
    v_cvt_pk_bf16_f32 v18, v18, v18
    v_lshlrev_b32 v18, 16, v18
    v_sqrt_f32 v18, v18
    s_nop 0
    v_cvt_pk_bf16_f32 v18, v18, v18
    v_lshlrev_b32 v18, 16, v18
    v_cvt_pk_bf16_f32 v16, v16, v18
    s_waitcnt vmcnt(14)
    v_add_u32 v17, 1, v20
    v_lshrrev_b32 v18, 2, v1
    v_readfirstlane_b32 s50, v17
    s_waitcnt vmcnt(0)
    s_mov_b32 exec_lo, 1
    s_mov_b32 exec_hi, 1
    buffer_store_dwordx2 v[16:17], v18, s[44:47], s48 offen sc0 sc1
    s_mov_b64 exec, -1
    s_mov_b32 s16, s54
    s_mov_b32 s17, s55
    s_mov_b32 s18, 0x188000
    s_mov_b32 s19, 0x20000
    s_lshl_b32 s30, s4, 12
    s_add_u32 m0, s30, 65536
    s_lshl_b32 s30, s3, 2
    s_add_u32 s30, s30, s4
    s_mul_i32 s33, s30, 12544
    s_add_u32 s34, s33, 0
    buffer_load_dwordx4 v29, s[16:19], s34 offen offset:0 lds
    buffer_load_dwordx4 v29, s[16:19], s34 offen offset:1024 lds
    buffer_load_dwordx4 v29, s[16:19], s34 offen offset:2048 lds
    buffer_load_dwordx4 v29, s[16:19], s34 offen offset:3072 lds
    s_add_u32 s34, s33, 4096
    buffer_load_dwordx4 v29, s[16:19], s34 offen offset:0 lds
    buffer_load_dwordx4 v29, s[16:19], s34 offen offset:1024 lds
    buffer_load_dwordx4 v29, s[16:19], s34 offen offset:2048 lds
    buffer_load_dwordx4 v29, s[16:19], s34 offen offset:3072 lds
    s_add_u32 s34, s33, 8192
    buffer_load_dwordx4 v29, s[16:19], s34 offen offset:0 lds
    buffer_load_dwordx4 v29, s[16:19], s34 offen offset:1024 lds
    buffer_load_dwordx4 v29, s[16:19], s34 offen offset:2048 lds
    buffer_load_dwordx4 v29, s[16:19], s34 offen offset:3072 lds
    s_add_u32 s34, s33, 12288
    buffer_load_dwordx4 v29, s[16:19], s34 offen offset:0 lds
    s_lshl_b32 s30, s4, 12
    s_add_u32 m0, s30, 65536
    s_add_u32 s31, s86, 0
    s_and_b32 s31, s31, 7
    s_lshl_b32 s31, s31, 8
    s_add_u32 s31, s31, s87
    buffer_load_dwordx4 v30, s[60:63], s31 offen lds
    s_add_u32 s31, s31, 0x4000
    buffer_load_dwordx4 v30, s[60:63], s31 offen lds
    s_add_u32 s31, s31, 0x4000
    buffer_load_dwordx4 v30, s[60:63], s31 offen lds
    s_add_u32 s31, s31, 0x4000
    buffer_load_dwordx4 v30, s[60:63], s31 offen lds
    s_add_u32 s31, s31, 0x4000
    buffer_load_dwordx4 v30, s[60:63], s31 offen lds
    s_add_u32 s31, s31, 0x4000
    buffer_load_dwordx4 v30, s[60:63], s31 offen lds
    s_add_u32 s31, s31, 0x4000
    buffer_load_dwordx4 v30, s[60:63], s31 offen lds
    s_add_u32 s31, s31, 0x4000
    buffer_load_dwordx4 v30, s[60:63], s31 offen lds
    s_add_u32 s31, s86, 1
    s_and_b32 s31, s31, 7
    s_lshl_b32 s31, s31, 8
    s_add_u32 s31, s31, s87
    buffer_load_dwordx4 v30, s[60:63], s31 offen lds
    s_add_u32 s31, s31, 0x4000
    buffer_load_dwordx4 v30, s[60:63], s31 offen lds
    s_add_u32 s31, s31, 0x4000
    buffer_load_dwordx4 v30, s[60:63], s31 offen lds
    s_add_u32 s31, s31, 0x4000
    buffer_load_dwordx4 v30, s[60:63], s31 offen lds
    s_add_u32 s31, s31, 0x4000
    buffer_load_dwordx4 v30, s[60:63], s31 offen lds
    s_add_u32 s31, s31, 0x4000
    buffer_load_dwordx4 v30, s[60:63], s31 offen lds
    s_add_u32 s31, s31, 0x4000
    buffer_load_dwordx4 v30, s[60:63], s31 offen lds
    s_add_u32 s31, s31, 0x4000
    buffer_load_dwordx4 v30, s[60:63], s31 offen lds
    s_add_u32 s31, s86, 2
    s_and_b32 s31, s31, 7
    s_lshl_b32 s31, s31, 8
    s_add_u32 s31, s31, s87
    buffer_load_dwordx4 v30, s[60:63], s31 offen lds
    s_add_u32 s31, s31, 0x4000
    buffer_load_dwordx4 v30, s[60:63], s31 offen lds
    s_add_u32 s31, s31, 0x4000
    buffer_load_dwordx4 v30, s[60:63], s31 offen lds
    s_add_u32 s31, s31, 0x4000
    buffer_load_dwordx4 v30, s[60:63], s31 offen lds
    s_add_u32 s31, s31, 0x4000
    buffer_load_dwordx4 v30, s[60:63], s31 offen lds
    s_add_u32 s31, s31, 0x4000
    buffer_load_dwordx4 v30, s[60:63], s31 offen lds
    s_add_u32 s31, s31, 0x4000
    buffer_load_dwordx4 v30, s[60:63], s31 offen lds
    s_add_u32 s31, s31, 0x4000
    buffer_load_dwordx4 v30, s[60:63], s31 offen lds
    s_add_u32 s31, s86, 3
    s_and_b32 s31, s31, 7
    s_lshl_b32 s31, s31, 8
    s_add_u32 s31, s31, s87
    buffer_load_dwordx4 v30, s[60:63], s31 offen lds
    s_add_u32 s31, s31, 0x4000
    buffer_load_dwordx4 v30, s[60:63], s31 offen lds
    s_add_u32 s31, s31, 0x4000
    buffer_load_dwordx4 v30, s[60:63], s31 offen lds
    s_add_u32 s31, s31, 0x4000
    buffer_load_dwordx4 v30, s[60:63], s31 offen lds
    s_add_u32 s31, s31, 0x4000
    buffer_load_dwordx4 v30, s[60:63], s31 offen lds
    s_add_u32 s31, s31, 0x4000
    buffer_load_dwordx4 v30, s[60:63], s31 offen lds
    s_add_u32 s31, s31, 0x4000
    buffer_load_dwordx4 v30, s[60:63], s31 offen lds
    s_add_u32 s31, s31, 0x4000
    buffer_load_dwordx4 v30, s[60:63], s31 offen lds
    s_lshl_b32 s30, s4, 12
    s_add_u32 m0, s30, 65536
    s_lshl_b32 s30, s4, 12
    s_add_u32 m0, s30, 65536
    s_lshl_b32 s30, s4, 12
    s_add_u32 m0, s30, 65536
    s_waitcnt lgkmcnt(0)
    s_cmp_ge_u32 s3, 28
    s_cbranch_scc1 fz_hw0
    v_mul_u32_u24 v5, 896, v3
    v_lshl_add_u32 v5, v4, 4, v5
    s_mov_b32 s16, s14
    s_mov_b32 s17, s15
    s_mov_b32 s18, 0xc4000
    s_mov_b32 s19, 0x20000
    s_add_u32 s20, s26, 0x500000
    s_addc_u32 s21, s27, 0
    s_mov_b32 s22, 0xc4000
    s_mov_b32 s23, 0x20000
    v_lshrrev_b32 v28, 1, v25
    v_and_b32 v25, 1, v25
    v_lshl_add_u32 v27, v28, 3, v27
    v_mul_u32_u24 v27, 192, v27
    v_lshl_add_u32 v27, v26, 3, v27
    v_lshl_add_u32 v27, v25, 5, v27
    s_lshl_b32 s30, s4, 13
    v_add_u32 v24, s30, v24
    v_add_u32 v27, s30, v27
    s_add_u32 s30, s4, 0
    s_min_u32 s30, s30, 6
    s_mul_i32 s33, s3, 28672
    s_lshl_b32 s31, s30, 7
    s_add_u32 s33, s33, s31
    s_and_b32 s34, s3, 1
    s_mul_i32 s34, s34, 27
    s_add_u32 s34, s34, s3
    s_mul_i32 s31, s30, 112
    s_add_u32 s34, s34, s31
    s_lshl_b32 s6, s34, 10
    s_add_u32 s35, s33, 0
    buffer_load_dwordx4 v[32:35], v5, s[16:19], s35 offen
    s_add_u32 s35, s33, 7168
    buffer_load_dwordx4 v[36:39], v5, s[16:19], s35 offen
    s_add_u32 s35, s33, 14336
    buffer_load_dwordx4 v[40:43], v5, s[16:19], s35 offen
    s_add_u32 s35, s33, 21504
    buffer_load_dwordx4 v[44:47], v5, s[16:19], s35 offen
    s_add_u32 s30, s4, 4
    s_min_u32 s30, s30, 6
    s_mul_i32 s33, s3, 28672
    s_lshl_b32 s31, s30, 7
    s_add_u32 s33, s33, s31
    s_and_b32 s34, s3, 1
    s_mul_i32 s34, s34, 27
    s_add_u32 s34, s34, s3
    s_mul_i32 s31, s30, 112
    s_add_u32 s34, s34, s31
    s_lshl_b32 s7, s34, 10
    s_add_u32 s35, s33, 0
    buffer_load_dwordx4 v[48:51], v5, s[16:19], s35 offen
    s_add_u32 s35, s33, 7168
    buffer_load_dwordx4 v[52:55], v5, s[16:19], s35 offen
    s_add_u32 s35, s33, 14336
    buffer_load_dwordx4 v[56:59], v5, s[16:19], s35 offen
    s_add_u32 s35, s33, 21504
    buffer_load_dwordx4 v[60:63], v5, s[16:19], s35 offen
    s_waitcnt vmcnt(7)
    ds_write_b128 v24, v[32:35] offset:0
    s_waitcnt vmcnt(6)
    ds_write_b128 v24, v[36:39] offset:1536
    s_waitcnt vmcnt(5)
    ds_write_b128 v24, v[40:43] offset:3072
    s_waitcnt vmcnt(4)
    ds_write_b128 v24, v[44:47] offset:4608
    ds_read_b64_tr_b16 v[144:145], v27 offset:0
    ds_read_b64_tr_b16 v[146:147], v27 offset:768
    ds_read_b64_tr_b16 v[148:149], v27 offset:3072
    ds_read_b64_tr_b16 v[150:151], v27 offset:3840
    ds_read_b64_tr_b16 v[152:153], v27 offset:64
    ds_read_b64_tr_b16 v[154:155], v27 offset:832
    ds_read_b64_tr_b16 v[156:157], v27 offset:3136
    ds_read_b64_tr_b16 v[158:159], v27 offset:3904
    s_add_u32 s35, s6, 0
    s_waitcnt lgkmcnt(6)
    buffer_store_dwordx4 v[144:147], v29, s[20:23], s35 offen sc1
    s_add_u32 s35, s6, 1024
    s_waitcnt lgkmcnt(4)
    buffer_store_dwordx4 v[148:151], v29, s[20:23], s35 offen sc1
    s_add_u32 s35, s6, 57344
    s_waitcnt lgkmcnt(2)
    buffer_store_dwordx4 v[152:155], v29, s[20:23], s35 offen sc1
    s_add_u32 s35, s6, 58368
    s_waitcnt lgkmcnt(0)
    buffer_store_dwordx4 v[156:159], v29, s[20:23], s35 offen sc1
    s_waitcnt vmcnt(7)
    ds_write_b128 v24, v[48:51] offset:0
    s_waitcnt vmcnt(6)
    ds_write_b128 v24, v[52:55] offset:1536
    s_waitcnt vmcnt(5)
    ds_write_b128 v24, v[56:59] offset:3072
    s_waitcnt vmcnt(4)
    ds_write_b128 v24, v[60:63] offset:4608
    ds_read_b64_tr_b16 v[160:161], v27 offset:0
    ds_read_b64_tr_b16 v[162:163], v27 offset:768
    ds_read_b64_tr_b16 v[164:165], v27 offset:3072
    ds_read_b64_tr_b16 v[166:167], v27 offset:3840
    ds_read_b64_tr_b16 v[168:169], v27 offset:64
    ds_read_b64_tr_b16 v[170:171], v27 offset:832
    ds_read_b64_tr_b16 v[172:173], v27 offset:3136
    ds_read_b64_tr_b16 v[174:175], v27 offset:3904
    s_add_u32 s35, s7, 0
    s_waitcnt lgkmcnt(6)
    buffer_store_dwordx4 v[160:163], v29, s[20:23], s35 offen sc1
    s_add_u32 s35, s7, 1024
    s_waitcnt lgkmcnt(4)
    buffer_store_dwordx4 v[164:167], v29, s[20:23], s35 offen sc1
    s_add_u32 s35, s7, 57344
    s_waitcnt lgkmcnt(2)
    buffer_store_dwordx4 v[168:171], v29, s[20:23], s35 offen sc1
    s_add_u32 s35, s7, 58368
    s_waitcnt lgkmcnt(0)
    buffer_store_dwordx4 v[172:175], v29, s[20:23], s35 offen sc1
fz_hw0:
    v_mov_b32 v40, -1
    v_mov_b32 v41, -1
    v_mov_b32 v42, -1
    v_mov_b32 v43, -1
    s_lshl_b32 s30, s3, 2
    s_add_u32 s30, s30, s4
    s_mul_i32 s30, s30, 28672
    s_add_u32 s16, s26, 0x2000000
    s_addc_u32 s17, s27, 0
    s_mov_b32 s18, 0x380000
    s_mov_b32 s19, 0x20000
    s_add_u32 s31, s30, 0
    buffer_store_dwordx4 v[40:43], v29, s[16:19], s31 offen offset:0 sc1
    buffer_store_dwordx4 v[40:43], v29, s[16:19], s31 offen offset:1024 sc1
    buffer_store_dwordx4 v[40:43], v29, s[16:19], s31 offen offset:2048 sc1
    buffer_store_dwordx4 v[40:43], v29, s[16:19], s31 offen offset:3072 sc1
    s_add_u32 s31, s30, 4096
    buffer_store_dwordx4 v[40:43], v29, s[16:19], s31 offen offset:0 sc1
    buffer_store_dwordx4 v[40:43], v29, s[16:19], s31 offen offset:1024 sc1
    buffer_store_dwordx4 v[40:43], v29, s[16:19], s31 offen offset:2048 sc1
    buffer_store_dwordx4 v[40:43], v29, s[16:19], s31 offen offset:3072 sc1
    s_add_u32 s31, s30, 8192
    buffer_store_dwordx4 v[40:43], v29, s[16:19], s31 offen offset:0 sc1
    buffer_store_dwordx4 v[40:43], v29, s[16:19], s31 offen offset:1024 sc1
    buffer_store_dwordx4 v[40:43], v29, s[16:19], s31 offen offset:2048 sc1
    buffer_store_dwordx4 v[40:43], v29, s[16:19], s31 offen offset:3072 sc1
    s_add_u32 s31, s30, 12288
    buffer_store_dwordx4 v[40:43], v29, s[16:19], s31 offen offset:0 sc1
    buffer_store_dwordx4 v[40:43], v29, s[16:19], s31 offen offset:1024 sc1
    buffer_store_dwordx4 v[40:43], v29, s[16:19], s31 offen offset:2048 sc1
    buffer_store_dwordx4 v[40:43], v29, s[16:19], s31 offen offset:3072 sc1
    s_add_u32 s31, s30, 16384
    buffer_store_dwordx4 v[40:43], v29, s[16:19], s31 offen offset:0 sc1
    buffer_store_dwordx4 v[40:43], v29, s[16:19], s31 offen offset:1024 sc1
    buffer_store_dwordx4 v[40:43], v29, s[16:19], s31 offen offset:2048 sc1
    buffer_store_dwordx4 v[40:43], v29, s[16:19], s31 offen offset:3072 sc1
    s_add_u32 s31, s30, 20480
    buffer_store_dwordx4 v[40:43], v29, s[16:19], s31 offen offset:0 sc1
    buffer_store_dwordx4 v[40:43], v29, s[16:19], s31 offen offset:1024 sc1
    buffer_store_dwordx4 v[40:43], v29, s[16:19], s31 offen offset:2048 sc1
    buffer_store_dwordx4 v[40:43], v29, s[16:19], s31 offen offset:3072 sc1
    s_add_u32 s31, s30, 24576
    buffer_store_dwordx4 v[40:43], v29, s[16:19], s31 offen offset:0 sc1
    buffer_store_dwordx4 v[40:43], v29, s[16:19], s31 offen offset:1024 sc1
    buffer_store_dwordx4 v[40:43], v29, s[16:19], s31 offen offset:2048 sc1
    buffer_store_dwordx4 v[40:43], v29, s[16:19], s31 offen offset:3072 sc1
    s_add_u32 s16, s26, 0xd80000
    s_addc_u32 s17, s27, 0
    s_mov_b32 s18, 0x380000
    s_mov_b32 s19, 0x20000
    s_add_u32 s31, s30, 0
    buffer_store_dwordx4 v[40:43], v29, s[16:19], s31 offen offset:0 sc1
    buffer_store_dwordx4 v[40:43], v29, s[16:19], s31 offen offset:1024 sc1
    buffer_store_dwordx4 v[40:43], v29, s[16:19], s31 offen offset:2048 sc1
    buffer_store_dwordx4 v[40:43], v29, s[16:19], s31 offen offset:3072 sc1
    s_add_u32 s31, s30, 4096
    buffer_store_dwordx4 v[40:43], v29, s[16:19], s31 offen offset:0 sc1
    buffer_store_dwordx4 v[40:43], v29, s[16:19], s31 offen offset:1024 sc1
    buffer_store_dwordx4 v[40:43], v29, s[16:19], s31 offen offset:2048 sc1
    buffer_store_dwordx4 v[40:43], v29, s[16:19], s31 offen offset:3072 sc1
    s_add_u32 s31, s30, 8192
    buffer_store_dwordx4 v[40:43], v29, s[16:19], s31 offen offset:0 sc1
    buffer_store_dwordx4 v[40:43], v29, s[16:19], s31 offen offset:1024 sc1
    buffer_store_dwordx4 v[40:43], v29, s[16:19], s31 offen offset:2048 sc1
    buffer_store_dwordx4 v[40:43], v29, s[16:19], s31 offen offset:3072 sc1
    s_add_u32 s31, s30, 12288
    buffer_store_dwordx4 v[40:43], v29, s[16:19], s31 offen offset:0 sc1
    buffer_store_dwordx4 v[40:43], v29, s[16:19], s31 offen offset:1024 sc1
    buffer_store_dwordx4 v[40:43], v29, s[16:19], s31 offen offset:2048 sc1
    buffer_store_dwordx4 v[40:43], v29, s[16:19], s31 offen offset:3072 sc1
    s_add_u32 s31, s30, 16384
    buffer_store_dwordx4 v[40:43], v29, s[16:19], s31 offen offset:0 sc1
    buffer_store_dwordx4 v[40:43], v29, s[16:19], s31 offen offset:1024 sc1
    buffer_store_dwordx4 v[40:43], v29, s[16:19], s31 offen offset:2048 sc1
    buffer_store_dwordx4 v[40:43], v29, s[16:19], s31 offen offset:3072 sc1
    s_add_u32 s31, s30, 20480
    buffer_store_dwordx4 v[40:43], v29, s[16:19], s31 offen offset:0 sc1
    buffer_store_dwordx4 v[40:43], v29, s[16:19], s31 offen offset:1024 sc1
    buffer_store_dwordx4 v[40:43], v29, s[16:19], s31 offen offset:2048 sc1
    buffer_store_dwordx4 v[40:43], v29, s[16:19], s31 offen offset:3072 sc1
    s_add_u32 s31, s30, 24576
    buffer_store_dwordx4 v[40:43], v29, s[16:19], s31 offen offset:0 sc1
    buffer_store_dwordx4 v[40:43], v29, s[16:19], s31 offen offset:1024 sc1
    buffer_store_dwordx4 v[40:43], v29, s[16:19], s31 offen offset:2048 sc1
    buffer_store_dwordx4 v[40:43], v29, s[16:19], s31 offen offset:3072 sc1
    s_waitcnt vmcnt(0)
    s_barrier
    s_cmp_lg_u32 s4, 0
    s_cbranch_scc1 fz_hw1
    s_lshl_b32 s30, s3, 7
    s_add_u32 s30, s30, 540672
    v_mov_b32 v21, s30
    v_mov_b32 v22, s50
    s_mov_b64 exec, 1
    global_store_dword v21, v22, s[26:27] sc0 sc1
    s_mov_b64 exec, -1
fz_hw1:
    s_lshl_b32 s30, s4, 12
    s_add_u32 m0, s30, 65536
    s_add_u32 s31, s86, 4
    s_and_b32 s31, s31, 7
    s_lshl_b32 s31, s31, 8
    s_add_u32 s31, s31, s87
    buffer_load_dwordx4 v30, s[60:63], s31 offen lds
    s_add_u32 s31, s31, 0x4000
    buffer_load_dwordx4 v30, s[60:63], s31 offen lds
    s_add_u32 s31, s31, 0x4000
    buffer_load_dwordx4 v30, s[60:63], s31 offen lds
    s_add_u32 s31, s31, 0x4000
    buffer_load_dwordx4 v30, s[60:63], s31 offen lds
    s_add_u32 s31, s31, 0x4000
    buffer_load_dwordx4 v30, s[60:63], s31 offen lds
    s_add_u32 s31, s31, 0x4000
    buffer_load_dwordx4 v30, s[60:63], s31 offen lds
    s_add_u32 s31, s31, 0x4000
    buffer_load_dwordx4 v30, s[60:63], s31 offen lds
    s_add_u32 s31, s31, 0x4000
    buffer_load_dwordx4 v30, s[60:63], s31 offen lds
    s_add_u32 s31, s86, 5
    s_and_b32 s31, s31, 7
    s_lshl_b32 s31, s31, 8
    s_add_u32 s31, s31, s87
    buffer_load_dwordx4 v30, s[60:63], s31 offen lds
    s_add_u32 s31, s31, 0x4000
    buffer_load_dwordx4 v30, s[60:63], s31 offen lds
    s_add_u32 s31, s31, 0x4000
    buffer_load_dwordx4 v30, s[60:63], s31 offen lds
    s_add_u32 s31, s31, 0x4000
    buffer_load_dwordx4 v30, s[60:63], s31 offen lds
    s_add_u32 s31, s31, 0x4000
    buffer_load_dwordx4 v30, s[60:63], s31 offen lds
    s_add_u32 s31, s31, 0x4000
    buffer_load_dwordx4 v30, s[60:63], s31 offen lds
    s_add_u32 s31, s31, 0x4000
    buffer_load_dwordx4 v30, s[60:63], s31 offen lds
    s_add_u32 s31, s31, 0x4000
    buffer_load_dwordx4 v30, s[60:63], s31 offen lds
    s_add_u32 s31, s86, 6
    s_and_b32 s31, s31, 7
    s_lshl_b32 s31, s31, 8
    s_add_u32 s31, s31, s87
    buffer_load_dwordx4 v30, s[60:63], s31 offen lds
    s_add_u32 s31, s31, 0x4000
    buffer_load_dwordx4 v30, s[60:63], s31 offen lds
    s_add_u32 s31, s31, 0x4000
    buffer_load_dwordx4 v30, s[60:63], s31 offen lds
    s_add_u32 s31, s31, 0x4000
    buffer_load_dwordx4 v30, s[60:63], s31 offen lds
    s_add_u32 s31, s31, 0x4000
    buffer_load_dwordx4 v30, s[60:63], s31 offen lds
    s_add_u32 s31, s31, 0x4000
    buffer_load_dwordx4 v30, s[60:63], s31 offen lds
    s_add_u32 s31, s31, 0x4000
    buffer_load_dwordx4 v30, s[60:63], s31 offen lds
    s_add_u32 s31, s31, 0x4000
    buffer_load_dwordx4 v30, s[60:63], s31 offen lds
    s_add_u32 s31, s86, 7
    s_and_b32 s31, s31, 7
    s_lshl_b32 s34, s31, 12
    s_add_u32 s12, s85, s34
    s_add_u32 s13, s12, 0x10000
    s_lshl_b32 s30, s31, 8
    s_add_u32 s30, s30, s87
    v_lshrrev_b32 v21, 4, v1
    v_and_b32 v22, 15, v1
    v_xor_b32 v22, v22, v21
    v_lshlrev_b32 v22, 4, v22
    v_lshl_add_u32 v22, v21, 12, v22
    s_lshl_b32 s31, s4, 13
    s_add_u32 s31, s31, 131072
    s_add_u32 m0, s31, 0
    v_xor_b32 v21, 0, v22
    buffer_load_dwordx4 v21, s[60:63], s30 offen lds
    s_add_u32 s30, s30, 0x4000
    s_add_u32 m0, s31, 1024
    v_xor_b32 v21, 64, v22
    buffer_load_dwordx4 v21, s[60:63], s30 offen lds
    s_add_u32 s30, s30, 0x4000
    s_add_u32 m0, s31, 2048
    v_xor_b32 v21, 128, v22
    buffer_load_dwordx4 v21, s[60:63], s30 offen lds
    s_add_u32 s30, s30, 0x4000
    s_add_u32 m0, s31, 3072
    v_xor_b32 v21, 192, v22
    buffer_load_dwordx4 v21, s[60:63], s30 offen lds
    s_add_u32 s30, s30, 0x4000
    s_add_u32 m0, s31, 4096
    v_xor_b32 v21, 0, v22
    buffer_load_dwordx4 v21, s[60:63], s30 offen lds
    s_add_u32 s30, s30, 0x4000
    s_add_u32 m0, s31, 5120
    v_xor_b32 v21, 64, v22
    buffer_load_dwordx4 v21, s[60:63], s30 offen lds
    s_add_u32 s30, s30, 0x4000
    s_add_u32 m0, s31, 6144
    v_xor_b32 v21, 128, v22
    buffer_load_dwordx4 v21, s[60:63], s30 offen lds
    s_add_u32 s30, s30, 0x4000
    s_add_u32 m0, s31, 7168
    v_xor_b32 v21, 192, v22
    buffer_load_dwordx4 v21, s[60:63], s30 offen lds
    s_waitcnt vmcnt(0)
    s_endpgm
fz_end:
    s_endpgm
.p2align 6
fz_tab:
    .short 80, 80, 80, 80, 4540, 4540, 4540, 4540, 4540, 4540, 4540, 4396, 4396, 4396, 4396, 4396
    .short 4396, 4396, 4396, 4396, 4252, 4252, 4252, 4252, 4252, 4252, 4252, 4108, 4108, 4108, 4108, 4108
    .short 4108, 4108, 4108, 4108, 3964, 3964, 3964, 3964, 3964, 3964, 3964, 3820, 3820, 3820, 3820, 3820
    .short 3820, 3820, 3820, 3820, 3676, 3676, 3676, 3676, 3676, 3676, 3676, 3532, 3532, 3532, 3532, 3532
    .short 3532, 3532, 3532, 3532, 3388, 3388, 3388, 3388, 3388, 3388, 3388, 3244, 3244, 3244, 3244, 3244
    .short 3244, 3244, 3244, 3244, 3100, 3100, 3100, 3100, 3100, 3100, 3100, 2956, 2956, 2956, 2956, 2956
    .short 2956, 2956, 2956, 2956, 2812, 2812, 2812, 2812, 2812, 2812, 2812, 2668, 2668, 2668, 2668, 2668
    .short 2668, 2668, 2668, 2668, 2524, 2524, 2524, 2524, 2524, 2524, 2524, 2380, 2380, 2380, 2380, 2380
    .short 2380, 2380, 2380, 2380, 2236, 2236, 2236, 2236, 2236, 2236, 2236, 2092, 2092, 2092, 2092, 2092
    .short 2092, 2092, 2092, 2092, 1948, 1948, 1948, 1948, 1948, 1948, 1948, 1804, 1804, 1804, 1804, 1804
    .short 1804, 1804, 1804, 1804, 1660, 1660, 1660, 1660, 1660, 1660, 1660, 1516, 1516, 1516, 1516, 1516
    .short 1516, 1516, 1516, 1516, 1372, 1372, 1372, 1372, 1372, 1372, 1372, 1228, 1228, 1228, 1228, 1228
    .short 1228, 1228, 1228, 1228, 1084, 1084, 1084, 1084, 1084, 1084, 1084, 940, 940, 940, 940, 940
    .short 940, 940, 940, 940, 796, 796, 796, 796, 796, 796, 796, 652, 652, 652, 652, 652
    .short 652, 652, 652, 652, 508, 508, 508, 508, 508, 508, 508, 364, 364, 364, 364, 364
    .short 364, 364, 364, 364, 220, 220, 220, 220, 220, 220, 220, 76, 76, 76, 76, 76
    .short 76, 76, 76, 76, 4536, 4536, 4536, 4536, 4536, 4536, 4536, 4392, 4392, 4392, 4392, 4392
    .short 4392, 4392, 4392, 4392, 4248, 4248, 4248, 4248, 4248, 4248, 4248, 4104, 4104, 4104, 4104, 4104
    .short 4104, 4104, 4104, 4104, 3960, 3960, 3960, 3960, 3960, 3960, 3960, 3816, 3816, 3816, 3816, 3816
    .short 3816, 3816, 3816, 3816, 3672, 3672, 3672, 3672, 3672, 3672, 3672, 3528, 3528, 3528, 3528, 3528
    .short 3528, 3528, 3528, 3528, 3384, 3384, 3384, 3384, 3384, 3384, 3384, 3240, 3240, 3240, 3240, 3240
    .short 3240, 3240, 3240, 3240, 3096, 3096, 3096, 3096, 3096, 3096, 3096, 2952, 2952, 2952, 2952, 2952
    .short 2952, 2952, 2952, 2952, 2808, 2808, 2808, 2808, 2808, 2808, 2808, 2664, 2664, 2664, 2664, 2664
    .short 2664, 2664, 2664, 2664, 2520, 2520, 2520, 2520, 2520, 2520, 2520, 2376, 2376, 2376, 2376, 2376
    .short 2376, 2376, 2376, 2376, 2232, 2232, 2232, 2232, 2232, 2232, 2232, 2088, 2088, 2088, 2088, 2088
    .short 2088, 2088, 2088, 2088, 1944, 1944, 1944, 1944, 1944, 1944, 1944, 1800, 1800, 1800, 1800, 1800
    .short 1800, 1800, 1800, 1800, 1656, 1656, 1656, 1656, 1656, 1656, 1656, 1512, 1512, 1512, 1512, 1512
    .short 1512, 1512, 1512, 1512, 1368, 1368, 1368, 1368, 1368, 1368, 1368, 1224, 1224, 1224, 1224, 1224
    .short 1224, 1224, 1224, 1224, 1080, 1080, 1080, 1080, 1080, 1080, 1080, 936, 936, 936, 936, 936
    .short 936, 936, 936, 936, 792, 792, 792, 792, 792, 792, 792, 648, 648, 648, 648, 648
    .short 648, 648, 648, 648, 504, 504, 504, 504, 504, 504, 504, 360, 360, 360, 360, 360
    .short 360, 360, 360, 360, 216, 216, 216, 216, 216, 216, 216, 72, 72, 72, 72, 72
    .short 72, 72, 72, 72, 4532, 4532, 4532, 4532, 4532, 4532, 4532, 4388, 4388, 4388, 4388, 4388
    .short 4388, 4388, 4388, 4388, 4244, 4244, 4244, 4244, 4244, 4244, 4244, 4100, 4100, 4100, 4100, 4100
    .short 4100, 4100, 4100, 4100, 3956, 3956, 3956, 3956, 3956, 3956, 3956, 3812, 3812, 3812, 3812, 3812
    .short 3812, 3812, 3812, 3812, 3668, 3668, 3668, 3668, 3668, 3668, 3668, 3524, 3524, 3524, 3524, 3524
    .short 3524, 3524, 3524, 3524, 3380, 3380, 3380, 3380, 3380, 3380, 3380, 3236, 3236, 3236, 3236, 3236
    .short 3236, 3236, 3236, 3236, 3092, 3092, 3092, 3092, 3092, 3092, 3092, 2948, 2948, 2948, 2948, 2948
    .short 2948, 2948, 2948, 2948, 2804, 2804, 2804, 2804, 2804, 2804, 2804, 2660, 2660, 2660, 2660, 2660
    .short 2660, 2660, 2660, 2660, 2516, 2516, 2516, 2516, 2516, 2516, 2516, 2372, 2372, 2372, 2372, 2372
    .short 2372, 2372, 2372, 2372, 2228, 2228, 2228, 2228, 2228, 2228, 2228, 2084, 2084, 2084, 2084, 2084
    .short 2084, 2084, 2084, 2084, 1940, 1940, 1940, 1940, 1940, 1940, 1940, 1796, 1796, 1796, 1796, 1796
    .short 1796, 1796, 1796, 1796, 1652, 1652, 1652, 1652, 1652, 1652, 1652, 1508, 1508, 1508, 1508, 1508
    .short 1508, 1508, 1508, 1508, 1364, 1364, 1364, 1364, 1364, 1364, 1364, 1220, 1220, 1220, 1220, 1220
    .short 1220, 1220, 1220, 1220, 1076, 1076, 1076, 1076, 1076, 1076, 1076, 932, 932, 932, 932, 932
    .short 932, 932, 932, 932, 788, 788, 788, 788, 788, 788, 788, 644, 644, 644, 644, 644
    .short 644, 644, 644, 644, 500, 500, 500, 500, 500, 500, 500, 356, 356, 356, 356, 356
    .short 356, 356, 356, 356, 212, 212, 212, 212, 212, 212, 212, 68, 68, 68, 68, 68
    .short 68, 68, 68, 68, 4528, 4528, 4528, 4528, 4528, 4528, 4528, 4384, 4384, 4384, 4384, 4384
    .short 4384, 4384, 4384, 4384, 4240, 4240, 4240, 4240, 4240, 4240, 4240, 4096, 4096, 4096, 4096, 4096
    .short 4096, 4096, 4096, 4096, 3952, 3952, 3952, 3952, 3952, 3952, 3952, 3808, 3808, 3808, 3808, 3808
    .short 3808, 3808, 3808, 3808, 3664, 3664, 3664, 3664, 3664, 3664, 3664, 3520, 3520, 3520, 3520, 3520
    .short 3520, 3520, 3520, 3520, 3376, 3376, 3376, 3376, 3376, 3376, 3376, 3232, 3232, 3232, 3232, 3232
    .short 3232, 3232, 3232, 3232, 3088, 3088, 3088, 3088, 3088, 3088, 3088, 2944, 2944, 2944, 2944, 2944
    .short 2944, 2944, 2944, 2944, 2800, 2800, 2800, 2800, 2800, 2800, 2800, 2656, 2656, 2656, 2656, 2656
    .short 2656, 2656, 2656, 2656, 2512, 2512, 2512, 2512, 2512, 2512, 2512, 2368, 2368, 2368, 2368, 2368
    .short 2368, 2368, 2368, 2368, 2224, 2224, 2224, 2224, 2224, 2224, 2224, 2080, 2080, 2080, 2080, 2080
    .short 2080, 2080, 2080, 2080, 1936, 1936, 1936, 1936, 1936, 1936, 1936, 1792, 1792, 1792, 1792, 1792
    .short 1792, 1792, 1792, 1792, 1648, 1648, 1648, 1648, 1648, 1648, 1648, 1504, 1504, 1504, 1504, 1504
    .short 1504, 1504, 1504, 1504, 1360, 1360, 1360, 1360, 1360, 1360, 1360, 1216, 1216, 1216, 1216, 1216
    .short 1216, 1216, 1216, 1216, 1072, 1072, 1072, 1072, 1072, 1072, 1072, 928, 928, 928, 928, 928
    .short 928, 928, 928, 928, 784, 784, 784, 784, 784, 784, 784, 640, 640, 640, 640, 640
    .short 640, 640, 640, 640, 496, 496, 496, 496, 496, 496, 496, 352, 352, 352, 352, 352
    .short 352, 352, 352, 352, 208, 208, 208, 208, 208, 208, 208, 64, 64, 64, 64, 64
    .short 64, 64, 4524, 4524, 4524, 4520, 4520, 4520, 4520, 4520, 4380, 4380, 4380, 4376, 4376, 4376
    .short 4376, 4376, 4236, 4236, 4236, 4232, 4232, 4232, 4232, 4232, 4092, 4092, 4092, 4088, 4088, 4088
    .short 4088, 4088, 3948, 3948, 3948, 3944, 3944, 3944, 3944, 3944, 3804, 3804, 3804, 3800, 3800, 3800
    .short 3800, 3800, 3660, 3660, 3660, 3656, 3656, 3656, 3656, 3656, 3516, 3516, 3516, 3512, 3512, 3512
    .short 3512, 3512, 3372, 3372, 3372, 3368, 3368, 3368, 3368, 3368, 3228, 3228, 3228, 3224, 3224, 3224
    .short 3224, 3224, 3084, 3084, 3084, 3080, 3080, 3080, 3080, 3080, 2940, 2940, 2940, 2936, 2936, 2936
    .short 2936, 2936, 2796, 2796, 2796, 2792, 2792, 2792, 2792, 2792, 2652, 2652, 2652, 2648, 2648, 2648
    .short 2648, 2648, 2508, 2508, 2508, 2504, 2504, 2504, 2504, 2504, 2364, 2364, 2364, 2360, 2360, 2360
    .short 2360, 2360, 2220, 2220, 2220, 2216, 2216, 2216, 2216, 2216, 2076, 2076, 2076, 2072, 2072, 2072
    .short 2072, 2072, 1932, 1932, 1932, 1928, 1928, 1928, 1928, 1928, 1788, 1788, 1788, 1784, 1784, 1784
    .short 1784, 1784, 1644, 1644, 1644, 1640, 1640, 1640, 1640, 1640, 1500, 1500, 1500, 1496, 1496, 1496
    .short 1496, 1496, 1356, 1356, 1356, 1352, 1352, 1352, 1352, 1352, 1212, 1212, 1212, 1208, 1208, 1208
    .short 1208, 1208, 1068, 1068, 1068, 1064, 1064, 1064, 1064, 1064, 924, 924, 924, 920, 920, 920
    .short 920, 920, 780, 780, 780, 776, 776, 776, 776, 776, 636, 636, 636, 632, 632, 632
    .short 632, 632, 492, 492, 492, 488, 488, 488, 488, 488, 348, 348, 348, 344, 344, 344
    .short 344, 344, 204, 204, 204, 200, 200, 200, 200, 200, 60, 60, 60, 56, 56, 56
    .short 56, 56, 4516, 4516, 4516, 4512, 4512, 4512, 4512, 4512, 4372, 4372, 4372, 4368, 4368, 4368
    .short 4368, 4368, 4228, 4228, 4228, 4224, 4224, 4224, 4224, 4224, 4084, 4084, 4084, 4080, 4080, 4080
    .short 4080, 4080, 3940, 3940, 3940, 3936, 3936, 3936, 3936, 3936, 3796, 3796, 3796, 3792, 3792, 3792
    .short 3792, 3792, 3652, 3652, 3652, 3648, 3648, 3648, 3648, 3648, 3508, 3508, 3508, 3504, 3504, 3504
    .short 3504, 3504, 3364, 3364, 3364, 3360, 3360, 3360, 3360, 3360, 3220, 3220, 3220, 3216, 3216, 3216
    .short 3216, 3216, 3076, 3076, 3076, 3072, 3072, 3072, 3072, 3072, 2932, 2932, 2932, 2928, 2928, 2928
    .short 2928, 2928, 2788, 2788, 2788, 2784, 2784, 2784, 2784, 2784, 2644, 2644, 2644, 2640, 2640, 2640
    .short 2640, 2640, 2500, 2500, 2500, 2496, 2496, 2496, 2496, 2496, 2356, 2356, 2356, 2352, 2352, 2352
    .short 2352, 2352, 2212, 2212, 2212, 2208, 2208, 2208, 2208, 2208, 2068, 2068, 2068, 2064, 2064, 2064
    .short 2064, 2064, 1924, 1924, 1924, 1920, 1920, 1920, 1920, 1920, 1780, 1780, 1780, 1776, 1776, 1776
    .short 1776, 1776, 1636, 1636, 1636, 1632, 1632, 1632, 1632, 1632, 1492, 1492, 1492, 1488, 1488, 1488
    .short 1488, 1488, 1348, 1348, 1348, 1344, 1344, 1344, 1344, 1344, 1204, 1204, 1204, 1200, 1200, 1200
    .short 1200, 1200, 1060, 1060, 1060, 1056, 1056, 1056, 1056, 1056, 916, 916, 916, 912, 912, 912
    .short 912, 912, 772, 772, 772, 768, 768, 768, 768, 768, 628, 628, 628, 624, 624, 624
    .short 624, 624, 484, 484, 484, 480, 480, 480, 480, 480, 340, 340, 340, 336, 336, 336
    .short 336, 336, 196, 196, 196, 192, 192, 192, 192, 192, 52, 52, 52, 48, 48, 48
    .short 48, 4508, 4504, 4504, 4504, 4500, 4496, 4496, 4496, 4364, 4360, 4360, 4360, 4356, 4352, 4352
    .short 4352, 4220, 4216, 4216, 4216, 4212, 4208, 4208, 4208, 4076, 4072, 4072, 4072, 4068, 4064, 4064
    .short 4064, 3932, 3928, 3928, 3928, 3924, 3920, 3920, 3920, 3788, 3784, 3784, 3784, 3780, 3776, 3776
    .short 3776, 3644, 3640, 3640, 3640, 3636, 3632, 3632, 3632, 3500, 3496, 3496, 3496, 3492, 3488, 3488
    .short 3488, 3356, 3352, 3352, 3352, 3348, 3344, 3344, 3344, 3212, 3208, 3208, 3208, 3204, 3200, 3200
    .short 3200, 3068, 3064, 3064, 3064, 3060, 3056, 3056, 3056, 2924, 2920, 2920, 2920, 2916, 2912, 2912
    .short 2912, 2780, 2776, 2776, 2776, 2772, 2768, 2768, 2768, 2636, 2632, 2632, 2632, 2628, 2624, 2624
    .short 2624, 2492, 2488, 2488, 2488, 2484, 2480, 2480, 2480, 2348, 2344, 2344, 2344, 2340, 2336, 2336
    .short 2336, 2204, 2200, 2200, 2200, 2196, 2192, 2192, 2192, 2060, 2056, 2056, 2056, 2052, 2048, 2048
    .short 2048, 1916, 1912, 1912, 1912, 1908, 1904, 1904, 1904, 1772, 1768, 1768, 1768, 1764, 1760, 1760
    .short 1760, 1628, 1624, 1624, 1624, 1620, 1616, 1616, 1616, 1484, 1480, 1480, 1480, 1476, 1472, 1472
    .short 1472, 1340, 1336, 1336, 1336, 1332, 1328, 1328, 1328, 1196, 1192, 1192, 1192, 1188, 1184, 1184
    .short 1184, 1052, 1048, 1048, 1048, 1044, 1040, 1040, 1040, 908, 904, 904, 904, 900, 896, 896
    .short 896, 764, 760, 760, 760, 756, 752, 752, 752, 620, 616, 616, 616, 612, 608, 608
    .short 608, 476, 472, 472, 472, 468, 464, 464, 464, 332, 328, 328, 328, 324, 320, 320
    .short 320, 188, 184, 184, 184, 180, 176, 176, 176, 44, 40, 40, 40, 36, 32, 32
    .short 4492, 4488, 4484, 4480, 4476, 4472, 4468, 4464, 4348, 4344, 4340, 4336, 4332, 4328, 4324, 4320
    .short 4204, 4200, 4196, 4192, 4188, 4184, 4180, 4176, 4060, 4056, 4052, 4048, 4044, 4040, 4036, 4032
    .short 3916, 3912, 3908, 3904, 3900, 3896, 3892, 3888, 3772, 3768, 3764, 3760, 3756, 3752, 3748, 3744
    .short 3628, 3624, 3620, 3616, 3612, 3608, 3604, 3600, 3484, 3480, 3476, 3472, 3468, 3464, 3460, 3456
    .short 3340, 3336, 3332, 3328, 3324, 3320, 3316, 3312, 3196, 3192, 3188, 3184, 3180, 3176, 3172, 3168
    .short 3052, 3048, 3044, 3040, 3036, 3032, 3028, 3024, 2908, 2904, 2900, 2896, 2892, 2888, 2884, 2880
    .short 2764, 2760, 2756, 2752, 2748, 2744, 2740, 2736, 2620, 2616, 2612, 2608, 2604, 2600, 2596, 2592
    .short 2476, 2472, 2468, 2464, 2460, 2456, 2452, 2448, 2332, 2328, 2324, 2320, 2316, 2312, 2308, 2304
    .short 2188, 2184, 2180, 2176, 2172, 2168, 2164, 2160, 2044, 2040, 2036, 2032, 2028, 2024, 2020, 2016
    .short 1900, 1896, 1892, 1888, 1884, 1880, 1876, 1872, 1756, 1752, 1748, 1744, 1740, 1736, 1732, 1728
    .short 1612, 1608, 1604, 1600, 1596, 1592, 1588, 1584, 1468, 1464, 1460, 1456, 1452, 1448, 1444, 1440
    .short 1324, 1320, 1316, 1312, 1308, 1304, 1300, 1296, 1180, 1176, 1172, 1168, 1164, 1160, 1156, 1152
    .short 1036, 1032, 1028, 1024, 1020, 1016, 1012, 1008, 892, 888, 884, 880, 876, 872, 868, 864
    .short 748, 744, 740, 736, 732, 728, 724, 720, 604, 600, 596, 592, 588, 584, 580, 576
    .short 460, 456, 452, 448, 444, 440, 436, 432, 316, 312, 308, 304, 300, 296, 292, 288
    .short 172, 168, 164, 160, 156, 152, 148, 144, 28, 24, 20, 16, 12, 8, 4, 0
    .short 128, 128, 128, 128, 128, 128, 128, 128, 128, 128, 128, 128, 128, 128, 128, 128
.section .rodata,"a"
.p2align 6
.amdhsa_kernel fz_kernel
  .amdhsa_next_free_vgpr 512
  .amdhsa_next_free_sgpr 102
  .amdhsa_accum_offset 256
  .amdhsa_group_segment_fixed_size 0
  .amdhsa_kernarg_size 136
  .amdhsa_user_sgpr_count 2
  .amdhsa_user_sgpr_kernarg_segment_ptr 1
  .amdhsa_system_sgpr_workgroup_id_x 1
  .amdhsa_float_denorm_mode_32 3
  .amdhsa_ieee_mode 0
.end_amdhsa_kernel
```
